```python
import torch

def _softmax(x, axis=-1):
    return torch.softmax(x, dim=axis)

def _gelu(x):
    return torch.nn.functional.gelu(x, approximate='tanh')

def _silu(x):
    return torch.nn.functional.silu(x)

def _sigmoid(x):
    return torch.sigmoid(x)

def _layernorm(x, axis=-1, eps=1e-05):
    m = x.mean(dim=axis, keepdim=True)
    v = x.var(dim=axis, keepdim=True, unbiased=False)
    return (x - m) / torch.sqrt(v + eps)

def _scatter_add(tgt, idx, src, axis=0):
    return tgt.clone().index_add_(axis, idx, src)

def _segment_sum(src, seg, n):
    out = torch.zeros((n,) + src.shape[1:], dtype=src.dtype)
    return out.index_add_(0, seg, src)

def _pad(x, pw):
    flat = tuple((v for pair in reversed(pw) for v in pair))
    return torch.nn.functional.pad(x, flat)
kernel_name = 'adaLN_cond__ssm_conv_s4__mixer_gmlp__prompt'

def setup_inputs():

    _w = lambda a: (lambda t: t.to(torch.bfloat16) if t.is_floating_point() else t)(torch.as_tensor(a))

    def _A_setup():
        B, L, D, N = (1, 2048, 640, 128)
        A_re = -(lambda _x: torch.exp(torch.as_tensor(_x)))((lambda *s: torch.randn(*s, dtype=torch.bfloat16) * 3.2)(D, N))
        A_im = torch.pi * (lambda *s: torch.randn(*s, dtype=torch.bfloat16) * 0.1)(D, N)
        B_re = (lambda *s: torch.randn(*s, dtype=torch.bfloat16) * 0.2)(D, N)
        B_im = (lambda *s: torch.randn(*s, dtype=torch.bfloat16) * 0.2)(D, N)
        C_re = (lambda *s: torch.randn(*s, dtype=torch.bfloat16) * 0.2)(D, N)
        C_im = (lambda *s: torch.randn(*s, dtype=torch.bfloat16) * 0.2)(D, N)
        log_dt = (lambda *s: torch.randn(*s, dtype=torch.bfloat16) * 0.1)(D) * 0.5 - 4.0
        Dskip = (lambda *s: torch.randn(*s, dtype=torch.bfloat16) * 0.1)(D)
        return {'u': _w((lambda *s: torch.randn(*s, dtype=torch.bfloat16) * 0.05)(B, L, D)), 'A_re': _w(A_re), 'A_im': _w(A_im), 'B_re': _w(B_re), 'B_im': _w(B_im), 'C_re': _w(C_re), 'C_im': _w(C_im), 'log_dt': _w(log_dt), 'Dskip': _w(Dskip)}
    _A_in = _A_setup()

    def _B_setup():
        B, S, D, F = (1, 2048, 640, 1728)
        Fh = F // 2
        return {'x': _w((lambda *s: torch.randn(*s, dtype=torch.bfloat16) * 0.05)(B, S, D)), 'w_in': _w((lambda *s: torch.randn(*s, dtype=torch.bfloat16) * 0.2)(D, 2 * Fh)), 'w_sp': _w(0.01 * (lambda *s: torch.randn(*s, dtype=torch.bfloat16) * 0.2)(S, S)), 'b_sp': _w(1.0 + 0.01 * (lambda *s: torch.randn(*s, dtype=torch.bfloat16) * 0.05)(S)), 'w_out': _w((lambda *s: torch.randn(*s, dtype=torch.bfloat16) * 0.05)(Fh, D))}
    _B_in = _B_setup()
    return {'A_u': _A_in['u'], 'A_A_re': _A_in['A_re'], 'A_A_im': _A_in['A_im'], 'A_B_re': _A_in['B_re'], 'A_B_im': _A_in['B_im'], 'A_C_re': _A_in['C_re'], 'A_C_im': _A_in['C_im'], 'A_log_dt': _A_in['log_dt'], 'A_Dskip': _A_in['Dskip'], 'B_x': _B_in['x'], 'B_w_in': _B_in['w_in'], 'B_w_sp': _B_in['w_sp'], 'B_b_sp': _B_in['b_sp'], 'B_w_out': _B_in['w_out'], 'c': _w((lambda *s: torch.randn(*s, dtype=torch.bfloat16) * 0.1)(1, 640) * 8.0), 'w_mod': _w((lambda *s: torch.randn(*s, dtype=torch.bfloat16) * 0.1)(640, 6 * 640) * 640 ** (-0.5) * 8.0)}

def reference(A_u, A_A_re, A_A_im, A_B_re, A_B_im, A_C_re, A_C_im, A_log_dt, A_Dskip, B_x, B_w_in, B_w_sp, B_b_sp, B_w_out, c, w_mod):

    def _A_ref(u, A_re, A_im, B_re, B_im, C_re, C_im, log_dt, Dskip):
        Bsz, L, D = u.shape
        dt = torch.exp(log_dt)[:, None]
        A = A_re + 1j * A_im
        Bc = B_re + 1j * B_im
        Cc = C_re + 1j * C_im
        logdA = dt * A
        dB = dt * Bc
        l = (lambda x, dt: x.to(dt))(torch.arange(L), A_re.dtype)
        P = torch.exp(logdA[:, :, None] * l[None, None, :])
        K = torch.einsum('dn,dnl,dn->dl', Cc, P, dB).real
        L2 = 2 * L
        Kp = _pad(K, ((0, 0), (0, L)))
        up = (lambda x, *d: x.permute(*d))(u, 0, 2, 1)
        up = _pad(up, ((0, 0), (0, 0), (0, L)))
        Kf = (lambda x, axes=(-2, -1): torch.fft.rfft2(x.float(), dim=axes))(Kp[:, None, :], axes=(-2, -1))
        Uf = (lambda x, axes=(-2, -1): torch.fft.rfft2(x.float(), dim=axes))(up[:, :, None, :], axes=(-2, -1))
        Yf = Uf * Kf[None, :, :, :]
        y = (lambda x, s, axes=(-2, -1): torch.fft.irfft2(x, s=s, dim=axes).to(torch.bfloat16))(Yf, (1, L2), axes=(-2, -1))[:, :, 0, :L]
        y = (lambda x, *d: x.permute(*d))(y, 0, 2, 1) + u * Dskip[None, None, :]
        return y

    def _B_ref(x, w_in, w_sp, b_sp, w_out):
        B, S, D = x.shape
        F = w_in.shape[-1]
        Fh = F // 2
        z = _gelu(torch.einsum('bsd,df->bsf', x, w_in))
        z1 = z[..., :Fh].clone()
        z2 = _layernorm(z[..., Fh:], axis=-1)
        g = torch.einsum('ts,bsf->btf', w_sp, z2) + b_sp[None, :, None]
        return torch.einsum('bsf,fd->bsd', z1 * g, w_out)
    x = A_u
    mod = (_silu(c) @ w_mod).reshape(c.shape[0], 6, 1, -1)
    sa, ca, ga, sb, cb, gb = (mod[:, 0].clone(), mod[:, 1].clone(), mod[:, 2].clone(), mod[:, 3].clone(), mod[:, 4].clone(), mod[:, 5].clone())
    h = _layernorm(x, axis=-1) * (1 + ca) + sa
    x = x + ga * _A_ref(h, A_A_re, A_A_im, A_B_re, A_B_im, A_C_re, A_C_im, A_log_dt, A_Dskip)
    h = _layernorm(x, axis=-1) * (1 + cb) + sb
    x = x + gb * _B_ref(h, B_w_in, B_w_sp, B_b_sp, B_w_out)
    return x
```

```asm
; @launch kernel=ka_prepconv_kernel grid=(1039,1,1) block=(256,1,1) lds=37888
; @launch kernel=k2_gemm1_kernel grid=(256,1,1) block=(512,1,1) lds=86016
; @launch kernel=k3_gemm2_kernel grid=(256,1,1) block=(512,1,1) lds=144384
; @launch kernel=k4_gemm3_kernel grid=(256,1,1) block=(256,1,1) lds=86016
.amdgcn_target "amdgcn-amd-amdhsa--gfx950"
.text
.globl ka_prepconv_kernel
.p2align 8
.type ka_prepconv_kernel,@function
ka_prepconv_kernel:
    s_cmp_ge_u32 s2, 1039
    s_cbranch_scc1 ka_exit
    s_load_dwordx2 s[34:35], s[0:1], 136
    s_load_dwordx2 s[30:31], s[0:1], 144
    s_cmp_ge_u32 s2, 1012
    s_cbranch_scc1 ka_t5
    s_cmp_ge_u32 s2, 904
    s_cbranch_scc1 ka_wprep
    s_cmp_ge_u32 s2, 264
    s_cbranch_scc1 ka_conv
    s_cmp_ge_u32 s2, 136
    s_cbranch_scc1 ka_t1
    s_cmp_eq_u32 s2, 0
    s_cbranch_scc1 ka_zero
    s_cmp_lt_u32 s2, 8
    s_cbranch_scc1 ka_exit
    s_load_dwordx2 s[36:37], s[0:1], 120
    s_load_dwordx2 s[38:39], s[0:1], 112
    s_waitcnt lgkmcnt(0)
    s_sub_u32 s3, s2, 8
    s_mov_b32 s8, s36
    s_and_b32 s9, s37, 0xffff
    s_mov_b32 s10, 4915200
    s_mov_b32 s11, 0x20000
    s_add_u32 s12, s30, 5279744
    s_addc_u32 s13, s31, 0
    s_and_b32 s13, s13, 0xffff
    s_mov_b32 s14, 245760
    s_mov_b32 s15, 0x20000
    s_mov_b32 s16, s38
    s_and_b32 s17, s39, 0xffff
    s_mov_b32 s18, 1284
    s_mov_b32 s19, 0x20000
    s_setprio 3
    v_lshrrev_b32 v1, 6, v0
    s_nop 0
    v_readfirstlane_b32 s5, v1
    s_and_b32 s6, s3, 7
    s_lshr_b32 s7, s3, 3
    s_mul_i32 s20, s7, 40
    s_mul_i32 s21, s5, 10
    s_add_u32 s20, s20, s21
    v_and_b32 v1, 63, v0
    v_min_u32 v2, 9, v1
    v_add_u32 v2, s20, v2
    v_lshlrev_b32 v2, 1, v2
    buffer_load_ushort v3, v2, s[16:19], 0 offen
    v_min_u32 v4, 59, v1
    v_lshlrev_b32 v4, 4, v4
    s_mul_i32 s21, s6, 960
    v_add_u32 v4, s21, v4
    s_mul_i32 s22, s20, 7680
    buffer_load_dwordx4 v[8:11], v4, s[8:11], s22 offen nt
    s_add_u32 s22, s22, 7680
    buffer_load_dwordx4 v[12:15], v4, s[8:11], s22 offen nt
    s_add_u32 s22, s22, 7680
    buffer_load_dwordx4 v[16:19], v4, s[8:11], s22 offen nt
    s_add_u32 s22, s22, 7680
    buffer_load_dwordx4 v[20:23], v4, s[8:11], s22 offen nt
    s_add_u32 s22, s22, 7680
    buffer_load_dwordx4 v[24:27], v4, s[8:11], s22 offen nt
    s_add_u32 s22, s22, 7680
    buffer_load_dwordx4 v[28:31], v4, s[8:11], s22 offen nt
    s_add_u32 s22, s22, 7680
    buffer_load_dwordx4 v[32:35], v4, s[8:11], s22 offen nt
    s_add_u32 s22, s22, 7680
    buffer_load_dwordx4 v[36:39], v4, s[8:11], s22 offen nt
    s_add_u32 s22, s22, 7680
    buffer_load_dwordx4 v[40:43], v4, s[8:11], s22 offen nt
    s_add_u32 s22, s22, 7680
    buffer_load_dwordx4 v[44:47], v4, s[8:11], s22 offen nt
    s_waitcnt vmcnt(10)
    v_lshlrev_b32 v3, 16, v3
    v_mul_f32 v5, 0xbfb8aa3b, v3
    v_exp_f32 v5, v5
    s_nop 0
    v_add_f32 v5, 1.0, v5
    v_rcp_f32 v5, v5
    s_nop 0
    v_mul_f32 v5, v3, v5
    v_cvt_pk_bf16_f32 v5, v5, v5
    v_lshlrev_b32 v5, 16, v5
    s_nop 0
    v_readlane_b32 s40, v5, 0
    v_readlane_b32 s41, v5, 1
    v_readlane_b32 s42, v5, 2
    v_readlane_b32 s43, v5, 3
    v_readlane_b32 s44, v5, 4
    v_readlane_b32 s45, v5, 5
    v_readlane_b32 s46, v5, 6
    v_readlane_b32 s47, v5, 7
    v_readlane_b32 s48, v5, 8
    v_readlane_b32 s49, v5, 9
    s_mov_b32 s23, 0xffff0000
    v_mov_b32 v48, 0
    v_mov_b32 v49, 0
    v_mov_b32 v50, 0
    v_mov_b32 v51, 0
    v_mov_b32 v52, 0
    v_mov_b32 v53, 0
    v_mov_b32 v54, 0
    v_mov_b32 v55, 0
    s_waitcnt vmcnt(9)
    v_lshlrev_b32 v56, 16, v8
    v_and_b32 v57, s23, v8
    v_fmac_f32 v48, s40, v56
    v_fmac_f32 v49, s40, v57
    v_lshlrev_b32 v58, 16, v9
    v_and_b32 v59, s23, v9
    v_fmac_f32 v50, s40, v58
    v_fmac_f32 v51, s40, v59
    v_lshlrev_b32 v56, 16, v10
    v_and_b32 v57, s23, v10
    v_fmac_f32 v52, s40, v56
    v_fmac_f32 v53, s40, v57
    v_lshlrev_b32 v58, 16, v11
    v_and_b32 v59, s23, v11
    v_fmac_f32 v54, s40, v58
    v_fmac_f32 v55, s40, v59
    s_waitcnt vmcnt(8)
    v_lshlrev_b32 v56, 16, v12
    v_and_b32 v57, s23, v12
    v_fmac_f32 v48, s41, v56
    v_fmac_f32 v49, s41, v57
    v_lshlrev_b32 v58, 16, v13
    v_and_b32 v59, s23, v13
    v_fmac_f32 v50, s41, v58
    v_fmac_f32 v51, s41, v59
    v_lshlrev_b32 v56, 16, v14
    v_and_b32 v57, s23, v14
    v_fmac_f32 v52, s41, v56
    v_fmac_f32 v53, s41, v57
    v_lshlrev_b32 v58, 16, v15
    v_and_b32 v59, s23, v15
    v_fmac_f32 v54, s41, v58
    v_fmac_f32 v55, s41, v59
    s_waitcnt vmcnt(7)
    v_lshlrev_b32 v56, 16, v16
    v_and_b32 v57, s23, v16
    v_fmac_f32 v48, s42, v56
    v_fmac_f32 v49, s42, v57
    v_lshlrev_b32 v58, 16, v17
    v_and_b32 v59, s23, v17
    v_fmac_f32 v50, s42, v58
    v_fmac_f32 v51, s42, v59
    v_lshlrev_b32 v56, 16, v18
    v_and_b32 v57, s23, v18
    v_fmac_f32 v52, s42, v56
    v_fmac_f32 v53, s42, v57
    v_lshlrev_b32 v58, 16, v19
    v_and_b32 v59, s23, v19
    v_fmac_f32 v54, s42, v58
    v_fmac_f32 v55, s42, v59
    s_waitcnt vmcnt(6)
    v_lshlrev_b32 v56, 16, v20
    v_and_b32 v57, s23, v20
    v_fmac_f32 v48, s43, v56
    v_fmac_f32 v49, s43, v57
    v_lshlrev_b32 v58, 16, v21
    v_and_b32 v59, s23, v21
    v_fmac_f32 v50, s43, v58
    v_fmac_f32 v51, s43, v59
    v_lshlrev_b32 v56, 16, v22
    v_and_b32 v57, s23, v22
    v_fmac_f32 v52, s43, v56
    v_fmac_f32 v53, s43, v57
    v_lshlrev_b32 v58, 16, v23
    v_and_b32 v59, s23, v23
    v_fmac_f32 v54, s43, v58
    v_fmac_f32 v55, s43, v59
    s_waitcnt vmcnt(5)
    v_lshlrev_b32 v56, 16, v24
    v_and_b32 v57, s23, v24
    v_fmac_f32 v48, s44, v56
    v_fmac_f32 v49, s44, v57
    v_lshlrev_b32 v58, 16, v25
    v_and_b32 v59, s23, v25
    v_fmac_f32 v50, s44, v58
    v_fmac_f32 v51, s44, v59
    v_lshlrev_b32 v56, 16, v26
    v_and_b32 v57, s23, v26
    v_fmac_f32 v52, s44, v56
    v_fmac_f32 v53, s44, v57
    v_lshlrev_b32 v58, 16, v27
    v_and_b32 v59, s23, v27
    v_fmac_f32 v54, s44, v58
    v_fmac_f32 v55, s44, v59
    s_waitcnt vmcnt(4)
    v_lshlrev_b32 v56, 16, v28
    v_and_b32 v57, s23, v28
    v_fmac_f32 v48, s45, v56
    v_fmac_f32 v49, s45, v57
    v_lshlrev_b32 v58, 16, v29
    v_and_b32 v59, s23, v29
    v_fmac_f32 v50, s45, v58
    v_fmac_f32 v51, s45, v59
    v_lshlrev_b32 v56, 16, v30
    v_and_b32 v57, s23, v30
    v_fmac_f32 v52, s45, v56
    v_fmac_f32 v53, s45, v57
    v_lshlrev_b32 v58, 16, v31
    v_and_b32 v59, s23, v31
    v_fmac_f32 v54, s45, v58
    v_fmac_f32 v55, s45, v59
    s_waitcnt vmcnt(3)
    v_lshlrev_b32 v56, 16, v32
    v_and_b32 v57, s23, v32
    v_fmac_f32 v48, s46, v56
    v_fmac_f32 v49, s46, v57
    v_lshlrev_b32 v58, 16, v33
    v_and_b32 v59, s23, v33
    v_fmac_f32 v50, s46, v58
    v_fmac_f32 v51, s46, v59
    v_lshlrev_b32 v56, 16, v34
    v_and_b32 v57, s23, v34
    v_fmac_f32 v52, s46, v56
    v_fmac_f32 v53, s46, v57
    v_lshlrev_b32 v58, 16, v35
    v_and_b32 v59, s23, v35
    v_fmac_f32 v54, s46, v58
    v_fmac_f32 v55, s46, v59
    s_waitcnt vmcnt(2)
    v_lshlrev_b32 v56, 16, v36
    v_and_b32 v57, s23, v36
    v_fmac_f32 v48, s47, v56
    v_fmac_f32 v49, s47, v57
    v_lshlrev_b32 v58, 16, v37
    v_and_b32 v59, s23, v37
    v_fmac_f32 v50, s47, v58
    v_fmac_f32 v51, s47, v59
    v_lshlrev_b32 v56, 16, v38
    v_and_b32 v57, s23, v38
    v_fmac_f32 v52, s47, v56
    v_fmac_f32 v53, s47, v57
    v_lshlrev_b32 v58, 16, v39
    v_and_b32 v59, s23, v39
    v_fmac_f32 v54, s47, v58
    v_fmac_f32 v55, s47, v59
    s_waitcnt vmcnt(1)
    v_lshlrev_b32 v56, 16, v40
    v_and_b32 v57, s23, v40
    v_fmac_f32 v48, s48, v56
    v_fmac_f32 v49, s48, v57
    v_lshlrev_b32 v58, 16, v41
    v_and_b32 v59, s23, v41
    v_fmac_f32 v50, s48, v58
    v_fmac_f32 v51, s48, v59
    v_lshlrev_b32 v56, 16, v42
    v_and_b32 v57, s23, v42
    v_fmac_f32 v52, s48, v56
    v_fmac_f32 v53, s48, v57
    v_lshlrev_b32 v58, 16, v43
    v_and_b32 v59, s23, v43
    v_fmac_f32 v54, s48, v58
    v_fmac_f32 v55, s48, v59
    s_waitcnt vmcnt(0)
    v_lshlrev_b32 v56, 16, v44
    v_and_b32 v57, s23, v44
    v_fmac_f32 v48, s49, v56
    v_fmac_f32 v49, s49, v57
    v_lshlrev_b32 v58, 16, v45
    v_and_b32 v59, s23, v45
    v_fmac_f32 v50, s49, v58
    v_fmac_f32 v51, s49, v59
    v_lshlrev_b32 v56, 16, v46
    v_and_b32 v57, s23, v46
    v_fmac_f32 v52, s49, v56
    v_fmac_f32 v53, s49, v57
    v_lshlrev_b32 v58, 16, v47
    v_and_b32 v59, s23, v47
    v_fmac_f32 v54, s49, v58
    v_fmac_f32 v55, s49, v59
    v_mov_b32 v60, 0
    v_cmp_eq_u32 vcc, 0, v0
    s_nop 0
    s_and_saveexec_b64 s[70:71], vcc
    global_load_dword v61, v60, s[34:35] sc1
    s_mov_b64 exec, s[70:71]
    v_lshlrev_b32 v2, 5, v0
    ds_write_b128 v2, v[48:51]
    ds_write_b128 v2, v[52:55] offset:16
    s_waitcnt lgkmcnt(0)
    s_barrier
    v_lshlrev_b32 v2, 4, v0
    ds_read_b128 v[8:11], v2 offset:0
    ds_read_b128 v[12:15], v2 offset:2048
    ds_read_b128 v[16:19], v2 offset:4096
    ds_read_b128 v[20:23], v2 offset:6144
    s_waitcnt lgkmcnt(2)
    v_add_f32 v8, v8, v12
    s_waitcnt lgkmcnt(0)
    v_add_f32 v16, v16, v20
    v_add_f32 v9, v9, v13
    v_add_f32 v17, v17, v21
    v_add_f32 v10, v10, v14
    v_add_f32 v18, v18, v22
    v_add_f32 v11, v11, v15
    v_add_f32 v19, v19, v23
    v_add_f32 v8, v8, v16
    v_add_f32 v9, v9, v17
    v_add_f32 v10, v10, v18
    v_add_f32 v11, v11, v19
    s_mul_i32 s21, s6, 1920
    s_mul_i32 s22, s7, 15360
    s_add_u32 s22, s22, s21
    v_cmp_gt_u32 vcc, 120, v0
    s_nop 0
    s_and_saveexec_b64 s[24:25], vcc
    buffer_store_dwordx4 v[8:11], v2, s[12:15], s22 offen sc1
    s_mov_b64 exec, s[24:25]
    s_waitcnt vmcnt(0)
    s_barrier
    s_mov_b64 exec, 1
    v_cmp_eq_u32 vcc, 0, v0
    s_nop 0
    s_and_b64 exec, exec, vcc
    s_cbranch_execz ka_prepconv_kernel_nosig1
    s_mov_b32 s42, 0
ka_prepconv_kernel_chk2:
    v_readfirstlane_b32 s41, v61
    s_nop 0
    s_cmp_eq_u32 s41, 1
    s_cbranch_scc1 ka_prepconv_kernel_clr3
    s_add_u32 s42, s42, 1
    s_cmp_ge_u32 s42, 32768
    s_cbranch_scc1 ka_prepconv_kernel_nosig1
    s_sleep 2
    global_load_dword v61, v60, s[34:35] sc1
    s_waitcnt vmcnt(0)
    s_branch ka_prepconv_kernel_chk2
ka_prepconv_kernel_clr3:
    s_and_b32 s40, s2, 15
    s_lshl_b32 s41, s40, 8
    s_add_u32 s41, s41, 22163456
    v_mov_b32 v1, s41
    v_mov_b32 v2, 1
    global_atomic_add v3, v1, v2, s[30:31] sc0 sc1
    s_mov_b32 s40, 22167552
    s_waitcnt vmcnt(0)
    v_cmp_eq_u32 vcc, 15, v3
    s_nop 0
    s_and_b64 exec, exec, vcc
    s_cbranch_execz ka_prepconv_kernel_nosig1
    s_mov_b64 exec, -1
    v_lshl_add_u32 v1, v0, 8, s40
    v_mov_b32 v2, 1
    global_atomic_add v1, v2, s[30:31] sc1
ka_prepconv_kernel_nosig1:
    s_endpgm
ka_t1:
    s_nop 7
    s_nop 7
    s_load_dwordx2 s[36:37], s[0:1], 0
    s_waitcnt lgkmcnt(0)
    s_sub_u32 s3, s2, 136
    s_mov_b32 s8, s36
    s_and_b32 s9, s37, 0xffff
    s_mov_b32 s10, 2621440
    s_mov_b32 s11, 0x20000
    s_mov_b32 s12, s30
    s_and_b32 s13, s31, 0xffff
    s_mov_b32 s14, 2621440
    s_mov_b32 s15, 0x20000
    s_add_u32 s16, s30, 2621440
    s_addc_u32 s17, s31, 0
    s_and_b32 s17, s17, 0xffff
    s_mov_b32 s18, 16384
    s_mov_b32 s19, 0x20000
    s_setprio 3
    v_lshrrev_b32 v1, 4, v0
    v_and_b32 v2, 15, v0
    s_lshl_b32 s4, s3, 4
    v_add_u32 v7, s4, v1
    v_mul_u32_u24 v3, 1280, v7
    v_lshl_add_u32 v3, v2, 4, v3
    buffer_load_dwordx4 v[8:11], v3, s[8:11], 0 offen offset:0 nt
    buffer_load_dwordx4 v[12:15], v3, s[8:11], 0 offen offset:256 nt
    buffer_load_dwordx4 v[16:19], v3, s[8:11], 0 offen offset:512 nt
    buffer_load_dwordx4 v[20:23], v3, s[8:11], 0 offen offset:768 nt
    buffer_load_dwordx4 v[24:27], v3, s[8:11], 0 offen offset:1024 nt
    v_mul_u32_u24 v5, 1312, v1
    v_lshl_add_u32 v5, v2, 4, v5
    v_lshrrev_b32 v6, 6, v0
    s_nop 0
    v_readfirstlane_b32 s5, v6
    v_bfe_u32 v4, v0, 4, 1
    v_bfe_u32 v6, v0, 2, 2
    v_lshl_add_u32 v6, v4, 3, v6
    v_mul_u32_u24 v28, 1312, v6
    v_and_b32 v6, 3, v0
    v_lshl_add_u32 v28, v6, 3, v28
    v_bfe_u32 v30, v0, 5, 1
    v_lshl_add_u32 v28, v30, 5, v28
    s_mul_i32 s6, s5, 320
    v_add_u32 v28, s6, v28
    v_bfe_u32 v29, v0, 2, 2
    v_lshl_add_u32 v29, v30, 2, v29
    v_lshlrev_b32 v29, 14, v29
    v_lshl_add_u32 v29, v6, 4, v29
    v_lshl_add_u32 v29, v4, 6, v29
    s_lshl_b32 s7, s3, 7
    s_mul_i32 s6, s5, 655360
    s_add_u32 s7, s7, s6
    v_mov_b32 v32, 0
    v_mov_b32 v33, 0
    v_mov_b32 v34, 0
    v_mov_b32 v35, 0
    s_mov_b32 s20, 0x3f803f80
    s_waitcnt vmcnt(4)
    ds_write_b128 v5, v[8:11] offset:0
    s_waitcnt vmcnt(3)
    ds_write_b128 v5, v[12:15] offset:256
    s_waitcnt vmcnt(2)
    ds_write_b128 v5, v[16:19] offset:512
    s_waitcnt vmcnt(1)
    ds_write_b128 v5, v[20:23] offset:768
    s_waitcnt vmcnt(0)
    ds_write_b128 v5, v[24:27] offset:1024
    s_waitcnt lgkmcnt(0)
    s_barrier
    ds_read_b64_tr_b16 v[36:37], v28 offset:0
    ds_read_b64_tr_b16 v[38:39], v28 offset:5248
    ds_read_b64_tr_b16 v[40:41], v28 offset:64
    ds_read_b64_tr_b16 v[42:43], v28 offset:5312
    ds_read_b64_tr_b16 v[44:45], v28 offset:128
    ds_read_b64_tr_b16 v[46:47], v28 offset:5376
    ds_read_b64_tr_b16 v[48:49], v28 offset:192
    ds_read_b64_tr_b16 v[50:51], v28 offset:5440
    ds_read_b64_tr_b16 v[52:53], v28 offset:256
    ds_read_b64_tr_b16 v[54:55], v28 offset:5504
    s_add_u32 s21, s7, 0
    s_waitcnt lgkmcnt(8)
    buffer_store_dwordx4 v[36:39], v29, s[12:15], s21 offen sc1
    s_add_u32 s21, s7, 131072
    s_waitcnt lgkmcnt(6)
    buffer_store_dwordx4 v[40:43], v29, s[12:15], s21 offen sc1
    s_add_u32 s21, s7, 262144
    s_waitcnt lgkmcnt(4)
    buffer_store_dwordx4 v[44:47], v29, s[12:15], s21 offen sc1
    s_add_u32 s21, s7, 393216
    s_waitcnt lgkmcnt(2)
    buffer_store_dwordx4 v[48:51], v29, s[12:15], s21 offen sc1
    s_add_u32 s21, s7, 524288
    s_waitcnt lgkmcnt(0)
    buffer_store_dwordx4 v[52:55], v29, s[12:15], s21 offen sc1
    v_mov_b32 v60, 0
    v_cmp_eq_u32 vcc, 0, v0
    s_nop 0
    s_and_saveexec_b64 s[70:71], vcc
    global_load_dword v61, v60, s[34:35] sc1
    s_mov_b64 exec, s[70:71]
    v_dot2_f32_bf16 v32, v8, s20, v32
    v_dot2_f32_bf16 v33, v9, s20, v33
    v_dot2_f32_bf16 v32, v10, s20, v32
    v_dot2_f32_bf16 v33, v11, s20, v33
    v_dot2_f32_bf16 v34, v8, v8, v34
    v_dot2_f32_bf16 v35, v9, v9, v35
    v_dot2_f32_bf16 v34, v10, v10, v34
    v_dot2_f32_bf16 v35, v11, v11, v35
    v_dot2_f32_bf16 v32, v12, s20, v32
    v_dot2_f32_bf16 v33, v13, s20, v33
    v_dot2_f32_bf16 v32, v14, s20, v32
    v_dot2_f32_bf16 v33, v15, s20, v33
    v_dot2_f32_bf16 v34, v12, v12, v34
    v_dot2_f32_bf16 v35, v13, v13, v35
    v_dot2_f32_bf16 v34, v14, v14, v34
    v_dot2_f32_bf16 v35, v15, v15, v35
    v_dot2_f32_bf16 v32, v16, s20, v32
    v_dot2_f32_bf16 v33, v17, s20, v33
    v_dot2_f32_bf16 v32, v18, s20, v32
    v_dot2_f32_bf16 v33, v19, s20, v33
    v_dot2_f32_bf16 v34, v16, v16, v34
    v_dot2_f32_bf16 v35, v17, v17, v35
    v_dot2_f32_bf16 v34, v18, v18, v34
    v_dot2_f32_bf16 v35, v19, v19, v35
    v_dot2_f32_bf16 v32, v20, s20, v32
    v_dot2_f32_bf16 v33, v21, s20, v33
    v_dot2_f32_bf16 v32, v22, s20, v32
    v_dot2_f32_bf16 v33, v23, s20, v33
    v_dot2_f32_bf16 v34, v20, v20, v34
    v_dot2_f32_bf16 v35, v21, v21, v35
    v_dot2_f32_bf16 v34, v22, v22, v34
    v_dot2_f32_bf16 v35, v23, v23, v35
    v_dot2_f32_bf16 v32, v24, s20, v32
    v_dot2_f32_bf16 v33, v25, s20, v33
    v_dot2_f32_bf16 v32, v26, s20, v32
    v_dot2_f32_bf16 v33, v27, s20, v33
    v_dot2_f32_bf16 v34, v24, v24, v34
    v_dot2_f32_bf16 v35, v25, v25, v35
    v_dot2_f32_bf16 v34, v26, v26, v34
    v_dot2_f32_bf16 v35, v27, v27, v35
    v_add_f32 v32, v32, v33
    s_nop 1
    v_add_f32 v34, v34, v35
    v_add_f32_dpp v32, v32, v32 quad_perm:[1,0,3,2] row_mask:0xf bank_mask:0xf
    s_nop 0
    v_add_f32_dpp v34, v34, v34 quad_perm:[1,0,3,2] row_mask:0xf bank_mask:0xf
    v_add_f32_dpp v32, v32, v32 quad_perm:[2,3,0,1] row_mask:0xf bank_mask:0xf
    s_nop 0
    v_add_f32_dpp v34, v34, v34 quad_perm:[2,3,0,1] row_mask:0xf bank_mask:0xf
    v_add_f32_dpp v32, v32, v32 row_half_mirror row_mask:0xf bank_mask:0xf
    s_nop 0
    v_add_f32_dpp v34, v34, v34 row_half_mirror row_mask:0xf bank_mask:0xf
    v_add_f32_dpp v32, v32, v32 row_mirror row_mask:0xf bank_mask:0xf
    s_nop 0
    v_add_f32_dpp v34, v34, v34 row_mirror row_mask:0xf bank_mask:0xf
    v_mul_f32 v32, 0x3acccccd, v32
    v_mul_f32 v34, 0x3acccccd, v34
    v_fma_f32 v34, -v32, v32, v34
    v_max_f32 v34, 0, v34
    v_cvt_pk_bf16_f32 v34, v34, v34
    v_lshlrev_b32 v34, 16, v34
    v_add_f32 v34, 0x3727c5ac, v34
    v_cvt_pk_bf16_f32 v34, v34, v34
    v_lshlrev_b32 v34, 16, v34
    v_sqrt_f32 v34, v34
    v_cvt_pk_bf16_f32 v32, v32, v32
    v_lshlrev_b32 v32, 16, v32
    v_cvt_pk_bf16_f32 v34, v34, v34
    v_lshlrev_b32 v34, 16, v34
    v_rcp_f32 v34, v34
    s_nop 0
    v_mul_f32 v35, v32, v34
    v_sub_f32 v35, 0, v35
    v_lshrrev_b32 v36, 3, v7
    v_lshlrev_b32 v36, 4, v36
    v_bfe_u32 v37, v7, 1, 2
    v_lshl_add_u32 v36, v37, 12, v36
    v_and_b32 v37, 1, v7
    v_lshl_add_u32 v7, v37, 3, v36
    v_cmp_eq_u32 vcc, 0, v2
    s_nop 0
    s_and_saveexec_b64 s[22:23], vcc
    buffer_store_dwordx2 v[34:35], v7, s[16:19], 0 offen sc1
    s_mov_b64 exec, s[22:23]
    s_waitcnt vmcnt(0)
    s_barrier
    s_mov_b64 exec, 1
    v_cmp_eq_u32 vcc, 0, v0
    s_nop 0
    s_and_b64 exec, exec, vcc
    s_cbranch_execz ka_prepconv_kernel_nosig4
    s_mov_b32 s42, 0
ka_prepconv_kernel_chk5:
    v_readfirstlane_b32 s41, v61
    s_nop 0
    s_cmp_eq_u32 s41, 1
    s_cbranch_scc1 ka_prepconv_kernel_clr6
    s_add_u32 s42, s42, 1
    s_cmp_ge_u32 s42, 32768
    s_cbranch_scc1 ka_prepconv_kernel_nosig4
    s_sleep 2
    global_load_dword v61, v60, s[34:35] sc1
    s_waitcnt vmcnt(0)
    s_branch ka_prepconv_kernel_chk5
ka_prepconv_kernel_clr6:
    s_and_b32 s40, s2, 15
    s_lshl_b32 s41, s40, 8
    s_add_u32 s41, s41, 22163456
    v_mov_b32 v1, s41
    v_mov_b32 v2, 1
    global_atomic_add v3, v1, v2, s[30:31] sc0 sc1
    s_mov_b32 s40, 22167552
    s_waitcnt vmcnt(0)
    v_cmp_eq_u32 vcc, 15, v3
    s_nop 0
    s_and_b64 exec, exec, vcc
    s_cbranch_execz ka_prepconv_kernel_nosig4
    s_mov_b64 exec, -1
    v_lshl_add_u32 v1, v0, 8, s40
    v_mov_b32 v2, 1
    global_atomic_add v1, v2, s[30:31] sc1
ka_prepconv_kernel_nosig4:
    s_endpgm
ka_t5:
    s_nop 7
    s_nop 7
    s_load_dwordx2 s[36:37], s[0:1], 104
    s_waitcnt lgkmcnt(0)
    s_sub_u32 s3, s2, 1012
    s_mov_b32 s8, s36
    s_and_b32 s9, s37, 0xffff
    s_mov_b32 s10, 1105920
    s_mov_b32 s11, 0x20000
    s_add_u32 s12, s30, 5525504
    s_addc_u32 s13, s31, 0
    s_and_b32 s13, s13, 0xffff
    s_mov_b32 s14, 1105920
    s_mov_b32 s15, 0x20000
    v_lshrrev_b32 v1, 3, v0
    v_and_b32 v2, 7, v0
    s_lshl_b32 s4, s3, 5
    v_add_u32 v3, s4, v1
    v_mul_u32_u24 v3, 1280, v3
    v_lshl_add_u32 v3, v2, 4, v3
    buffer_load_dwordx4 v[8:11], v3, s[8:11], 0 offen offset:0 nt
    buffer_load_dwordx4 v[12:15], v3, s[8:11], 0 offen offset:128 nt
    buffer_load_dwordx4 v[16:19], v3, s[8:11], 0 offen offset:256 nt
    buffer_load_dwordx4 v[20:23], v3, s[8:11], 0 offen offset:384 nt
    buffer_load_dwordx4 v[24:27], v3, s[8:11], 0 offen offset:512 nt
    buffer_load_dwordx4 v[28:31], v3, s[8:11], 0 offen offset:640 nt
    buffer_load_dwordx4 v[32:35], v3, s[8:11], 0 offen offset:768 nt
    buffer_load_dwordx4 v[36:39], v3, s[8:11], 0 offen offset:896 nt
    buffer_load_dwordx4 v[40:43], v3, s[8:11], 0 offen offset:1024 nt
    buffer_load_dwordx4 v[44:47], v3, s[8:11], 0 offen offset:1152 nt
    v_mul_u32_u24 v5, 672, v1
    v_lshl_add_u32 v5, v2, 4, v5
    v_lshrrev_b32 v6, 6, v0
    s_nop 0
    v_readfirstlane_b32 s5, v6
    v_and_b32 v4, 63, v0
    v_lshrrev_b32 v7, 4, v4
    v_bfe_u32 v6, v0, 2, 2
    v_lshl_add_u32 v6, v7, 2, v6
    v_mul_u32_u24 v48, 672, v6
    v_and_b32 v6, 3, v0
    v_lshl_add_u32 v48, v6, 3, v48
    s_mul_i32 s6, s5, 160
    v_add_u32 v48, s6, v48
    v_and_b32 v6, 15, v0
    v_lshlrev_b32 v49, 4, v4
    s_mul_i32 s7, s3, 40960
    s_mul_i32 s6, s5, 5120
    s_add_u32 s7, s7, s6
    s_waitcnt vmcnt(9)
    ds_write_b128 v5, v[8:11] offset:0
    s_waitcnt vmcnt(8)
    ds_write_b128 v5, v[12:15] offset:128
    s_waitcnt vmcnt(7)
    ds_write_b128 v5, v[16:19] offset:256
    s_waitcnt vmcnt(6)
    ds_write_b128 v5, v[20:23] offset:384
    s_waitcnt vmcnt(5)
    ds_write_b128 v5, v[24:27] offset:512
    s_waitcnt lgkmcnt(0)
    s_barrier
    ds_read_b64_tr_b16 v[56:57], v48 offset:0
    ds_read_b64_tr_b16 v[58:59], v48 offset:10752
    ds_read_b64_tr_b16 v[60:61], v48 offset:32
    ds_read_b64_tr_b16 v[62:63], v48 offset:10784
    ds_read_b64_tr_b16 v[64:65], v48 offset:64
    ds_read_b64_tr_b16 v[66:67], v48 offset:10816
    ds_read_b64_tr_b16 v[68:69], v48 offset:96
    ds_read_b64_tr_b16 v[70:71], v48 offset:10848
    ds_read_b64_tr_b16 v[72:73], v48 offset:128
    ds_read_b64_tr_b16 v[74:75], v48 offset:10880
    s_add_u32 s21, s7, 0
    s_waitcnt lgkmcnt(8)
    buffer_store_dwordx4 v[56:59], v49, s[12:15], s21 offen
    s_add_u32 s21, s7, 1024
    s_waitcnt lgkmcnt(6)
    buffer_store_dwordx4 v[60:63], v49, s[12:15], s21 offen
    s_add_u32 s21, s7, 2048
    s_waitcnt lgkmcnt(4)
    buffer_store_dwordx4 v[64:67], v49, s[12:15], s21 offen
    s_add_u32 s21, s7, 3072
    s_waitcnt lgkmcnt(2)
    buffer_store_dwordx4 v[68:71], v49, s[12:15], s21 offen
    s_add_u32 s21, s7, 4096
    s_waitcnt lgkmcnt(0)
    buffer_store_dwordx4 v[72:75], v49, s[12:15], s21 offen
    s_barrier
    s_waitcnt vmcnt(9)
    ds_write_b128 v5, v[28:31] offset:0
    s_waitcnt vmcnt(8)
    ds_write_b128 v5, v[32:35] offset:128
    s_waitcnt vmcnt(7)
    ds_write_b128 v5, v[36:39] offset:256
    s_waitcnt vmcnt(6)
    ds_write_b128 v5, v[40:43] offset:384
    s_waitcnt vmcnt(5)
    ds_write_b128 v5, v[44:47] offset:512
    s_waitcnt lgkmcnt(0)
    s_barrier
    ds_read_b64_tr_b16 v[56:57], v48 offset:0
    ds_read_b64_tr_b16 v[58:59], v48 offset:10752
    ds_read_b64_tr_b16 v[60:61], v48 offset:32
    ds_read_b64_tr_b16 v[62:63], v48 offset:10784
    ds_read_b64_tr_b16 v[64:65], v48 offset:64
    ds_read_b64_tr_b16 v[66:67], v48 offset:10816
    ds_read_b64_tr_b16 v[68:69], v48 offset:96
    ds_read_b64_tr_b16 v[70:71], v48 offset:10848
    ds_read_b64_tr_b16 v[72:73], v48 offset:128
    ds_read_b64_tr_b16 v[74:75], v48 offset:10880
    s_add_u32 s21, s7, 20480
    s_waitcnt lgkmcnt(8)
    buffer_store_dwordx4 v[56:59], v49, s[12:15], s21 offen
    s_add_u32 s21, s7, 21504
    s_waitcnt lgkmcnt(6)
    buffer_store_dwordx4 v[60:63], v49, s[12:15], s21 offen
    s_add_u32 s21, s7, 22528
    s_waitcnt lgkmcnt(4)
    buffer_store_dwordx4 v[64:67], v49, s[12:15], s21 offen
    s_add_u32 s21, s7, 23552
    s_waitcnt lgkmcnt(2)
    buffer_store_dwordx4 v[68:71], v49, s[12:15], s21 offen
    s_add_u32 s21, s7, 24576
    s_waitcnt lgkmcnt(0)
    buffer_store_dwordx4 v[72:75], v49, s[12:15], s21 offen
    s_endpgm
ka_zero:
    s_nop 7
    s_nop 7
    s_waitcnt lgkmcnt(0)
    s_add_u32 s12, s30, 18599936
    s_addc_u32 s13, s31, 0
    s_and_b32 s13, s13, 0xffff
    s_mov_b32 s14, 16384
    s_mov_b32 s15, 0x20000
    s_add_u32 s16, s30, 22163456
    s_addc_u32 s17, s31, 0
    s_and_b32 s17, s17, 0xffff
    s_mov_b32 s18, 20480
    s_mov_b32 s19, 0x20000
    s_setprio 3
    v_mov_b32 v4, 0
    v_mov_b32 v5, 0
    v_mov_b32 v6, 0
    v_mov_b32 v7, 0
    v_lshlrev_b32 v3, 8, v0
    buffer_store_dword v4, v3, s[16:19], 0 offen sc1
    v_lshlrev_b32 v1, 4, v0
    s_waitcnt vmcnt(0)
    s_barrier
    v_cmp_eq_u32 vcc, 0, v0
    s_nop 0
    s_and_saveexec_b64 s[20:21], vcc
    v_mov_b32 v2, 1
    global_store_dword v1, v2, s[34:35] sc1
    s_mov_b64 exec, s[20:21]
    s_add_u32 s24, s30, 22155264
    s_addc_u32 s25, s31, 0
    s_and_b32 s25, s25, 0xffff
    s_mov_b32 s26, 8192
    s_mov_b32 s27, 0x20000
    buffer_store_dwordx4 v[4:7], v1, s[12:15], 0 offen
    buffer_store_dwordx4 v[4:7], v1, s[24:27], 0 offen
    v_add_u32 v1, 4096, v1
    buffer_store_dwordx4 v[4:7], v1, s[12:15], 0 offen
    buffer_store_dwordx4 v[4:7], v1, s[24:27], 0 offen
    v_add_u32 v1, 4096, v1
    buffer_store_dwordx4 v[4:7], v1, s[12:15], 0 offen
    buffer_store_dwordx4 v[4:7], v1, s[24:27], 0 offen
    v_add_u32 v1, 4096, v1
    buffer_store_dwordx4 v[4:7], v1, s[12:15], 0 offen
    buffer_store_dwordx4 v[4:7], v1, s[24:27], 0 offen
    s_endpgm
ka_wprep:
    s_nop 7
    s_nop 7
    s_load_dwordx2 s[32:33], s[0:1], 80
    s_waitcnt lgkmcnt(0)
    s_sub_u32 s3, s2, 904
    s_mul_i32 s4, s3, 2428
    s_lshr_b32 s4, s4, 16
    s_mul_i32 s5, s4, 27
    s_sub_u32 s5, s3, s5
    s_mov_b32 s8, s32
    s_and_b32 s9, s33, 0xffff
    s_mov_b32 s10, 2211840
    s_mov_b32 s11, 0x20000
    s_add_u32 s12, s30, 5279744
    s_addc_u32 s13, s31, 0
    s_and_b32 s13, s13, 0xffff
    s_mov_b32 s14, 245760
    s_mov_b32 s15, 0x20000
    s_add_u32 s16, s30, 6631424
    s_addc_u32 s17, s31, 0
    s_and_b32 s17, s17, 0xffff
    s_mov_b32 s18, 2211840
    s_mov_b32 s19, 0x20000
    s_add_u32 s20, s30, 8843264
    s_addc_u32 s21, s31, 0
    s_and_b32 s21, s21, 0xffff
    s_mov_b32 s22, 55296
    s_mov_b32 s23, 0x20000
    v_lshrrev_b32 v1, 3, v0
    v_and_b32 v2, 7, v0
    s_mul_i32 s6, s4, 160
    v_add_u32 v3, s6, v1
    v_mul_u32_u24 v4, 3456, v3
    v_lshl_add_u32 v4, v2, 4, v4
    s_lshl_b32 s7, s5, 7
    buffer_load_dwordx4 v[8:11], v4, s[8:11], s7 offen nt
    s_add_u32 s7, s7, 110592
    buffer_load_dwordx4 v[12:15], v4, s[8:11], s7 offen nt
    s_add_u32 s7, s7, 110592
    buffer_load_dwordx4 v[16:19], v4, s[8:11], s7 offen nt
    s_add_u32 s7, s7, 110592
    buffer_load_dwordx4 v[20:23], v4, s[8:11], s7 offen nt
    s_add_u32 s7, s7, 110592
    buffer_load_dwordx4 v[24:27], v4, s[8:11], s7 offen nt
    s_waitcnt vmcnt(0) lgkmcnt(0)
    v_lshrrev_b32 v64, 6, v0
    s_nop 0
    v_readfirstlane_b32 s28, v64
    s_nop 0
    s_cmp_lg_u32 s28, 0
    s_cbranch_scc1 ka_prepconv_kernel_polled7
    s_mov_b32 s82, 0
    v_mov_b32 v64, 0
ka_prepconv_kernel_pollc8:
    s_mov_b64 exec, 1
    global_load_dword v65, v64, s[34:35] sc1
    s_mov_b64 exec, -1
    s_waitcnt vmcnt(0)
    v_readfirstlane_b32 s80, v65
    s_add_u32 s82, s82, 1
    s_cmp_ge_u32 s82, 32768
    s_cbranch_scc1 ka_prepconv_kernel_polled7
    s_cmp_eq_u32 s80, 1
    s_cbranch_scc1 ka_prepconv_kernel_pollc8x
    s_sleep 16
    s_branch ka_prepconv_kernel_pollc8
ka_prepconv_kernel_pollc8x:
    s_and_b32 s80, s2, 63
    s_lshl_b32 s80, s80, 8
    s_add_u32 s80, s80, 22167552
    v_mov_b32 v64, s80
ka_prepconv_kernel_poll9:
    s_mov_b64 exec, 1
    global_load_dword v65, v64, s[30:31] sc1
    s_mov_b64 exec, -1
    s_waitcnt vmcnt(0)
    v_readfirstlane_b32 s81, v65
    s_add_u32 s82, s82, 1
    s_cmp_ge_u32 s82, 32768
    s_cbranch_scc1 ka_prepconv_kernel_polled7
    s_cmp_eq_u32 s81, 16
    s_cbranch_scc1 ka_prepconv_kernel_polled7
    s_sleep 4
    s_branch ka_prepconv_kernel_poll9
ka_prepconv_kernel_polled7:
    s_barrier
    v_add_u32 v64, 0, v0
    v_mul_u32_u24 v65, 52429, v64
    v_lshrrev_b32 v65, 22, v65
    v_mul_u32_u24 v66, 80, v65
    v_sub_u32 v66, v64, v66
    v_mul_u32_u24 v65, 15360, v65
    v_lshl_add_u32 v65, v66, 4, v65
    v_cmp_le_u32 vcc, 40, v66
    v_mov_b32 v66, 1920
    s_nop 0
    v_cndmask_b32 v66, 0, v66, vcc
    v_add_u32 v65, v65, v66
    s_lshl_b32 s7, s6, 2
    s_add_u32 s7, s7, 7680
    buffer_load_dwordx4 v[28:31], v65, s[12:15], s7 offen sc1
    v_add_u32 v64, 256, v0
    v_mul_u32_u24 v65, 52429, v64
    v_lshrrev_b32 v65, 22, v65
    v_mul_u32_u24 v66, 80, v65
    v_sub_u32 v66, v64, v66
    v_mul_u32_u24 v65, 15360, v65
    v_lshl_add_u32 v65, v66, 4, v65
    v_cmp_le_u32 vcc, 40, v66
    v_mov_b32 v66, 1920
    s_nop 0
    v_cndmask_b32 v66, 0, v66, vcc
    v_add_u32 v65, v65, v66
    s_lshl_b32 s7, s6, 2
    s_add_u32 s7, s7, 7680
    buffer_load_dwordx4 v[32:35], v65, s[12:15], s7 offen sc1
    v_add_u32 v64, 512, v0
    v_mul_u32_u24 v65, 52429, v64
    v_lshrrev_b32 v65, 22, v65
    v_mul_u32_u24 v66, 80, v65
    v_sub_u32 v66, v64, v66
    v_mul_u32_u24 v65, 15360, v65
    v_lshl_add_u32 v65, v66, 4, v65
    v_cmp_le_u32 vcc, 40, v66
    v_mov_b32 v66, 1920
    s_nop 0
    v_cndmask_b32 v66, 0, v66, vcc
    v_add_u32 v65, v65, v66
    s_lshl_b32 s7, s6, 2
    s_add_u32 s7, s7, 7680
    buffer_load_dwordx4 v[36:39], v65, s[12:15], s7 offen sc1
    v_add_u32 v64, 768, v0
    v_mul_u32_u24 v65, 52429, v64
    v_lshrrev_b32 v65, 22, v65
    v_mul_u32_u24 v66, 80, v65
    v_sub_u32 v66, v64, v66
    v_mul_u32_u24 v65, 15360, v65
    v_lshl_add_u32 v65, v66, 4, v65
    v_cmp_le_u32 vcc, 40, v66
    v_mov_b32 v66, 1920
    s_nop 0
    v_cndmask_b32 v66, 0, v66, vcc
    v_add_u32 v65, v65, v66
    s_lshl_b32 s7, s6, 2
    s_add_u32 s7, s7, 7680
    buffer_load_dwordx4 v[40:43], v65, s[12:15], s7 offen sc1
    v_add_u32 v64, 1024, v0
    v_mul_u32_u24 v65, 52429, v64
    v_lshrrev_b32 v65, 22, v65
    v_mul_u32_u24 v66, 80, v65
    v_sub_u32 v66, v64, v66
    v_mul_u32_u24 v65, 15360, v65
    v_lshl_add_u32 v65, v66, 4, v65
    v_cmp_le_u32 vcc, 40, v66
    v_mov_b32 v66, 1920
    s_nop 0
    v_cndmask_b32 v66, 0, v66, vcc
    v_add_u32 v65, v65, v66
    s_lshl_b32 s7, s6, 2
    s_add_u32 s7, s7, 7680
    buffer_load_dwordx4 v[44:47], v65, s[12:15], s7 offen sc1
    v_lshlrev_b32 v5, 4, v0
    s_waitcnt vmcnt(4)
    ds_write_b128 v5, v[28:31] offset:0
    s_waitcnt vmcnt(3)
    ds_write_b128 v5, v[32:35] offset:4096
    s_waitcnt vmcnt(2)
    ds_write_b128 v5, v[36:39] offset:8192
    s_waitcnt vmcnt(1)
    ds_write_b128 v5, v[40:43] offset:12288
    s_waitcnt vmcnt(0)
    ds_write_b128 v5, v[44:47] offset:16384
    s_waitcnt lgkmcnt(0)
    s_barrier
    v_min_u32 v5, 159, v0
    v_lshlrev_b32 v5, 2, v5
    ds_read_b32 v28, v5 offset:0
    ds_read_b32 v29, v5 offset:1280
    ds_read_b32 v30, v5 offset:2560
    ds_read_b32 v31, v5 offset:3840
    ds_read_b32 v32, v5 offset:5120
    ds_read_b32 v33, v5 offset:6400
    ds_read_b32 v34, v5 offset:7680
    ds_read_b32 v35, v5 offset:8960
    ds_read_b32 v36, v5 offset:10240
    ds_read_b32 v37, v5 offset:11520
    ds_read_b32 v38, v5 offset:12800
    ds_read_b32 v39, v5 offset:14080
    ds_read_b32 v40, v5 offset:15360
    ds_read_b32 v41, v5 offset:16640
    ds_read_b32 v42, v5 offset:17920
    ds_read_b32 v43, v5 offset:19200
    ds_read_b32 v44, v5 offset:640
    ds_read_b32 v45, v5 offset:1920
    ds_read_b32 v46, v5 offset:3200
    ds_read_b32 v47, v5 offset:4480
    ds_read_b32 v48, v5 offset:5760
    ds_read_b32 v49, v5 offset:7040
    ds_read_b32 v50, v5 offset:8320
    ds_read_b32 v51, v5 offset:9600
    ds_read_b32 v52, v5 offset:10880
    ds_read_b32 v53, v5 offset:12160
    ds_read_b32 v54, v5 offset:13440
    ds_read_b32 v55, v5 offset:14720
    ds_read_b32 v56, v5 offset:16000
    ds_read_b32 v57, v5 offset:17280
    ds_read_b32 v58, v5 offset:18560
    ds_read_b32 v59, v5 offset:19840
    s_waitcnt lgkmcnt(15)
    v_add_f32 v28, v28, v36
    v_add_f32 v29, v29, v37
    v_add_f32 v30, v30, v38
    v_add_f32 v31, v31, v39
    v_add_f32 v32, v32, v40
    v_add_f32 v33, v33, v41
    v_add_f32 v34, v34, v42
    v_add_f32 v35, v35, v43
    s_waitcnt lgkmcnt(7)
    v_add_f32 v44, v44, v52
    s_waitcnt lgkmcnt(6)
    v_add_f32 v45, v45, v53
    s_waitcnt lgkmcnt(5)
    v_add_f32 v46, v46, v54
    s_waitcnt lgkmcnt(4)
    v_add_f32 v47, v47, v55
    s_waitcnt lgkmcnt(3)
    v_add_f32 v48, v48, v56
    s_waitcnt lgkmcnt(2)
    v_add_f32 v49, v49, v57
    s_waitcnt lgkmcnt(1)
    v_add_f32 v50, v50, v58
    s_waitcnt lgkmcnt(0)
    v_add_f32 v51, v51, v59
    v_add_f32 v28, v28, v32
    v_add_f32 v29, v29, v33
    v_add_f32 v30, v30, v34
    v_add_f32 v31, v31, v35
    v_add_f32 v44, v44, v48
    v_add_f32 v45, v45, v49
    v_add_f32 v46, v46, v50
    v_add_f32 v47, v47, v51
    v_add_f32 v28, v28, v30
    v_add_f32 v29, v29, v31
    v_add_f32 v44, v44, v46
    v_add_f32 v45, v45, v47
    v_add_f32 v28, v28, v29
    v_add_f32 v44, v44, v45
    v_cvt_pk_bf16_f32 v28, v28, v28
    v_lshlrev_b32 v28, 16, v28
    v_cvt_pk_bf16_f32 v44, v44, v44
    v_lshlrev_b32 v44, 16, v44
    v_add_f32 v44, 1.0, v44
    v_cvt_pk_bf16_f32 v44, v44, v44
    v_lshlrev_b32 v44, 16, v44
    ds_write_b32 v5, v28 offset:25600
    ds_write_b32 v5, v44 offset:26240
    s_waitcnt lgkmcnt(0)
    s_barrier
    v_lshlrev_b32 v5, 2, v1
    ds_read_b32 v28, v5 offset:25600
    ds_read_b32 v30, v5 offset:26240
    ds_read_b32 v32, v5 offset:25728
    ds_read_b32 v34, v5 offset:26368
    ds_read_b32 v36, v5 offset:25856
    ds_read_b32 v38, v5 offset:26496
    ds_read_b32 v40, v5 offset:25984
    ds_read_b32 v42, v5 offset:26624
    ds_read_b32 v44, v5 offset:26112
    ds_read_b32 v46, v5 offset:26752
    s_waitcnt lgkmcnt(0)
    s_barrier
    v_mov_b32 v48, 0
    v_mov_b32 v49, 0
    v_mov_b32 v50, 0
    v_mov_b32 v51, 0
    v_mov_b32 v52, 0
    v_mov_b32 v53, 0
    v_mov_b32 v54, 0
    v_mov_b32 v55, 0
    v_mov_b32 v56, 0
    v_mov_b32 v57, 0
    v_mov_b32 v58, 0
    v_mov_b32 v59, 0
    v_mov_b32 v60, 0
    v_mov_b32 v61, 0
    v_mov_b32 v62, 0
    v_mov_b32 v63, 0
    v_mul_u32_u24 v6, 160, v1
    v_lshl_add_u32 v6, v2, 4, v6
    v_lshlrev_b32 v64, 16, v8
    v_and_b32 v65, 0xffff0000, v8
    v_fmac_f32 v56, v28, v64
    v_fmac_f32 v57, v28, v65
    v_mul_f32 v64, v30, v64
    v_mul_f32 v65, v30, v65
    v_cvt_pk_bf16_f32 v8, v64, v65
    v_lshlrev_b32 v64, 16, v8
    v_and_b32 v65, 0xffff0000, v8
    v_add_f32 v48, v48, v64
    v_add_f32 v49, v49, v65
    v_lshlrev_b32 v66, 16, v9
    v_and_b32 v67, 0xffff0000, v9
    v_fmac_f32 v58, v28, v66
    v_fmac_f32 v59, v28, v67
    v_mul_f32 v66, v30, v66
    v_mul_f32 v67, v30, v67
    v_cvt_pk_bf16_f32 v9, v66, v67
    v_lshlrev_b32 v66, 16, v9
    v_and_b32 v67, 0xffff0000, v9
    v_add_f32 v50, v50, v66
    v_add_f32 v51, v51, v67
    v_lshlrev_b32 v64, 16, v10
    v_and_b32 v65, 0xffff0000, v10
    v_fmac_f32 v60, v28, v64
    v_fmac_f32 v61, v28, v65
    v_mul_f32 v64, v30, v64
    v_mul_f32 v65, v30, v65
    v_cvt_pk_bf16_f32 v10, v64, v65
    v_lshlrev_b32 v64, 16, v10
    v_and_b32 v65, 0xffff0000, v10
    v_add_f32 v52, v52, v64
    v_add_f32 v53, v53, v65
    v_lshlrev_b32 v66, 16, v11
    v_and_b32 v67, 0xffff0000, v11
    v_fmac_f32 v62, v28, v66
    v_fmac_f32 v63, v28, v67
    v_mul_f32 v66, v30, v66
    v_mul_f32 v67, v30, v67
    v_cvt_pk_bf16_f32 v11, v66, v67
    v_lshlrev_b32 v66, 16, v11
    v_and_b32 v67, 0xffff0000, v11
    v_add_f32 v54, v54, v66
    v_add_f32 v55, v55, v67
    ds_write_b128 v6, v[8:11] offset:0
    v_lshlrev_b32 v64, 16, v12
    v_and_b32 v65, 0xffff0000, v12
    v_fmac_f32 v56, v32, v64
    v_fmac_f32 v57, v32, v65
    v_mul_f32 v64, v34, v64
    v_mul_f32 v65, v34, v65
    v_cvt_pk_bf16_f32 v12, v64, v65
    v_lshlrev_b32 v64, 16, v12
    v_and_b32 v65, 0xffff0000, v12
    v_add_f32 v48, v48, v64
    v_add_f32 v49, v49, v65
    v_lshlrev_b32 v66, 16, v13
    v_and_b32 v67, 0xffff0000, v13
    v_fmac_f32 v58, v32, v66
    v_fmac_f32 v59, v32, v67
    v_mul_f32 v66, v34, v66
    v_mul_f32 v67, v34, v67
    v_cvt_pk_bf16_f32 v13, v66, v67
    v_lshlrev_b32 v66, 16, v13
    v_and_b32 v67, 0xffff0000, v13
    v_add_f32 v50, v50, v66
    v_add_f32 v51, v51, v67
    v_lshlrev_b32 v64, 16, v14
    v_and_b32 v65, 0xffff0000, v14
    v_fmac_f32 v60, v32, v64
    v_fmac_f32 v61, v32, v65
    v_mul_f32 v64, v34, v64
    v_mul_f32 v65, v34, v65
    v_cvt_pk_bf16_f32 v14, v64, v65
    v_lshlrev_b32 v64, 16, v14
    v_and_b32 v65, 0xffff0000, v14
    v_add_f32 v52, v52, v64
    v_add_f32 v53, v53, v65
    v_lshlrev_b32 v66, 16, v15
    v_and_b32 v67, 0xffff0000, v15
    v_fmac_f32 v62, v32, v66
    v_fmac_f32 v63, v32, v67
    v_mul_f32 v66, v34, v66
    v_mul_f32 v67, v34, v67
    v_cvt_pk_bf16_f32 v15, v66, v67
    v_lshlrev_b32 v66, 16, v15
    v_and_b32 v67, 0xffff0000, v15
    v_add_f32 v54, v54, v66
    v_add_f32 v55, v55, v67
    ds_write_b128 v6, v[12:15] offset:5120
    v_lshlrev_b32 v64, 16, v16
    v_and_b32 v65, 0xffff0000, v16
    v_fmac_f32 v56, v36, v64
    v_fmac_f32 v57, v36, v65
    v_mul_f32 v64, v38, v64
    v_mul_f32 v65, v38, v65
    v_cvt_pk_bf16_f32 v16, v64, v65
    v_lshlrev_b32 v64, 16, v16
    v_and_b32 v65, 0xffff0000, v16
    v_add_f32 v48, v48, v64
    v_add_f32 v49, v49, v65
    v_lshlrev_b32 v66, 16, v17
    v_and_b32 v67, 0xffff0000, v17
    v_fmac_f32 v58, v36, v66
    v_fmac_f32 v59, v36, v67
    v_mul_f32 v66, v38, v66
    v_mul_f32 v67, v38, v67
    v_cvt_pk_bf16_f32 v17, v66, v67
    v_lshlrev_b32 v66, 16, v17
    v_and_b32 v67, 0xffff0000, v17
    v_add_f32 v50, v50, v66
    v_add_f32 v51, v51, v67
    v_lshlrev_b32 v64, 16, v18
    v_and_b32 v65, 0xffff0000, v18
    v_fmac_f32 v60, v36, v64
    v_fmac_f32 v61, v36, v65
    v_mul_f32 v64, v38, v64
    v_mul_f32 v65, v38, v65
    v_cvt_pk_bf16_f32 v18, v64, v65
    v_lshlrev_b32 v64, 16, v18
    v_and_b32 v65, 0xffff0000, v18
    v_add_f32 v52, v52, v64
    v_add_f32 v53, v53, v65
    v_lshlrev_b32 v66, 16, v19
    v_and_b32 v67, 0xffff0000, v19
    v_fmac_f32 v62, v36, v66
    v_fmac_f32 v63, v36, v67
    v_mul_f32 v66, v38, v66
    v_mul_f32 v67, v38, v67
    v_cvt_pk_bf16_f32 v19, v66, v67
    v_lshlrev_b32 v66, 16, v19
    v_and_b32 v67, 0xffff0000, v19
    v_add_f32 v54, v54, v66
    v_add_f32 v55, v55, v67
    ds_write_b128 v6, v[16:19] offset:10240
    v_lshlrev_b32 v64, 16, v20
    v_and_b32 v65, 0xffff0000, v20
    v_fmac_f32 v56, v40, v64
    v_fmac_f32 v57, v40, v65
    v_mul_f32 v64, v42, v64
    v_mul_f32 v65, v42, v65
    v_cvt_pk_bf16_f32 v20, v64, v65
    v_lshlrev_b32 v64, 16, v20
    v_and_b32 v65, 0xffff0000, v20
    v_add_f32 v48, v48, v64
    v_add_f32 v49, v49, v65
    v_lshlrev_b32 v66, 16, v21
    v_and_b32 v67, 0xffff0000, v21
    v_fmac_f32 v58, v40, v66
    v_fmac_f32 v59, v40, v67
    v_mul_f32 v66, v42, v66
    v_mul_f32 v67, v42, v67
    v_cvt_pk_bf16_f32 v21, v66, v67
    v_lshlrev_b32 v66, 16, v21
    v_and_b32 v67, 0xffff0000, v21
    v_add_f32 v50, v50, v66
    v_add_f32 v51, v51, v67
    v_lshlrev_b32 v64, 16, v22
    v_and_b32 v65, 0xffff0000, v22
    v_fmac_f32 v60, v40, v64
    v_fmac_f32 v61, v40, v65
    v_mul_f32 v64, v42, v64
    v_mul_f32 v65, v42, v65
    v_cvt_pk_bf16_f32 v22, v64, v65
    v_lshlrev_b32 v64, 16, v22
    v_and_b32 v65, 0xffff0000, v22
    v_add_f32 v52, v52, v64
    v_add_f32 v53, v53, v65
    v_lshlrev_b32 v66, 16, v23
    v_and_b32 v67, 0xffff0000, v23
    v_fmac_f32 v62, v40, v66
    v_fmac_f32 v63, v40, v67
    v_mul_f32 v66, v42, v66
    v_mul_f32 v67, v42, v67
    v_cvt_pk_bf16_f32 v23, v66, v67
    v_lshlrev_b32 v66, 16, v23
    v_and_b32 v67, 0xffff0000, v23
    v_add_f32 v54, v54, v66
    v_add_f32 v55, v55, v67
    ds_write_b128 v6, v[20:23] offset:15360
    v_lshlrev_b32 v64, 16, v24
    v_and_b32 v65, 0xffff0000, v24
    v_fmac_f32 v56, v44, v64
    v_fmac_f32 v57, v44, v65
    v_mul_f32 v64, v46, v64
    v_mul_f32 v65, v46, v65
    v_cvt_pk_bf16_f32 v24, v64, v65
    v_lshlrev_b32 v64, 16, v24
    v_and_b32 v65, 0xffff0000, v24
    v_add_f32 v48, v48, v64
    v_add_f32 v49, v49, v65
    v_lshlrev_b32 v66, 16, v25
    v_and_b32 v67, 0xffff0000, v25
    v_fmac_f32 v58, v44, v66
    v_fmac_f32 v59, v44, v67
    v_mul_f32 v66, v46, v66
    v_mul_f32 v67, v46, v67
    v_cvt_pk_bf16_f32 v25, v66, v67
    v_lshlrev_b32 v66, 16, v25
    v_and_b32 v67, 0xffff0000, v25
    v_add_f32 v50, v50, v66
    v_add_f32 v51, v51, v67
    v_lshlrev_b32 v64, 16, v26
    v_and_b32 v65, 0xffff0000, v26
    v_fmac_f32 v60, v44, v64
    v_fmac_f32 v61, v44, v65
    v_mul_f32 v64, v46, v64
    v_mul_f32 v65, v46, v65
    v_cvt_pk_bf16_f32 v26, v64, v65
    v_lshlrev_b32 v64, 16, v26
    v_and_b32 v65, 0xffff0000, v26
    v_add_f32 v52, v52, v64
    v_add_f32 v53, v53, v65
    v_lshlrev_b32 v66, 16, v27
    v_and_b32 v67, 0xffff0000, v27
    v_fmac_f32 v62, v44, v66
    v_fmac_f32 v63, v44, v67
    v_mul_f32 v66, v46, v66
    v_mul_f32 v67, v46, v67
    v_cvt_pk_bf16_f32 v27, v66, v67
    v_lshlrev_b32 v66, 16, v27
    v_and_b32 v67, 0xffff0000, v27
    v_add_f32 v54, v54, v66
    v_add_f32 v55, v55, v67
    ds_write_b128 v6, v[24:27] offset:20480
    v_add_f32_dpp v48, v48, v48 row_ror:8 row_mask:0xf bank_mask:0xf
    v_add_f32_dpp v49, v49, v49 row_ror:8 row_mask:0xf bank_mask:0xf
    v_add_f32_dpp v50, v50, v50 row_ror:8 row_mask:0xf bank_mask:0xf
    v_add_f32_dpp v51, v51, v51 row_ror:8 row_mask:0xf bank_mask:0xf
    v_add_f32_dpp v52, v52, v52 row_ror:8 row_mask:0xf bank_mask:0xf
    v_add_f32_dpp v53, v53, v53 row_ror:8 row_mask:0xf bank_mask:0xf
    v_add_f32_dpp v54, v54, v54 row_ror:8 row_mask:0xf bank_mask:0xf
    v_add_f32_dpp v55, v55, v55 row_ror:8 row_mask:0xf bank_mask:0xf
    v_add_f32_dpp v56, v56, v56 row_ror:8 row_mask:0xf bank_mask:0xf
    v_add_f32_dpp v57, v57, v57 row_ror:8 row_mask:0xf bank_mask:0xf
    v_add_f32_dpp v58, v58, v58 row_ror:8 row_mask:0xf bank_mask:0xf
    v_add_f32_dpp v59, v59, v59 row_ror:8 row_mask:0xf bank_mask:0xf
    v_add_f32_dpp v60, v60, v60 row_ror:8 row_mask:0xf bank_mask:0xf
    v_add_f32_dpp v61, v61, v61 row_ror:8 row_mask:0xf bank_mask:0xf
    v_add_f32_dpp v62, v62, v62 row_ror:8 row_mask:0xf bank_mask:0xf
    v_add_f32_dpp v63, v63, v63 row_ror:8 row_mask:0xf bank_mask:0xf
    v_lshrrev_b32 v7, 4, v0
    v_lshlrev_b32 v7, 9, v7
    v_lshl_add_u32 v7, v2, 5, v7
    ds_write_b128 v7, v[48:51] offset:25600
    ds_write_b128 v7, v[52:55] offset:25616
    ds_write_b128 v7, v[56:59] offset:25856
    ds_write_b128 v7, v[60:63] offset:25872
    v_lshrrev_b32 v5, 6, v0
    s_nop 0
    v_readfirstlane_b32 s24, v5
    v_bfe_u32 v5, v0, 4, 2
    v_bfe_u32 v6, v0, 2, 2
    v_lshl_add_u32 v5, v5, 2, v6
    v_mul_u32_u24 v5, 160, v5
    v_and_b32 v6, 3, v0
    v_lshl_add_u32 v5, v6, 3, v5
    s_lshl_b32 s25, s24, 5
    v_add_u32 v5, s25, v5
    s_waitcnt lgkmcnt(0)
    s_barrier
    ds_read_b64_tr_b16 v[8:9], v5 offset:0
    ds_read_b64_tr_b16 v[10:11], v5 offset:2560
    ds_read_b64_tr_b16 v[12:13], v5 offset:5120
    ds_read_b64_tr_b16 v[14:15], v5 offset:7680
    ds_read_b64_tr_b16 v[16:17], v5 offset:10240
    ds_read_b64_tr_b16 v[18:19], v5 offset:12800
    ds_read_b64_tr_b16 v[20:21], v5 offset:15360
    ds_read_b64_tr_b16 v[22:23], v5 offset:17920
    ds_read_b64_tr_b16 v[24:25], v5 offset:20480
    ds_read_b64_tr_b16 v[26:27], v5 offset:23040
    v_and_b32 v6, 127, v0
    v_lshlrev_b32 v6, 2, v6
    ds_read_b32 v28, v6 offset:25600
    ds_read_b32 v29, v6 offset:26112
    ds_read_b32 v30, v6 offset:26624
    ds_read_b32 v31, v6 offset:27136
    ds_read_b32 v32, v6 offset:27648
    ds_read_b32 v33, v6 offset:28160
    ds_read_b32 v34, v6 offset:28672
    ds_read_b32 v35, v6 offset:29184
    ds_read_b32 v36, v6 offset:29696
    ds_read_b32 v37, v6 offset:30208
    ds_read_b32 v38, v6 offset:30720
    ds_read_b32 v39, v6 offset:31232
    ds_read_b32 v40, v6 offset:31744
    ds_read_b32 v41, v6 offset:32256
    ds_read_b32 v42, v6 offset:32768
    ds_read_b32 v43, v6 offset:33280
    s_lshl_b32 s25, s5, 2
    s_add_u32 s25, s25, s24
    s_mul_i32 s25, s25, 20
    s_mul_i32 s26, s4, 5
    s_add_u32 s25, s25, s26
    s_lshl_b32 s25, s25, 10
    v_and_b32 v7, 63, v0
    v_lshlrev_b32 v7, 4, v7
    s_waitcnt lgkmcnt(15)
    buffer_store_dwordx4 v[8:11], v7, s[16:19], s25 offen offset:0
    buffer_store_dwordx4 v[12:15], v7, s[16:19], s25 offen offset:1024
    buffer_store_dwordx4 v[16:19], v7, s[16:19], s25 offen offset:2048
    buffer_store_dwordx4 v[20:23], v7, s[16:19], s25 offen offset:3072
    s_add_u32 s25, s25, 4096
    buffer_store_dwordx4 v[24:27], v7, s[16:19], s25 offen
    s_waitcnt lgkmcnt(7)
    v_add_f32 v28, v28, v36
    s_waitcnt lgkmcnt(6)
    v_add_f32 v29, v29, v37
    s_waitcnt lgkmcnt(5)
    v_add_f32 v30, v30, v38
    s_waitcnt lgkmcnt(4)
    v_add_f32 v31, v31, v39
    s_waitcnt lgkmcnt(3)
    v_add_f32 v32, v32, v40
    s_waitcnt lgkmcnt(2)
    v_add_f32 v33, v33, v41
    s_waitcnt lgkmcnt(1)
    v_add_f32 v34, v34, v42
    s_waitcnt lgkmcnt(0)
    v_add_f32 v35, v35, v43
    v_add_f32 v28, v28, v32
    v_add_f32 v29, v29, v33
    v_add_f32 v30, v30, v34
    v_add_f32 v31, v31, v35
    v_add_f32 v28, v28, v30
    v_add_f32 v29, v29, v31
    v_add_f32 v28, v28, v29
    v_bfe_u32 v6, v0, 6, 1
    v_mul_u32_u24 v6, 1728, v6
    v_and_b32 v7, 63, v0
    v_add_u32 v6, v6, v7
    v_lshlrev_b32 v6, 2, v6
    s_mul_i32 s25, s4, 13824
    s_lshl_b32 s26, s5, 8
    s_add_u32 s25, s25, s26
    v_cmp_gt_u32 vcc, 128, v0
    s_nop 0
    s_and_saveexec_b64 s[26:27], vcc
    buffer_store_dword v28, v6, s[20:23], s25 offen
    s_endpgm
ka_conv:
    s_nop 7
    s_nop 7
    s_load_dwordx8 s[8:15], s[0:1], 8
    s_load_dwordx8 s[16:23], s[0:1], 40
    s_load_dwordx2 s[36:37], s[0:1], 88
    s_waitcnt lgkmcnt(0)
    s_sub_u32 s3, s2, 264
    s_and_b32 s4, s3, 7
    s_mul_i32 s4, s4, 80
    s_lshr_b32 s5, s3, 3
    s_add_u32 s4, s4, s5
    v_bfe_u32 v2, v0, 4, 2
    v_lshrrev_b32 v3, 6, v0
    v_lshlrev_b32 v4, 5, v3
    v_lshl_add_u32 v4, v2, 2, v4
    v_bfe_u32 v1, v0, 2, 1
    v_lshl_add_u32 v4, v1, 4, v4
    v_and_b32 v1, 3, v0
    v_add_u32 v4, v4, v1
    v_lshlrev_b32 v4, 1, v4
    s_lshl_b32 s5, s4, 8
    v_add_u32 v4, s5, v4
    s_mov_b32 exec_lo, 0x00ff00ff
    s_mov_b32 exec_hi, 0x00ff00ff
    global_load_ushort v8, v4, s[8:9] nt
    global_load_ushort v9, v4, s[10:11] nt
    global_load_ushort v10, v4, s[12:13] nt
    global_load_ushort v11, v4, s[14:15] nt
    global_load_ushort v12, v4, s[16:17] nt
    global_load_ushort v13, v4, s[18:19] nt
    s_mov_b64 exec, -1
    s_lshr_b32 s5, s4, 1
    s_lshl_b32 s5, s5, 2
    s_load_dword s6, s[20:21], s5
    s_load_dword s24, s[22:23], s5
    s_mov_b32 s56, s30
    s_and_b32 s57, s31, 0xffff
    s_mov_b32 s58, 2621440
    s_mov_b32 s59, 0x20000
    s_add_u32 s60, s30, 2621440
    s_addc_u32 s61, s31, 0
    s_and_b32 s61, s61, 0xffff
    s_mov_b32 s62, 16384
    s_mov_b32 s63, 0x20000
    s_add_u32 s64, s30, 5279744
    s_addc_u32 s65, s31, 0
    s_and_b32 s65, s65, 0xffff
    s_mov_b32 s66, 245760
    s_mov_b32 s67, 0x20000
    v_readfirstlane_b32 s7, v3
    s_mov_b32 s25, 0xffff0000
    v_and_b32 v5, 15, v0
    v_cvt_f32_u32 v5, v5
    v_lshlrev_b32 v16, 4, v0
    v_sub_u32 v16, 4094, v16
    v_cvt_f32_u32 v16, v16
    v_mov_b32 v18, 0x46860000
    v_subrev_f32 v68, 0x00000000, v16
    v_subrev_f32 v69, 0x40000000, v16
    v_cvt_pk_bf16_f32 v17, v68, v69
    v_lshlrev_b32 v68, 16, v17
    v_and_b32 v69, s25, v17
    v_fmamk_f32 v17, v68, 0x3e800000, v18
    v_add_f32 v68, 0x46800000, v68
    v_min_f32 v68, v68, v17
    v_cvt_u32_f32 v68, v68
    v_fmamk_f32 v17, v69, 0x3e800000, v18
    v_add_f32 v69, 0x46800000, v69
    v_min_f32 v69, v69, v17
    v_cvt_u32_f32 v69, v69
    v_subrev_f32 v70, 0x40800000, v16
    v_subrev_f32 v71, 0x40c00000, v16
    v_cvt_pk_bf16_f32 v17, v70, v71
    v_lshlrev_b32 v70, 16, v17
    v_and_b32 v71, s25, v17
    v_fmamk_f32 v17, v70, 0x3e800000, v18
    v_add_f32 v70, 0x46800000, v70
    v_min_f32 v70, v70, v17
    v_cvt_u32_f32 v70, v70
    v_fmamk_f32 v17, v71, 0x3e800000, v18
    v_add_f32 v71, 0x46800000, v71
    v_min_f32 v71, v71, v17
    v_cvt_u32_f32 v71, v71
    v_subrev_f32 v72, 0x41000000, v16
    v_subrev_f32 v73, 0x41200000, v16
    v_cvt_pk_bf16_f32 v17, v72, v73
    v_lshlrev_b32 v72, 16, v17
    v_and_b32 v73, s25, v17
    v_fmamk_f32 v17, v72, 0x3e800000, v18
    v_add_f32 v72, 0x46800000, v72
    v_min_f32 v72, v72, v17
    v_cvt_u32_f32 v72, v72
    v_fmamk_f32 v17, v73, 0x3e800000, v18
    v_add_f32 v73, 0x46800000, v73
    v_min_f32 v73, v73, v17
    v_cvt_u32_f32 v73, v73
    v_subrev_f32 v74, 0x41400000, v16
    v_subrev_f32 v75, 0x41600000, v16
    v_cvt_pk_bf16_f32 v17, v74, v75
    v_lshlrev_b32 v74, 16, v17
    v_and_b32 v75, s25, v17
    v_fmamk_f32 v17, v74, 0x3e800000, v18
    v_add_f32 v74, 0x46800000, v74
    v_min_f32 v74, v74, v17
    v_cvt_u32_f32 v74, v74
    v_fmamk_f32 v17, v75, 0x3e800000, v18
    v_add_f32 v75, 0x46800000, v75
    v_min_f32 v75, v75, v17
    v_cvt_u32_f32 v75, v75
    s_waitcnt lgkmcnt(0)
    s_bitcmp1_b32 s4, 0
    s_cselect_b32 s5, 0, 16
    s_lshl_b32 s6, s6, s5
    s_and_b32 s6, s6, 0xffff0000
    s_lshl_b32 s24, s24, s5
    s_and_b32 s24, s24, 0xffff0000
    v_mov_b32 v6, s6
    v_mul_f32 v16, 0x3fb8aa3b, v6
    s_mov_b32 s26, 0x3fb8aa3b
    v_fma_f32 v17, v6, s26, -v16
    v_fmamk_f32 v17, v6, 0x32a57060, v17
    v_exp_f32 v7, v16
    v_mul_f32 v17, 0x3f317218, v17
    v_fmac_f32 v7, v7, v17
    v_cvt_pk_bf16_f32 v7, v7, v7
    v_lshlrev_b32 v7, 16, v7
    v_mul_f32 v6, v7, v5
    v_mul_f32 v5, 0x3fb8aa3b, v6
    v_mul_f32 v6, 0x3e22f983, v6
    s_waitcnt vmcnt(5)
    v_lshlrev_b32 v8, 16, v8
    s_waitcnt vmcnt(4)
    v_lshlrev_b32 v9, 16, v9
    s_waitcnt vmcnt(3)
    v_lshlrev_b32 v10, 16, v10
    s_waitcnt vmcnt(2)
    v_lshlrev_b32 v11, 16, v11
    s_waitcnt vmcnt(1)
    v_lshlrev_b32 v12, 16, v12
    s_waitcnt vmcnt(0)
    v_lshlrev_b32 v13, 16, v13
    v_mul_f32 v14, v12, v10
    v_mul_f32 v15, v12, v11
    v_fma_f32 v14, -v13, v11, v14
    v_fmac_f32 v15, v13, v10
    v_mul_f32 v14, v7, v14
    v_mul_f32 v15, v7, v15
    v_mul_f32_dpp v40, v8, v5 row_newbcast:0 row_mask:0xf bank_mask:0xf
    v_mul_f32_dpp v54, v8, v5 row_newbcast:1 row_mask:0xf bank_mask:0xf
    v_mul_f32_dpp v41, v9, v6 row_newbcast:0 row_mask:0xf bank_mask:0xf
    v_mul_f32_dpp v55, v9, v6 row_newbcast:1 row_mask:0xf bank_mask:0xf
    v_mov_b64_dpp v[46:47], v[14:15] row_newbcast:0 row_mask:0xf bank_mask:0xf
    v_mov_b64_dpp v[60:61], v[14:15] row_newbcast:1 row_mask:0xf bank_mask:0xf
    v_fract_f32 v41, v41
    v_fract_f32 v55, v55
    v_exp_f32 v40, v40
    v_exp_f32 v54, v54
    v_sin_f32 v43, v41
    v_sin_f32 v57, v55
    v_cos_f32 v42, v41
    v_cos_f32 v56, v55
    v_pk_mul_f32 v[42:43], v[42:43], v[40:41] op_sel:[0,0] op_sel_hi:[1,0]
    v_pk_mul_f32 v[56:57], v[56:57], v[54:55] op_sel:[0,0] op_sel_hi:[1,0]
    v_pk_mul_f32 v[44:45], v[42:43], v[42:43] op_sel:[0,0] op_sel_hi:[0,1]
    v_pk_mul_f32 v[58:59], v[56:57], v[56:57] op_sel:[0,0] op_sel_hi:[0,1]
    v_pk_fma_f32 v[44:45], v[42:43], v[42:43], v[44:45] op_sel:[1,1,0] op_sel_hi:[0,1,1] neg_lo:[1,0,0]
    v_pk_fma_f32 v[58:59], v[56:57], v[56:57], v[58:59] op_sel:[1,1,0] op_sel_hi:[0,1,1] neg_lo:[1,0,0]
    v_pk_mul_f32 v[48:49], v[42:43], v[46:47] op_sel:[0,0] op_sel_hi:[0,1]
    v_pk_mul_f32 v[62:63], v[56:57], v[60:61] op_sel:[0,0] op_sel_hi:[0,1]
    v_pk_fma_f32 v[48:49], v[42:43], v[46:47], v[48:49] op_sel:[1,1,0] op_sel_hi:[1,0,1] neg_lo:[1,0,0]
    v_pk_fma_f32 v[62:63], v[56:57], v[60:61], v[62:63] op_sel:[1,1,0] op_sel_hi:[1,0,1] neg_lo:[1,0,0]
    v_pk_mul_f32 v[40:41], v[44:45], v[44:45] op_sel:[0,0] op_sel_hi:[0,1]
    v_pk_mul_f32 v[54:55], v[58:59], v[58:59] op_sel:[0,0] op_sel_hi:[0,1]
    v_pk_fma_f32 v[40:41], v[44:45], v[44:45], v[40:41] op_sel:[1,1,0] op_sel_hi:[0,1,1] neg_lo:[1,0,0]
    v_pk_fma_f32 v[54:55], v[58:59], v[58:59], v[54:55] op_sel:[1,1,0] op_sel_hi:[0,1,1] neg_lo:[1,0,0]
    v_cvt_pk_bf16_f32 v16, v48, v49
    v_cvt_pk_bf16_f32 v17, v62, v63
    v_pk_mul_f32 v[44:45], v[40:41], v[40:41] op_sel:[0,0] op_sel_hi:[0,1]
    v_pk_mul_f32 v[58:59], v[54:55], v[54:55] op_sel:[0,0] op_sel_hi:[0,1]
    v_pk_fma_f32 v[44:45], v[40:41], v[40:41], v[44:45] op_sel:[1,1,0] op_sel_hi:[0,1,1] neg_lo:[1,0,0]
    v_pk_fma_f32 v[58:59], v[54:55], v[54:55], v[58:59] op_sel:[1,1,0] op_sel_hi:[0,1,1] neg_lo:[1,0,0]
    v_pk_mul_f32 v[48:49], v[40:41], v[46:47] op_sel:[0,0] op_sel_hi:[0,1]
    v_pk_mul_f32 v[62:63], v[54:55], v[60:61] op_sel:[0,0] op_sel_hi:[0,1]
    v_pk_fma_f32 v[48:49], v[40:41], v[46:47], v[48:49] op_sel:[1,1,0] op_sel_hi:[1,0,1] neg_lo:[1,0,0]
    v_pk_fma_f32 v[62:63], v[54:55], v[60:61], v[62:63] op_sel:[1,1,0] op_sel_hi:[1,0,1] neg_lo:[1,0,0]
    v_pk_mul_f32 v[42:43], v[44:45], v[44:45] op_sel:[0,0] op_sel_hi:[0,1]
    v_pk_mul_f32 v[56:57], v[58:59], v[58:59] op_sel:[0,0] op_sel_hi:[0,1]
    v_pk_fma_f32 v[42:43], v[44:45], v[44:45], v[42:43] op_sel:[1,1,0] op_sel_hi:[0,1,1] neg_lo:[1,0,0]
    v_pk_fma_f32 v[56:57], v[58:59], v[58:59], v[56:57] op_sel:[1,1,0] op_sel_hi:[0,1,1] neg_lo:[1,0,0]
    v_cvt_pk_bf16_f32 v20, v48, v49
    v_cvt_pk_bf16_f32 v21, v62, v63
    v_pk_mul_f32 v[44:45], v[42:43], v[42:43] op_sel:[0,0] op_sel_hi:[0,1]
    v_pk_mul_f32 v[58:59], v[56:57], v[56:57] op_sel:[0,0] op_sel_hi:[0,1]
    v_pk_fma_f32 v[44:45], v[42:43], v[42:43], v[44:45] op_sel:[1,1,0] op_sel_hi:[0,1,1] neg_lo:[1,0,0]
    v_pk_fma_f32 v[58:59], v[56:57], v[56:57], v[58:59] op_sel:[1,1,0] op_sel_hi:[0,1,1] neg_lo:[1,0,0]
    v_pk_mul_f32 v[40:41], v[44:45], v[44:45] op_sel:[0,0] op_sel_hi:[0,1]
    v_pk_mul_f32 v[54:55], v[58:59], v[58:59] op_sel:[0,0] op_sel_hi:[0,1]
    v_pk_fma_f32 v[40:41], v[44:45], v[44:45], v[40:41] op_sel:[1,1,0] op_sel_hi:[0,1,1] neg_lo:[1,0,0]
    v_pk_fma_f32 v[54:55], v[58:59], v[58:59], v[54:55] op_sel:[1,1,0] op_sel_hi:[0,1,1] neg_lo:[1,0,0]
    v_cvt_pk_bf16_f32 v24, v42, -v43
    v_cvt_pk_bf16_f32 v25, v56, -v57
    v_mov_b64_dpp v[46:47], v[40:41] row_newbcast:8 row_mask:0xf bank_mask:0xf
    v_mov_b64_dpp v[60:61], v[54:55] row_newbcast:8 row_mask:0xf bank_mask:0xf
    v_mov_b64_dpp v[44:45], v[40:41] row_newbcast:4 row_mask:0xf bank_mask:0xf
    v_mov_b64_dpp v[58:59], v[54:55] row_newbcast:4 row_mask:0xf bank_mask:0xf
    v_pk_mul_f32 v[50:51], v[40:41], v[46:47] op_sel:[0,0] op_sel_hi:[0,1]
    v_pk_mul_f32 v[64:65], v[54:55], v[60:61] op_sel:[0,0] op_sel_hi:[0,1]
    v_pk_fma_f32 v[50:51], v[40:41], v[46:47], v[50:51] op_sel:[1,1,0] op_sel_hi:[1,0,1] neg_lo:[1,0,0]
    v_pk_fma_f32 v[64:65], v[54:55], v[60:61], v[64:65] op_sel:[1,1,0] op_sel_hi:[1,0,1] neg_lo:[1,0,0]
    v_pk_mul_f32 v[48:49], v[42:43], v[44:45] op_sel:[0,0] op_sel_hi:[0,1]
    v_pk_mul_f32 v[62:63], v[56:57], v[58:59] op_sel:[0,0] op_sel_hi:[0,1]
    v_pk_fma_f32 v[48:49], v[42:43], v[44:45], v[48:49] op_sel:[1,1,0] op_sel_hi:[1,0,1] neg_lo:[1,0,0]
    v_pk_fma_f32 v[62:63], v[56:57], v[58:59], v[62:63] op_sel:[1,1,0] op_sel_hi:[1,0,1] neg_lo:[1,0,0]
    v_mov_b64_dpp v[46:47], v[50:51] row_newbcast:8 row_mask:0xf bank_mask:0xf
    v_mov_b64_dpp v[60:61], v[64:65] row_newbcast:8 row_mask:0xf bank_mask:0xf
    v_cvt_pk_bf16_f32 v32, v50, -v51
    v_cvt_pk_bf16_f32 v33, v64, -v65
    v_pk_mul_f32 v[52:53], v[50:51], v[46:47] op_sel:[0,0] op_sel_hi:[0,1]
    v_pk_mul_f32 v[66:67], v[64:65], v[60:61] op_sel:[0,0] op_sel_hi:[0,1]
    v_pk_fma_f32 v[52:53], v[50:51], v[46:47], v[52:53] op_sel:[1,1,0] op_sel_hi:[1,0,1] neg_lo:[1,0,0]
    v_pk_fma_f32 v[66:67], v[64:65], v[60:61], v[66:67] op_sel:[1,1,0] op_sel_hi:[1,0,1] neg_lo:[1,0,0]
    v_cvt_pk_bf16_f32 v28, v48, -v49
    v_cvt_pk_bf16_f32 v29, v62, -v63
    v_cvt_pk_bf16_f32 v36, v52, -v53
    v_cvt_pk_bf16_f32 v37, v66, -v67
    v_mul_f32_dpp v40, v8, v5 row_newbcast:2 row_mask:0xf bank_mask:0xf
    v_mul_f32_dpp v54, v8, v5 row_newbcast:3 row_mask:0xf bank_mask:0xf
    v_mul_f32_dpp v41, v9, v6 row_newbcast:2 row_mask:0xf bank_mask:0xf
    v_mul_f32_dpp v55, v9, v6 row_newbcast:3 row_mask:0xf bank_mask:0xf
    v_mov_b64_dpp v[46:47], v[14:15] row_newbcast:2 row_mask:0xf bank_mask:0xf
    v_mov_b64_dpp v[60:61], v[14:15] row_newbcast:3 row_mask:0xf bank_mask:0xf
    v_fract_f32 v41, v41
    v_fract_f32 v55, v55
    v_exp_f32 v40, v40
    v_exp_f32 v54, v54
    v_sin_f32 v43, v41
    v_sin_f32 v57, v55
    v_cos_f32 v42, v41
    v_cos_f32 v56, v55
    v_pk_mul_f32 v[42:43], v[42:43], v[40:41] op_sel:[0,0] op_sel_hi:[1,0]
    v_pk_mul_f32 v[56:57], v[56:57], v[54:55] op_sel:[0,0] op_sel_hi:[1,0]
    v_pk_mul_f32 v[44:45], v[42:43], v[42:43] op_sel:[0,0] op_sel_hi:[0,1]
    v_pk_mul_f32 v[58:59], v[56:57], v[56:57] op_sel:[0,0] op_sel_hi:[0,1]
    v_pk_fma_f32 v[44:45], v[42:43], v[42:43], v[44:45] op_sel:[1,1,0] op_sel_hi:[0,1,1] neg_lo:[1,0,0]
    v_pk_fma_f32 v[58:59], v[56:57], v[56:57], v[58:59] op_sel:[1,1,0] op_sel_hi:[0,1,1] neg_lo:[1,0,0]
    v_pk_mul_f32 v[48:49], v[42:43], v[46:47] op_sel:[0,0] op_sel_hi:[0,1]
    v_pk_mul_f32 v[62:63], v[56:57], v[60:61] op_sel:[0,0] op_sel_hi:[0,1]
    v_pk_fma_f32 v[48:49], v[42:43], v[46:47], v[48:49] op_sel:[1,1,0] op_sel_hi:[1,0,1] neg_lo:[1,0,0]
    v_pk_fma_f32 v[62:63], v[56:57], v[60:61], v[62:63] op_sel:[1,1,0] op_sel_hi:[1,0,1] neg_lo:[1,0,0]
    v_pk_mul_f32 v[40:41], v[44:45], v[44:45] op_sel:[0,0] op_sel_hi:[0,1]
    v_pk_mul_f32 v[54:55], v[58:59], v[58:59] op_sel:[0,0] op_sel_hi:[0,1]
    v_pk_fma_f32 v[40:41], v[44:45], v[44:45], v[40:41] op_sel:[1,1,0] op_sel_hi:[0,1,1] neg_lo:[1,0,0]
    v_pk_fma_f32 v[54:55], v[58:59], v[58:59], v[54:55] op_sel:[1,1,0] op_sel_hi:[0,1,1] neg_lo:[1,0,0]
    v_cvt_pk_bf16_f32 v18, v48, v49
    v_cvt_pk_bf16_f32 v19, v62, v63
    v_pk_mul_f32 v[44:45], v[40:41], v[40:41] op_sel:[0,0] op_sel_hi:[0,1]
    v_pk_mul_f32 v[58:59], v[54:55], v[54:55] op_sel:[0,0] op_sel_hi:[0,1]
    v_pk_fma_f32 v[44:45], v[40:41], v[40:41], v[44:45] op_sel:[1,1,0] op_sel_hi:[0,1,1] neg_lo:[1,0,0]
    v_pk_fma_f32 v[58:59], v[54:55], v[54:55], v[58:59] op_sel:[1,1,0] op_sel_hi:[0,1,1] neg_lo:[1,0,0]
    v_pk_mul_f32 v[48:49], v[40:41], v[46:47] op_sel:[0,0] op_sel_hi:[0,1]
    v_pk_mul_f32 v[62:63], v[54:55], v[60:61] op_sel:[0,0] op_sel_hi:[0,1]
    v_pk_fma_f32 v[48:49], v[40:41], v[46:47], v[48:49] op_sel:[1,1,0] op_sel_hi:[1,0,1] neg_lo:[1,0,0]
    v_pk_fma_f32 v[62:63], v[54:55], v[60:61], v[62:63] op_sel:[1,1,0] op_sel_hi:[1,0,1] neg_lo:[1,0,0]
    v_pk_mul_f32 v[42:43], v[44:45], v[44:45] op_sel:[0,0] op_sel_hi:[0,1]
    v_pk_mul_f32 v[56:57], v[58:59], v[58:59] op_sel:[0,0] op_sel_hi:[0,1]
    v_pk_fma_f32 v[42:43], v[44:45], v[44:45], v[42:43] op_sel:[1,1,0] op_sel_hi:[0,1,1] neg_lo:[1,0,0]
    v_pk_fma_f32 v[56:57], v[58:59], v[58:59], v[56:57] op_sel:[1,1,0] op_sel_hi:[0,1,1] neg_lo:[1,0,0]
    v_cvt_pk_bf16_f32 v22, v48, v49
    v_cvt_pk_bf16_f32 v23, v62, v63
    v_pk_mul_f32 v[44:45], v[42:43], v[42:43] op_sel:[0,0] op_sel_hi:[0,1]
    v_pk_mul_f32 v[58:59], v[56:57], v[56:57] op_sel:[0,0] op_sel_hi:[0,1]
    v_pk_fma_f32 v[44:45], v[42:43], v[42:43], v[44:45] op_sel:[1,1,0] op_sel_hi:[0,1,1] neg_lo:[1,0,0]
    v_pk_fma_f32 v[58:59], v[56:57], v[56:57], v[58:59] op_sel:[1,1,0] op_sel_hi:[0,1,1] neg_lo:[1,0,0]
    v_pk_mul_f32 v[40:41], v[44:45], v[44:45] op_sel:[0,0] op_sel_hi:[0,1]
    v_pk_mul_f32 v[54:55], v[58:59], v[58:59] op_sel:[0,0] op_sel_hi:[0,1]
    v_pk_fma_f32 v[40:41], v[44:45], v[44:45], v[40:41] op_sel:[1,1,0] op_sel_hi:[0,1,1] neg_lo:[1,0,0]
    v_pk_fma_f32 v[54:55], v[58:59], v[58:59], v[54:55] op_sel:[1,1,0] op_sel_hi:[0,1,1] neg_lo:[1,0,0]
    v_cvt_pk_bf16_f32 v26, v42, -v43
    v_cvt_pk_bf16_f32 v27, v56, -v57
    v_mov_b64_dpp v[46:47], v[40:41] row_newbcast:8 row_mask:0xf bank_mask:0xf
    v_mov_b64_dpp v[60:61], v[54:55] row_newbcast:8 row_mask:0xf bank_mask:0xf
    v_mov_b64_dpp v[44:45], v[40:41] row_newbcast:4 row_mask:0xf bank_mask:0xf
    v_mov_b64_dpp v[58:59], v[54:55] row_newbcast:4 row_mask:0xf bank_mask:0xf
    v_pk_mul_f32 v[50:51], v[40:41], v[46:47] op_sel:[0,0] op_sel_hi:[0,1]
    v_pk_mul_f32 v[64:65], v[54:55], v[60:61] op_sel:[0,0] op_sel_hi:[0,1]
    v_pk_fma_f32 v[50:51], v[40:41], v[46:47], v[50:51] op_sel:[1,1,0] op_sel_hi:[1,0,1] neg_lo:[1,0,0]
    v_pk_fma_f32 v[64:65], v[54:55], v[60:61], v[64:65] op_sel:[1,1,0] op_sel_hi:[1,0,1] neg_lo:[1,0,0]
    v_pk_mul_f32 v[48:49], v[42:43], v[44:45] op_sel:[0,0] op_sel_hi:[0,1]
    v_pk_mul_f32 v[62:63], v[56:57], v[58:59] op_sel:[0,0] op_sel_hi:[0,1]
    v_pk_fma_f32 v[48:49], v[42:43], v[44:45], v[48:49] op_sel:[1,1,0] op_sel_hi:[1,0,1] neg_lo:[1,0,0]
    v_pk_fma_f32 v[62:63], v[56:57], v[58:59], v[62:63] op_sel:[1,1,0] op_sel_hi:[1,0,1] neg_lo:[1,0,0]
    v_mov_b64_dpp v[46:47], v[50:51] row_newbcast:8 row_mask:0xf bank_mask:0xf
    v_mov_b64_dpp v[60:61], v[64:65] row_newbcast:8 row_mask:0xf bank_mask:0xf
    v_cvt_pk_bf16_f32 v34, v50, -v51
    v_cvt_pk_bf16_f32 v35, v64, -v65
    v_pk_mul_f32 v[52:53], v[50:51], v[46:47] op_sel:[0,0] op_sel_hi:[0,1]
    v_pk_mul_f32 v[66:67], v[64:65], v[60:61] op_sel:[0,0] op_sel_hi:[0,1]
    v_pk_fma_f32 v[52:53], v[50:51], v[46:47], v[52:53] op_sel:[1,1,0] op_sel_hi:[1,0,1] neg_lo:[1,0,0]
    v_pk_fma_f32 v[66:67], v[64:65], v[60:61], v[66:67] op_sel:[1,1,0] op_sel_hi:[1,0,1] neg_lo:[1,0,0]
    v_cvt_pk_bf16_f32 v30, v48, -v49
    v_cvt_pk_bf16_f32 v31, v62, -v63
    v_cvt_pk_bf16_f32 v38, v52, -v53
    v_cvt_pk_bf16_f32 v39, v66, -v67
    v_mfma_f32_16x16x32_bf16 a[0:3], v[16:19], v[24:27], 0
    v_mfma_f32_16x16x32_bf16 a[4:7], v[16:19], v[28:31], 0
    v_mfma_f32_16x16x32_bf16 a[8:11], v[20:23], v[32:35], 0
    v_mfma_f32_16x16x32_bf16 a[12:15], v[20:23], v[36:39], 0
    v_mul_f32_dpp v40, v8, v5 row_newbcast:4 row_mask:0xf bank_mask:0xf
    v_mul_f32_dpp v54, v8, v5 row_newbcast:5 row_mask:0xf bank_mask:0xf
    v_mul_f32_dpp v41, v9, v6 row_newbcast:4 row_mask:0xf bank_mask:0xf
    v_mul_f32_dpp v55, v9, v6 row_newbcast:5 row_mask:0xf bank_mask:0xf
    v_mov_b64_dpp v[46:47], v[14:15] row_newbcast:4 row_mask:0xf bank_mask:0xf
    v_mov_b64_dpp v[60:61], v[14:15] row_newbcast:5 row_mask:0xf bank_mask:0xf
    v_fract_f32 v41, v41
    v_fract_f32 v55, v55
    v_exp_f32 v40, v40
    v_exp_f32 v54, v54
    v_sin_f32 v43, v41
    v_sin_f32 v57, v55
    v_cos_f32 v42, v41
    v_cos_f32 v56, v55
    v_pk_mul_f32 v[42:43], v[42:43], v[40:41] op_sel:[0,0] op_sel_hi:[1,0]
    v_pk_mul_f32 v[56:57], v[56:57], v[54:55] op_sel:[0,0] op_sel_hi:[1,0]
    v_pk_mul_f32 v[44:45], v[42:43], v[42:43] op_sel:[0,0] op_sel_hi:[0,1]
    v_pk_mul_f32 v[58:59], v[56:57], v[56:57] op_sel:[0,0] op_sel_hi:[0,1]
    v_pk_fma_f32 v[44:45], v[42:43], v[42:43], v[44:45] op_sel:[1,1,0] op_sel_hi:[0,1,1] neg_lo:[1,0,0]
    v_pk_fma_f32 v[58:59], v[56:57], v[56:57], v[58:59] op_sel:[1,1,0] op_sel_hi:[0,1,1] neg_lo:[1,0,0]
    v_pk_mul_f32 v[48:49], v[42:43], v[46:47] op_sel:[0,0] op_sel_hi:[0,1]
    v_pk_mul_f32 v[62:63], v[56:57], v[60:61] op_sel:[0,0] op_sel_hi:[0,1]
    v_pk_fma_f32 v[48:49], v[42:43], v[46:47], v[48:49] op_sel:[1,1,0] op_sel_hi:[1,0,1] neg_lo:[1,0,0]
    v_pk_fma_f32 v[62:63], v[56:57], v[60:61], v[62:63] op_sel:[1,1,0] op_sel_hi:[1,0,1] neg_lo:[1,0,0]
    v_pk_mul_f32 v[40:41], v[44:45], v[44:45] op_sel:[0,0] op_sel_hi:[0,1]
    v_pk_mul_f32 v[54:55], v[58:59], v[58:59] op_sel:[0,0] op_sel_hi:[0,1]
    v_pk_fma_f32 v[40:41], v[44:45], v[44:45], v[40:41] op_sel:[1,1,0] op_sel_hi:[0,1,1] neg_lo:[1,0,0]
    v_pk_fma_f32 v[54:55], v[58:59], v[58:59], v[54:55] op_sel:[1,1,0] op_sel_hi:[0,1,1] neg_lo:[1,0,0]
    v_cvt_pk_bf16_f32 v16, v48, v49
    v_cvt_pk_bf16_f32 v17, v62, v63
    v_pk_mul_f32 v[44:45], v[40:41], v[40:41] op_sel:[0,0] op_sel_hi:[0,1]
    v_pk_mul_f32 v[58:59], v[54:55], v[54:55] op_sel:[0,0] op_sel_hi:[0,1]
    v_pk_fma_f32 v[44:45], v[40:41], v[40:41], v[44:45] op_sel:[1,1,0] op_sel_hi:[0,1,1] neg_lo:[1,0,0]
    v_pk_fma_f32 v[58:59], v[54:55], v[54:55], v[58:59] op_sel:[1,1,0] op_sel_hi:[0,1,1] neg_lo:[1,0,0]
    v_pk_mul_f32 v[48:49], v[40:41], v[46:47] op_sel:[0,0] op_sel_hi:[0,1]
    v_pk_mul_f32 v[62:63], v[54:55], v[60:61] op_sel:[0,0] op_sel_hi:[0,1]
    v_pk_fma_f32 v[48:49], v[40:41], v[46:47], v[48:49] op_sel:[1,1,0] op_sel_hi:[1,0,1] neg_lo:[1,0,0]
    v_pk_fma_f32 v[62:63], v[54:55], v[60:61], v[62:63] op_sel:[1,1,0] op_sel_hi:[1,0,1] neg_lo:[1,0,0]
    v_pk_mul_f32 v[42:43], v[44:45], v[44:45] op_sel:[0,0] op_sel_hi:[0,1]
    v_pk_mul_f32 v[56:57], v[58:59], v[58:59] op_sel:[0,0] op_sel_hi:[0,1]
    v_pk_fma_f32 v[42:43], v[44:45], v[44:45], v[42:43] op_sel:[1,1,0] op_sel_hi:[0,1,1] neg_lo:[1,0,0]
    v_pk_fma_f32 v[56:57], v[58:59], v[58:59], v[56:57] op_sel:[1,1,0] op_sel_hi:[0,1,1] neg_lo:[1,0,0]
    v_cvt_pk_bf16_f32 v20, v48, v49
    v_cvt_pk_bf16_f32 v21, v62, v63
    v_pk_mul_f32 v[44:45], v[42:43], v[42:43] op_sel:[0,0] op_sel_hi:[0,1]
    v_pk_mul_f32 v[58:59], v[56:57], v[56:57] op_sel:[0,0] op_sel_hi:[0,1]
    v_pk_fma_f32 v[44:45], v[42:43], v[42:43], v[44:45] op_sel:[1,1,0] op_sel_hi:[0,1,1] neg_lo:[1,0,0]
    v_pk_fma_f32 v[58:59], v[56:57], v[56:57], v[58:59] op_sel:[1,1,0] op_sel_hi:[0,1,1] neg_lo:[1,0,0]
    v_pk_mul_f32 v[40:41], v[44:45], v[44:45] op_sel:[0,0] op_sel_hi:[0,1]
    v_pk_mul_f32 v[54:55], v[58:59], v[58:59] op_sel:[0,0] op_sel_hi:[0,1]
    v_pk_fma_f32 v[40:41], v[44:45], v[44:45], v[40:41] op_sel:[1,1,0] op_sel_hi:[0,1,1] neg_lo:[1,0,0]
    v_pk_fma_f32 v[54:55], v[58:59], v[58:59], v[54:55] op_sel:[1,1,0] op_sel_hi:[0,1,1] neg_lo:[1,0,0]
    v_cvt_pk_bf16_f32 v24, v42, -v43
    v_cvt_pk_bf16_f32 v25, v56, -v57
    v_mov_b64_dpp v[46:47], v[40:41] row_newbcast:8 row_mask:0xf bank_mask:0xf
    v_mov_b64_dpp v[60:61], v[54:55] row_newbcast:8 row_mask:0xf bank_mask:0xf
    v_mov_b64_dpp v[44:45], v[40:41] row_newbcast:4 row_mask:0xf bank_mask:0xf
    v_mov_b64_dpp v[58:59], v[54:55] row_newbcast:4 row_mask:0xf bank_mask:0xf
    v_pk_mul_f32 v[50:51], v[40:41], v[46:47] op_sel:[0,0] op_sel_hi:[0,1]
    v_pk_mul_f32 v[64:65], v[54:55], v[60:61] op_sel:[0,0] op_sel_hi:[0,1]
    v_pk_fma_f32 v[50:51], v[40:41], v[46:47], v[50:51] op_sel:[1,1,0] op_sel_hi:[1,0,1] neg_lo:[1,0,0]
    v_pk_fma_f32 v[64:65], v[54:55], v[60:61], v[64:65] op_sel:[1,1,0] op_sel_hi:[1,0,1] neg_lo:[1,0,0]
    v_pk_mul_f32 v[48:49], v[42:43], v[44:45] op_sel:[0,0] op_sel_hi:[0,1]
    v_pk_mul_f32 v[62:63], v[56:57], v[58:59] op_sel:[0,0] op_sel_hi:[0,1]
    v_pk_fma_f32 v[48:49], v[42:43], v[44:45], v[48:49] op_sel:[1,1,0] op_sel_hi:[1,0,1] neg_lo:[1,0,0]
    v_pk_fma_f32 v[62:63], v[56:57], v[58:59], v[62:63] op_sel:[1,1,0] op_sel_hi:[1,0,1] neg_lo:[1,0,0]
    v_mov_b64_dpp v[46:47], v[50:51] row_newbcast:8 row_mask:0xf bank_mask:0xf
    v_mov_b64_dpp v[60:61], v[64:65] row_newbcast:8 row_mask:0xf bank_mask:0xf
    v_cvt_pk_bf16_f32 v32, v50, -v51
    v_cvt_pk_bf16_f32 v33, v64, -v65
    v_pk_mul_f32 v[52:53], v[50:51], v[46:47] op_sel:[0,0] op_sel_hi:[0,1]
    v_pk_mul_f32 v[66:67], v[64:65], v[60:61] op_sel:[0,0] op_sel_hi:[0,1]
    v_pk_fma_f32 v[52:53], v[50:51], v[46:47], v[52:53] op_sel:[1,1,0] op_sel_hi:[1,0,1] neg_lo:[1,0,0]
    v_pk_fma_f32 v[66:67], v[64:65], v[60:61], v[66:67] op_sel:[1,1,0] op_sel_hi:[1,0,1] neg_lo:[1,0,0]
    v_cvt_pk_bf16_f32 v28, v48, -v49
    v_cvt_pk_bf16_f32 v29, v62, -v63
    v_cvt_pk_bf16_f32 v36, v52, -v53
    v_cvt_pk_bf16_f32 v37, v66, -v67
    v_mul_f32_dpp v40, v8, v5 row_newbcast:6 row_mask:0xf bank_mask:0xf
    v_mul_f32_dpp v54, v8, v5 row_newbcast:7 row_mask:0xf bank_mask:0xf
    v_mul_f32_dpp v41, v9, v6 row_newbcast:6 row_mask:0xf bank_mask:0xf
    v_mul_f32_dpp v55, v9, v6 row_newbcast:7 row_mask:0xf bank_mask:0xf
    v_mov_b64_dpp v[46:47], v[14:15] row_newbcast:6 row_mask:0xf bank_mask:0xf
    v_mov_b64_dpp v[60:61], v[14:15] row_newbcast:7 row_mask:0xf bank_mask:0xf
    v_fract_f32 v41, v41
    v_fract_f32 v55, v55
    v_exp_f32 v40, v40
    v_exp_f32 v54, v54
    v_sin_f32 v43, v41
    v_sin_f32 v57, v55
    v_cos_f32 v42, v41
    v_cos_f32 v56, v55
    v_pk_mul_f32 v[42:43], v[42:43], v[40:41] op_sel:[0,0] op_sel_hi:[1,0]
    v_pk_mul_f32 v[56:57], v[56:57], v[54:55] op_sel:[0,0] op_sel_hi:[1,0]
    v_pk_mul_f32 v[44:45], v[42:43], v[42:43] op_sel:[0,0] op_sel_hi:[0,1]
    v_pk_mul_f32 v[58:59], v[56:57], v[56:57] op_sel:[0,0] op_sel_hi:[0,1]
    v_pk_fma_f32 v[44:45], v[42:43], v[42:43], v[44:45] op_sel:[1,1,0] op_sel_hi:[0,1,1] neg_lo:[1,0,0]
    v_pk_fma_f32 v[58:59], v[56:57], v[56:57], v[58:59] op_sel:[1,1,0] op_sel_hi:[0,1,1] neg_lo:[1,0,0]
    v_pk_mul_f32 v[48:49], v[42:43], v[46:47] op_sel:[0,0] op_sel_hi:[0,1]
    v_pk_mul_f32 v[62:63], v[56:57], v[60:61] op_sel:[0,0] op_sel_hi:[0,1]
    v_pk_fma_f32 v[48:49], v[42:43], v[46:47], v[48:49] op_sel:[1,1,0] op_sel_hi:[1,0,1] neg_lo:[1,0,0]
    v_pk_fma_f32 v[62:63], v[56:57], v[60:61], v[62:63] op_sel:[1,1,0] op_sel_hi:[1,0,1] neg_lo:[1,0,0]
    v_pk_mul_f32 v[40:41], v[44:45], v[44:45] op_sel:[0,0] op_sel_hi:[0,1]
    v_pk_mul_f32 v[54:55], v[58:59], v[58:59] op_sel:[0,0] op_sel_hi:[0,1]
    v_pk_fma_f32 v[40:41], v[44:45], v[44:45], v[40:41] op_sel:[1,1,0] op_sel_hi:[0,1,1] neg_lo:[1,0,0]
    v_pk_fma_f32 v[54:55], v[58:59], v[58:59], v[54:55] op_sel:[1,1,0] op_sel_hi:[0,1,1] neg_lo:[1,0,0]
    v_cvt_pk_bf16_f32 v18, v48, v49
    v_cvt_pk_bf16_f32 v19, v62, v63
    v_pk_mul_f32 v[44:45], v[40:41], v[40:41] op_sel:[0,0] op_sel_hi:[0,1]
    v_pk_mul_f32 v[58:59], v[54:55], v[54:55] op_sel:[0,0] op_sel_hi:[0,1]
    v_pk_fma_f32 v[44:45], v[40:41], v[40:41], v[44:45] op_sel:[1,1,0] op_sel_hi:[0,1,1] neg_lo:[1,0,0]
    v_pk_fma_f32 v[58:59], v[54:55], v[54:55], v[58:59] op_sel:[1,1,0] op_sel_hi:[0,1,1] neg_lo:[1,0,0]
    v_pk_mul_f32 v[48:49], v[40:41], v[46:47] op_sel:[0,0] op_sel_hi:[0,1]
    v_pk_mul_f32 v[62:63], v[54:55], v[60:61] op_sel:[0,0] op_sel_hi:[0,1]
    v_pk_fma_f32 v[48:49], v[40:41], v[46:47], v[48:49] op_sel:[1,1,0] op_sel_hi:[1,0,1] neg_lo:[1,0,0]
    v_pk_fma_f32 v[62:63], v[54:55], v[60:61], v[62:63] op_sel:[1,1,0] op_sel_hi:[1,0,1] neg_lo:[1,0,0]
    v_pk_mul_f32 v[42:43], v[44:45], v[44:45] op_sel:[0,0] op_sel_hi:[0,1]
    v_pk_mul_f32 v[56:57], v[58:59], v[58:59] op_sel:[0,0] op_sel_hi:[0,1]
    v_pk_fma_f32 v[42:43], v[44:45], v[44:45], v[42:43] op_sel:[1,1,0] op_sel_hi:[0,1,1] neg_lo:[1,0,0]
    v_pk_fma_f32 v[56:57], v[58:59], v[58:59], v[56:57] op_sel:[1,1,0] op_sel_hi:[0,1,1] neg_lo:[1,0,0]
    v_cvt_pk_bf16_f32 v22, v48, v49
    v_cvt_pk_bf16_f32 v23, v62, v63
    v_pk_mul_f32 v[44:45], v[42:43], v[42:43] op_sel:[0,0] op_sel_hi:[0,1]
    v_pk_mul_f32 v[58:59], v[56:57], v[56:57] op_sel:[0,0] op_sel_hi:[0,1]
    v_pk_fma_f32 v[44:45], v[42:43], v[42:43], v[44:45] op_sel:[1,1,0] op_sel_hi:[0,1,1] neg_lo:[1,0,0]
    v_pk_fma_f32 v[58:59], v[56:57], v[56:57], v[58:59] op_sel:[1,1,0] op_sel_hi:[0,1,1] neg_lo:[1,0,0]
    v_pk_mul_f32 v[40:41], v[44:45], v[44:45] op_sel:[0,0] op_sel_hi:[0,1]
    v_pk_mul_f32 v[54:55], v[58:59], v[58:59] op_sel:[0,0] op_sel_hi:[0,1]
    v_pk_fma_f32 v[40:41], v[44:45], v[44:45], v[40:41] op_sel:[1,1,0] op_sel_hi:[0,1,1] neg_lo:[1,0,0]
    v_pk_fma_f32 v[54:55], v[58:59], v[58:59], v[54:55] op_sel:[1,1,0] op_sel_hi:[0,1,1] neg_lo:[1,0,0]
    v_cvt_pk_bf16_f32 v26, v42, -v43
    v_cvt_pk_bf16_f32 v27, v56, -v57
    v_mov_b64_dpp v[46:47], v[40:41] row_newbcast:8 row_mask:0xf bank_mask:0xf
    v_mov_b64_dpp v[60:61], v[54:55] row_newbcast:8 row_mask:0xf bank_mask:0xf
    v_mov_b64_dpp v[44:45], v[40:41] row_newbcast:4 row_mask:0xf bank_mask:0xf
    v_mov_b64_dpp v[58:59], v[54:55] row_newbcast:4 row_mask:0xf bank_mask:0xf
    v_pk_mul_f32 v[50:51], v[40:41], v[46:47] op_sel:[0,0] op_sel_hi:[0,1]
    v_pk_mul_f32 v[64:65], v[54:55], v[60:61] op_sel:[0,0] op_sel_hi:[0,1]
    v_pk_fma_f32 v[50:51], v[40:41], v[46:47], v[50:51] op_sel:[1,1,0] op_sel_hi:[1,0,1] neg_lo:[1,0,0]
    v_pk_fma_f32 v[64:65], v[54:55], v[60:61], v[64:65] op_sel:[1,1,0] op_sel_hi:[1,0,1] neg_lo:[1,0,0]
    v_pk_mul_f32 v[48:49], v[42:43], v[44:45] op_sel:[0,0] op_sel_hi:[0,1]
    v_pk_mul_f32 v[62:63], v[56:57], v[58:59] op_sel:[0,0] op_sel_hi:[0,1]
    v_pk_fma_f32 v[48:49], v[42:43], v[44:45], v[48:49] op_sel:[1,1,0] op_sel_hi:[1,0,1] neg_lo:[1,0,0]
    v_pk_fma_f32 v[62:63], v[56:57], v[58:59], v[62:63] op_sel:[1,1,0] op_sel_hi:[1,0,1] neg_lo:[1,0,0]
    v_mov_b64_dpp v[46:47], v[50:51] row_newbcast:8 row_mask:0xf bank_mask:0xf
    v_mov_b64_dpp v[60:61], v[64:65] row_newbcast:8 row_mask:0xf bank_mask:0xf
    v_cvt_pk_bf16_f32 v34, v50, -v51
    v_cvt_pk_bf16_f32 v35, v64, -v65
    v_pk_mul_f32 v[52:53], v[50:51], v[46:47] op_sel:[0,0] op_sel_hi:[0,1]
    v_pk_mul_f32 v[66:67], v[64:65], v[60:61] op_sel:[0,0] op_sel_hi:[0,1]
    v_pk_fma_f32 v[52:53], v[50:51], v[46:47], v[52:53] op_sel:[1,1,0] op_sel_hi:[1,0,1] neg_lo:[1,0,0]
    v_pk_fma_f32 v[66:67], v[64:65], v[60:61], v[66:67] op_sel:[1,1,0] op_sel_hi:[1,0,1] neg_lo:[1,0,0]
    v_cvt_pk_bf16_f32 v30, v48, -v49
    v_cvt_pk_bf16_f32 v31, v62, -v63
    v_cvt_pk_bf16_f32 v38, v52, -v53
    v_cvt_pk_bf16_f32 v39, v66, -v67
    v_mfma_f32_16x16x32_bf16 a[0:3], v[16:19], v[24:27], a[0:3]
    v_mfma_f32_16x16x32_bf16 a[4:7], v[16:19], v[28:31], a[4:7]
    v_mfma_f32_16x16x32_bf16 a[8:11], v[20:23], v[32:35], a[8:11]
    v_mfma_f32_16x16x32_bf16 a[12:15], v[20:23], v[36:39], a[12:15]
    s_add_u32 s20, s30, 8900608
    s_addc_u32 s21, s31, 0
    s_and_b32 s21, s21, 0xffff
    s_mov_b32 s22, 2621440
    s_mov_b32 s23, 0x20000
    v_and_b32 v4, 15, v0
    v_lshlrev_b32 v4, 6, v4
    v_lshl_add_u32 v4, v2, 4, v4
    v_lshl_add_u32 v4, v3, 12, v4
    v_lshlrev_b32 v5, 4, v0
    ds_write_b128 v4, a[0:3] offset:0
    ds_write_b128 v4, a[4:7] offset:1024
    ds_write_b128 v4, a[8:11] offset:2048
    ds_write_b128 v4, a[12:15] offset:3072
    s_waitcnt lgkmcnt(0)
    s_barrier
    ds_read_b128 v[8:11], v5 offset:0
    ds_read_b128 v[12:15], v5 offset:4096
    ds_read_b128 v[16:19], v5 offset:8192
    ds_read_b128 v[20:23], v5 offset:12288
    s_waitcnt lgkmcnt(2)
    v_add_f32 v8, v8, v12
    s_waitcnt lgkmcnt(0)
    v_add_f32 v16, v16, v20
    v_add_f32 v9, v9, v13
    v_add_f32 v17, v17, v21
    v_add_f32 v10, v10, v14
    v_add_f32 v18, v18, v22
    v_add_f32 v11, v11, v15
    v_add_f32 v19, v19, v23
    v_add_f32 v8, v8, v16
    v_add_f32 v9, v9, v17
    v_add_f32 v10, v10, v18
    v_add_f32 v11, v11, v19
    v_cvt_pk_bf16_f32 v12, v8, v9
    v_cvt_pk_bf16_f32 v13, v10, v11
    v_lshlrev_b32 v4, 3, v0
    ds_write_b64 v4, v[12:13] offset:16384
    v_mov_b32 v28, 0
    v_mov_b32 v29, 0
    v_mov_b32 v30, 0
    v_mov_b32 v31, 0
    s_waitcnt lgkmcnt(0)
    s_barrier
    ds_read_u16 v8, v68
    ds_read_u16 v9, v69
    ds_read_u16 v10, v70
    ds_read_u16 v11, v71
    ds_read_u16 v12, v72
    ds_read_u16 v13, v73
    ds_read_u16 v14, v74
    ds_read_u16 v15, v75
    s_waitcnt lgkmcnt(6)
    v_lshl_or_b32 v16, v9, 16, v8
    s_waitcnt lgkmcnt(4)
    v_lshl_or_b32 v17, v11, 16, v10
    s_waitcnt lgkmcnt(2)
    v_lshl_or_b32 v18, v13, 16, v12
    s_waitcnt lgkmcnt(0)
    v_lshl_or_b32 v19, v15, 16, v14
    ds_write_b128 v5, v[16:19] offset:33776
    v_cmp_eq_u32 vcc, 0, v0
    s_nop 0
    s_and_saveexec_b64 s[26:27], vcc
    ds_write_b128 v5, v[28:31] offset:37872
    s_mov_b64 exec, s[26:27]
    s_waitcnt lgkmcnt(0)
    s_barrier
    ds_read_b128 v[20:23], v5 offset:33792
    v_cmp_gt_u32 vcc, 32, v0
    s_nop 0
    s_and_saveexec_b64 s[26:27], vcc
    ds_write_b128 v5, v[28:31] offset:33280
    v_cmp_gt_u32 vcc, 8, v0
    s_nop 0
    s_and_b64 exec, exec, vcc
    v_mul_u32_u24 v4, 4160, v0
    ds_write_b128 v4, v[28:31] offset:4096
    s_mov_b64 exec, s[26:27]
    v_and_b32 v4, 7, v0
    v_mul_u32_u24 v1, 4160, v4
    v_bfe_u32 v4, v0, 4, 2
    v_lshl_add_u32 v1, v4, 4, v1
    v_lshlrev_b32 v2, 4, v4
    v_bfe_u32 v4, v0, 3, 1
    v_lshlrev_b32 v4, 4, v4
    v_sub_u32 v1, v1, v4
    s_lshl_b32 s26, s7, 7
    s_sub_u32 s27, 400, s26
    v_add_u32 v1, s27, v1
    v_and_b32 v4, 15, v0
    v_lshl_add_u32 v2, v4, 5, v2
    s_sub_u32 s27, 33696, s26
    v_add_u32 v2, s27, v2
    v_alignbit_b32 v32, v17, v16, 16
    v_alignbit_b32 v33, v18, v17, 16
    v_alignbit_b32 v34, v19, v18, 16
    s_waitcnt lgkmcnt(2)
    v_alignbit_b32 v35, v20, v19, 16
    v_alignbit_b32 v36, v21, v20, 16
    v_alignbit_b32 v37, v22, v21, 16
    v_alignbit_b32 v38, v18, v17, 16
    v_alignbit_b32 v39, v19, v18, 16
    v_alignbit_b32 v40, v20, v19, 16
    v_alignbit_b32 v41, v21, v20, 16
    v_alignbit_b32 v42, v22, v21, 16
    v_alignbit_b32 v43, v23, v22, 16
    v_mov_b32 v44, v17
    v_mov_b32 v45, v18
    v_mov_b32 v46, v19
    v_mov_b32 v47, v20
    v_mov_b32 v48, v21
    v_mov_b32 v49, v22
    ds_write_b128 v5, v[40:43] offset:0
    ds_write_b128 v5, v[46:49] offset:4160
    ds_write_b128 v5, v[34:37] offset:8320
    ds_write_b128 v5, v[18:21] offset:12480
    ds_write_b128 v5, v[38:41] offset:16640
    ds_write_b128 v5, v[44:47] offset:20800
    ds_write_b128 v5, v[32:35] offset:24960
    ds_write_b128 v5, v[16:19] offset:29120
    s_waitcnt lgkmcnt(0)
    s_cmp_lg_u32 s7, 0
    s_cbranch_scc1 ka_prepconv_kernel_polled10
    s_mov_b32 s82, 0
    v_mov_b32 v8, 0
ka_prepconv_kernel_pollc11:
    s_mov_b64 exec, 1
    global_load_dword v9, v8, s[34:35] sc1
    s_mov_b64 exec, -1
    s_waitcnt vmcnt(0)
    v_readfirstlane_b32 s80, v9
    s_add_u32 s82, s82, 1
    s_cmp_ge_u32 s82, 32768
    s_cbranch_scc1 ka_prepconv_kernel_polled10
    s_cmp_eq_u32 s80, 1
    s_cbranch_scc1 ka_prepconv_kernel_pollc11x
    s_sleep 16
    s_branch ka_prepconv_kernel_pollc11
ka_prepconv_kernel_pollc11x:
    s_and_b32 s80, s2, 63
    s_lshl_b32 s80, s80, 8
    s_add_u32 s80, s80, 22167552
    v_mov_b32 v8, s80
ka_prepconv_kernel_poll12:
    s_mov_b64 exec, 1
    global_load_dword v9, v8, s[30:31] sc1
    s_mov_b64 exec, -1
    s_waitcnt vmcnt(0)
    v_readfirstlane_b32 s81, v9
    s_add_u32 s82, s82, 1
    s_cmp_ge_u32 s82, 32768
    s_cbranch_scc1 ka_prepconv_kernel_polled10
    s_cmp_eq_u32 s81, 16
    s_cbranch_scc1 ka_prepconv_kernel_polled10
    s_sleep 4
    s_branch ka_prepconv_kernel_poll12
ka_prepconv_kernel_polled10:
    s_barrier
    s_lshr_b32 s5, s4, 2
    s_lshl_b32 s5, s5, 14
    s_and_b32 s26, s4, 3
    s_lshl_b32 s26, s26, 4
    s_add_u32 s5, s5, s26
    v_and_b32 v8, 15, v0
    v_mul_u32_u24 v8, 15360, v8
    v_bfe_u32 v9, v0, 4, 2
    v_mul_u32_u24 v9, 2560, v9
    v_add_u32 v8, v8, v9
    s_lshl_b32 s26, s4, 2
    s_mov_b32 exec_hi, 0xffff
    buffer_load_dword v68, v8, s[64:67], s26 offen sc1
    s_mov_b32 exec_hi, -1
    v_lshlrev_b32 v9, 6, v0
    buffer_load_dwordx4 v[92:95], v9, s[56:59], s5 offen sc1
    s_mov_b32 s26, 0
    buffer_load_dwordx4 v[76:79], v5, s[60:63], s26 offen sc1
    s_mov_b32 s26, 4096
    buffer_load_dwordx4 v[80:83], v5, s[60:63], s26 offen sc1
    s_mov_b32 s26, 8192
    buffer_load_dwordx4 v[84:87], v5, s[60:63], s26 offen sc1
    s_mov_b32 s26, 12288
    buffer_load_dwordx4 v[88:91], v5, s[60:63], s26 offen sc1
    s_waitcnt vmcnt(5)
    v_add_f32_dpp v68, v68, v68 quad_perm:[1,0,3,2] row_mask:0xf bank_mask:0xf
    s_nop 1
    v_add_f32_dpp v68, v68, v68 quad_perm:[2,3,0,1] row_mask:0xf bank_mask:0xf
    s_nop 1
    v_add_f32_dpp v68, v68, v68 row_half_mirror row_mask:0xf bank_mask:0xf
    s_nop 1
    v_add_f32_dpp v68, v68, v68 row_mirror row_mask:0xf bank_mask:0xf
    v_cvt_pk_bf16_f32 v68, v68, v68
    v_lshlrev_b32 v68, 16, v68
    v_add_f32 v69, 1.0, v68
    v_cvt_pk_bf16_f32 v69, v69, v69
    v_lshlrev_b32 v69, 16, v69
    v_readlane_b32 s52, v68, 0
    v_readlane_b32 s53, v69, 16
    v_readlane_b32 s54, v68, 32
    v_mov_b32 v68, s52
    v_mov_b32 v69, s53
    v_mov_b32 v70, s54
    s_waitcnt vmcnt(4)
    v_lshlrev_b32 v8, 16, v92
    v_and_b32 v9, s25, v92
    s_waitcnt vmcnt(3)
    v_fma_f32 v8, v8, v76, v77
    v_fma_f32 v9, v9, v78, v79
    v_fma_f32 v8, v8, v69, v68
    v_fma_f32 v9, v9, v69, v68
    v_cvt_pk_bf16_f32 v72, v8, v9
    v_lshlrev_b32 v10, 16, v93
    v_and_b32 v11, s25, v93
    s_waitcnt vmcnt(2)
    v_fma_f32 v10, v10, v80, v81
    v_fma_f32 v11, v11, v82, v83
    v_fma_f32 v10, v10, v69, v68
    v_fma_f32 v11, v11, v69, v68
    v_cvt_pk_bf16_f32 v73, v10, v11
    v_lshlrev_b32 v8, 16, v94
    v_and_b32 v9, s25, v94
    s_waitcnt vmcnt(1)
    v_fma_f32 v8, v8, v84, v85
    v_fma_f32 v9, v9, v86, v87
    v_fma_f32 v8, v8, v69, v68
    v_fma_f32 v9, v9, v69, v68
    v_cvt_pk_bf16_f32 v74, v8, v9
    v_lshlrev_b32 v10, 16, v95
    v_and_b32 v11, s25, v95
    s_waitcnt vmcnt(0)
    v_fma_f32 v10, v10, v88, v89
    v_fma_f32 v11, v11, v90, v91
    v_fma_f32 v10, v10, v69, v68
    v_fma_f32 v11, v11, v69, v68
    v_cvt_pk_bf16_f32 v75, v10, v11
    ds_write_b128 v5, v[72:75] offset:33792
    s_waitcnt lgkmcnt(0)
    s_barrier
    s_mov_b32 s44, s36
    s_and_b32 s45, s37, 0xffff
    s_mov_b32 s46, 8388608
    s_mov_b32 s47, 0x20000
    s_lshl_b32 s6, s3, 14
    v_lshlrev_b32 v85, 6, v0
    buffer_load_dword v84, v85, s[44:47], s6 offen
    ds_read_b128 v[8:11], v1 offset:3648
    ds_read_b128 v[40:43], v2 offset:64
    ds_read_b128 v[36:39], v1 offset:64
    ds_read_b128 v[68:71], v2 offset:3648
    ds_read_b128 v[12:15], v1 offset:3136
    ds_read_b128 v[44:47], v2 offset:576
    ds_read_b128 v[32:35], v1 offset:576
    ds_read_b128 v[64:67], v2 offset:3136
    ds_read_b128 v[16:19], v1 offset:2624
    ds_read_b128 v[48:51], v2 offset:1088
    ds_read_b128 v[28:31], v1 offset:1088
    ds_read_b128 v[60:63], v2 offset:2624
    ds_read_b128 v[20:23], v1 offset:2112
    ds_read_b128 v[52:55], v2 offset:1600
    ds_read_b128 v[24:27], v1 offset:1600
    ds_read_b128 v[56:59], v2 offset:2112
    s_waitcnt lgkmcnt(13)
    v_mfma_f32_16x16x32_bf16 a[28:31], v[36:39], v[40:43], 0
    s_waitcnt lgkmcnt(12)
    v_mfma_f32_16x16x32_bf16 a[28:31], v[8:11], v[68:71], a[28:31]
    ds_read_b128 v[36:39], v1 offset:0
    ds_read_b128 v[68:71], v2 offset:3584
    s_waitcnt lgkmcnt(11)
    v_mfma_f32_16x16x32_bf16 a[24:27], v[32:35], v[40:43], 0
    v_mfma_f32_16x16x32_bf16 a[28:31], v[32:35], v[44:47], a[28:31]
    s_waitcnt lgkmcnt(10)
    v_mfma_f32_16x16x32_bf16 a[24:27], v[8:11], v[64:67], a[24:27]
    v_mfma_f32_16x16x32_bf16 a[28:31], v[12:15], v[64:67], a[28:31]
    ds_read_b128 v[32:35], v1 offset:512
    ds_read_b128 v[64:67], v2 offset:3072
    s_waitcnt lgkmcnt(9)
    v_mfma_f32_16x16x32_bf16 a[20:23], v[28:31], v[40:43], 0
    v_mfma_f32_16x16x32_bf16 a[24:27], v[28:31], v[44:47], a[24:27]
    v_mfma_f32_16x16x32_bf16 a[28:31], v[28:31], v[48:51], a[28:31]
    s_waitcnt lgkmcnt(8)
    v_mfma_f32_16x16x32_bf16 a[20:23], v[8:11], v[60:63], a[20:23]
    v_mfma_f32_16x16x32_bf16 a[24:27], v[12:15], v[60:63], a[24:27]
    v_mfma_f32_16x16x32_bf16 a[28:31], v[16:19], v[60:63], a[28:31]
    ds_read_b128 v[28:31], v1 offset:1024
    ds_read_b128 v[60:63], v2 offset:2560
    s_waitcnt lgkmcnt(7)
    v_mfma_f32_16x16x32_bf16 a[16:19], v[24:27], v[40:43], 0
    v_mfma_f32_16x16x32_bf16 a[20:23], v[24:27], v[44:47], a[20:23]
    v_mfma_f32_16x16x32_bf16 a[24:27], v[24:27], v[48:51], a[24:27]
    v_mfma_f32_16x16x32_bf16 a[28:31], v[24:27], v[52:55], a[28:31]
    s_waitcnt lgkmcnt(6)
    v_mfma_f32_16x16x32_bf16 a[16:19], v[8:11], v[56:59], a[16:19]
    v_mfma_f32_16x16x32_bf16 a[20:23], v[12:15], v[56:59], a[20:23]
    v_mfma_f32_16x16x32_bf16 a[24:27], v[16:19], v[56:59], a[24:27]
    v_mfma_f32_16x16x32_bf16 a[28:31], v[20:23], v[56:59], a[28:31]
    ds_read_b128 v[24:27], v1 offset:1536
    ds_read_b128 v[56:59], v2 offset:2048
    v_mfma_f32_16x16x32_bf16 a[12:15], v[20:23], v[40:43], 0
    v_mfma_f32_16x16x32_bf16 a[16:19], v[20:23], v[44:47], a[16:19]
    v_mfma_f32_16x16x32_bf16 a[20:23], v[20:23], v[48:51], a[20:23]
    v_mfma_f32_16x16x32_bf16 a[24:27], v[20:23], v[52:55], a[24:27]
    v_mfma_f32_16x16x32_bf16 a[12:15], v[8:11], v[52:55], a[12:15]
    v_mfma_f32_16x16x32_bf16 a[16:19], v[12:15], v[52:55], a[16:19]
    v_mfma_f32_16x16x32_bf16 a[20:23], v[16:19], v[52:55], a[20:23]
    ds_read_b128 v[20:23], v1 offset:2048
    ds_read_b128 v[52:55], v2 offset:1536
    v_mfma_f32_16x16x32_bf16 a[8:11], v[16:19], v[40:43], 0
    v_mfma_f32_16x16x32_bf16 a[12:15], v[16:19], v[44:47], a[12:15]
    v_mfma_f32_16x16x32_bf16 a[16:19], v[16:19], v[48:51], a[16:19]
    v_mfma_f32_16x16x32_bf16 a[8:11], v[8:11], v[48:51], a[8:11]
    v_mfma_f32_16x16x32_bf16 a[12:15], v[12:15], v[48:51], a[12:15]
    ds_read_b128 v[16:19], v1 offset:2560
    ds_read_b128 v[48:51], v2 offset:1024
    v_mfma_f32_16x16x32_bf16 a[4:7], v[12:15], v[40:43], 0
    v_mfma_f32_16x16x32_bf16 a[8:11], v[12:15], v[44:47], a[8:11]
    v_mfma_f32_16x16x32_bf16 a[4:7], v[8:11], v[44:47], a[4:7]
    ds_read_b128 v[12:15], v1 offset:3072
    ds_read_b128 v[44:47], v2 offset:512
    v_mfma_f32_16x16x32_bf16 a[0:3], v[8:11], v[40:43], 0
    ds_read_b128 v[8:11], v1 offset:3584
    ds_read_b128 v[40:43], v2 offset:0
    s_waitcnt lgkmcnt(7)
    v_mfma_f32_16x16x32_bf16 a[28:31], v[20:23], v[56:59], a[28:31]
    s_waitcnt lgkmcnt(6)
    v_mfma_f32_16x16x32_bf16 a[24:27], v[20:23], v[52:55], a[24:27]
    v_mfma_f32_16x16x32_bf16 a[28:31], v[24:27], v[52:55], a[28:31]
    s_waitcnt lgkmcnt(5)
    v_mfma_f32_16x16x32_bf16 a[28:31], v[16:19], v[60:63], a[28:31]
    v_mfma_f32_16x16x32_bf16 a[24:27], v[16:19], v[56:59], a[24:27]
    v_mfma_f32_16x16x32_bf16 a[20:23], v[16:19], v[52:55], a[20:23]
    s_waitcnt lgkmcnt(4)
    v_mfma_f32_16x16x32_bf16 a[16:19], v[16:19], v[48:51], a[16:19]
    v_mfma_f32_16x16x32_bf16 a[28:31], v[28:31], v[48:51], a[28:31]
    v_mfma_f32_16x16x32_bf16 a[24:27], v[24:27], v[48:51], a[24:27]
    v_mfma_f32_16x16x32_bf16 a[20:23], v[20:23], v[48:51], a[20:23]
    s_waitcnt lgkmcnt(3)
    v_mfma_f32_16x16x32_bf16 a[28:31], v[12:15], v[64:67], a[28:31]
    v_mfma_f32_16x16x32_bf16 a[24:27], v[12:15], v[60:63], a[24:27]
    v_mfma_f32_16x16x32_bf16 a[20:23], v[12:15], v[56:59], a[20:23]
    v_mfma_f32_16x16x32_bf16 a[16:19], v[12:15], v[52:55], a[16:19]
    v_mfma_f32_16x16x32_bf16 a[12:15], v[12:15], v[48:51], a[12:15]
    s_waitcnt lgkmcnt(2)
    v_mfma_f32_16x16x32_bf16 a[8:11], v[12:15], v[44:47], a[8:11]
    v_mfma_f32_16x16x32_bf16 a[28:31], v[32:35], v[44:47], a[28:31]
    v_mfma_f32_16x16x32_bf16 a[24:27], v[28:31], v[44:47], a[24:27]
    v_mfma_f32_16x16x32_bf16 a[20:23], v[24:27], v[44:47], a[20:23]
    v_mfma_f32_16x16x32_bf16 a[16:19], v[20:23], v[44:47], a[16:19]
    v_mfma_f32_16x16x32_bf16 a[12:15], v[16:19], v[44:47], a[12:15]
    s_waitcnt lgkmcnt(1)
    v_mfma_f32_16x16x32_bf16 a[28:31], v[8:11], v[68:71], a[28:31]
    v_mfma_f32_16x16x32_bf16 a[24:27], v[8:11], v[64:67], a[24:27]
    v_mfma_f32_16x16x32_bf16 a[20:23], v[8:11], v[60:63], a[20:23]
    v_mfma_f32_16x16x32_bf16 a[16:19], v[8:11], v[56:59], a[16:19]
    v_mfma_f32_16x16x32_bf16 a[12:15], v[8:11], v[52:55], a[12:15]
    v_mfma_f32_16x16x32_bf16 a[8:11], v[8:11], v[48:51], a[8:11]
    v_mfma_f32_16x16x32_bf16 a[4:7], v[8:11], v[44:47], a[4:7]
    s_waitcnt lgkmcnt(0)
    v_mfma_f32_16x16x32_bf16 a[0:3], v[8:11], v[40:43], a[0:3]
    v_mfma_f32_16x16x32_bf16 a[28:31], v[36:39], v[40:43], a[28:31]
    v_mfma_f32_16x16x32_bf16 a[24:27], v[32:35], v[40:43], a[24:27]
    v_mfma_f32_16x16x32_bf16 a[20:23], v[28:31], v[40:43], a[20:23]
    v_mfma_f32_16x16x32_bf16 a[16:19], v[24:27], v[40:43], a[16:19]
    v_mfma_f32_16x16x32_bf16 a[12:15], v[20:23], v[40:43], a[12:15]
    v_mfma_f32_16x16x32_bf16 a[8:11], v[16:19], v[40:43], a[8:11]
    v_mfma_f32_16x16x32_bf16 a[4:7], v[12:15], v[40:43], a[4:7]
    v_and_b32 v4, 63, v0
    v_lshlrev_b32 v4, 4, v4
    s_lshl_b32 s26, s7, 13
    v_add_u32 v4, s26, v4
    v_lshrrev_b32 v7, 5, v0
    v_lshlrev_b32 v7, 10, v7
    v_bfe_u32 v3, v0, 1, 4
    v_lshl_add_u32 v7, v3, 4, v7
    v_and_b32 v3, 1, v0
    v_lshl_add_u32 v7, v3, 9, v7
    s_barrier
    ds_write_b128 v4, a[0:3] offset:0
    ds_write_b128 v4, a[4:7] offset:1024
    ds_write_b128 v4, a[8:11] offset:2048
    ds_write_b128 v4, a[12:15] offset:3072
    ds_write_b128 v4, a[16:19] offset:4096
    ds_write_b128 v4, a[20:23] offset:5120
    ds_write_b128 v4, a[24:27] offset:6144
    ds_write_b128 v4, a[28:31] offset:7168
    s_waitcnt lgkmcnt(0)
    s_barrier
    ds_read_b128 v[8:11], v7 offset:0
    ds_read_b128 v[12:15], v7 offset:256
    ds_read_b128 v[16:19], v7 offset:8192
    ds_read_b128 v[20:23], v7 offset:8448
    ds_read_b128 v[24:27], v7 offset:16384
    ds_read_b128 v[28:31], v7 offset:16640
    ds_read_b128 v[32:35], v7 offset:24576
    ds_read_b128 v[36:39], v7 offset:24832
    v_mov_b32 v76, s54
    v_mul_f32 v3, s24, v76
    v_lshlrev_b32 v44, 16, v92
    v_and_b32 v45, s25, v92
    v_lshlrev_b32 v52, 16, v72
    v_and_b32 v53, s25, v72
    v_fmac_f32 v44, v3, v52
    v_fmac_f32 v45, v3, v53
    v_lshlrev_b32 v46, 16, v93
    v_and_b32 v47, s25, v93
    v_lshlrev_b32 v54, 16, v73
    v_and_b32 v55, s25, v73
    v_fmac_f32 v46, v3, v54
    v_fmac_f32 v47, v3, v55
    v_lshlrev_b32 v48, 16, v94
    v_and_b32 v49, s25, v94
    v_lshlrev_b32 v52, 16, v74
    v_and_b32 v53, s25, v74
    v_fmac_f32 v48, v3, v52
    v_fmac_f32 v49, v3, v53
    v_lshlrev_b32 v50, 16, v95
    v_and_b32 v51, s25, v95
    v_lshlrev_b32 v54, 16, v75
    v_and_b32 v55, s25, v75
    v_fmac_f32 v50, v3, v54
    v_fmac_f32 v51, v3, v55
    s_waitcnt lgkmcnt(5)
    v_add_f32 v8, v8, v16
    s_waitcnt lgkmcnt(1)
    v_add_f32 v24, v24, v32
    v_add_f32 v9, v9, v17
    v_add_f32 v25, v25, v33
    v_add_f32 v10, v10, v18
    v_add_f32 v26, v26, v34
    v_add_f32 v11, v11, v19
    v_add_f32 v27, v27, v35
    v_add_f32 v12, v12, v20
    s_waitcnt lgkmcnt(0)
    v_add_f32 v28, v28, v36
    v_add_f32 v13, v13, v21
    v_add_f32 v29, v29, v37
    v_add_f32 v14, v14, v22
    v_add_f32 v30, v30, v38
    v_add_f32 v15, v15, v23
    v_add_f32 v31, v31, v39
    v_add_f32 v8, v8, v24
    v_add_f32 v9, v9, v25
    v_add_f32 v10, v10, v26
    v_add_f32 v11, v11, v27
    v_add_f32 v12, v12, v28
    v_add_f32 v13, v13, v29
    v_add_f32 v14, v14, v30
    v_add_f32 v15, v15, v31
    v_fmac_f32 v44, v76, v8
    v_fmac_f32 v45, v76, v9
    v_fmac_f32 v46, v76, v10
    v_fmac_f32 v47, v76, v11
    v_fmac_f32 v48, v76, v12
    v_fmac_f32 v49, v76, v13
    v_fmac_f32 v50, v76, v14
    v_fmac_f32 v51, v76, v15
    v_cvt_pk_bf16_f32 v40, v44, v45
    v_cvt_pk_bf16_f32 v41, v46, v47
    v_cvt_pk_bf16_f32 v42, v48, v49
    v_cvt_pk_bf16_f32 v43, v50, v51
    s_lshl_b32 s5, s4, 12
    buffer_store_dwordx4 v[40:43], v5, s[20:23], s5 offen sc1
    s_endpgm
ka_exit:
    s_nop 7
    s_nop 7
    s_endpgm

.globl k2_gemm1_kernel
.p2align 8
.type k2_gemm1_kernel,@function
k2_gemm1_kernel:
    s_cmp_ge_u32 s2, 256
    s_cbranch_scc1 k2_exit
    s_load_dwordx2 s[4:5], s[0:1], 144
    s_and_b32 s3, s2, 7
    s_lshr_b32 s6, s2, 3
    s_and_b32 s7, s3, 1
    s_and_b32 s36, s6, 3
    s_lshr_b32 s25, s3, 1
    s_lshl_b32 s25, s25, 3
    s_lshr_b32 s6, s6, 2
    s_add_u32 s25, s25, s6
    v_lshrrev_b32 v1, 6, v0
    s_nop 0
    v_readfirstlane_b32 s37, v1
    s_mul_i32 s38, s36, 14
    s_mul_i32 s39, s7, 54
    s_add_u32 s38, s38, s39
    s_lshl_b32 s26, s37, 1
    s_add_u32 s24, s38, s26
    s_lshl_b32 s26, s26, 4
    s_waitcnt lgkmcnt(0)
    s_add_u32 s8, s4, 8900608
    s_addc_u32 s9, s5, 0
    s_and_b32 s9, s9, 0xffff
    s_mov_b32 s10, 2621440
    s_mov_b32 s11, 0x20000
    s_add_u32 s12, s4, 6631424
    s_addc_u32 s13, s5, 0
    s_and_b32 s13, s13, 0xffff
    s_mov_b32 s14, 2211840
    s_mov_b32 s15, 0x20000
    s_add_u32 s40, s4, 8843264
    s_addc_u32 s41, s5, 0
    s_and_b32 s41, s41, 0xffff
    s_mov_b32 s42, 55296
    s_mov_b32 s43, 0x20000
    s_add_u32 s32, s4, 18599936
    s_addc_u32 s33, s5, 0
    s_and_b32 s33, s33, 0xffff
    s_mov_b32 s34, 16384
    s_mov_b32 s35, 0x20000
    v_and_b32 v3, 255, v0
    s_lshl_b32 s39, s38, 4
    v_add_u32 v3, s39, v3
    v_min_u32 v3, 1727, v3
    v_lshrrev_b32 v8, 8, v0
    v_mul_u32_u24 v8, 1728, v8
    v_add_u32 v3, v3, v8
    v_lshlrev_b32 v3, 2, v3
    v_bfe_u32 v12, v0, 3, 3
    v_bfe_u32 v13, v0, 1, 2
    v_bfe_u32 v14, v0, 4, 2
    v_xor_b32 v13, v13, v14
    v_lshlrev_b32 v13, 5, v13
    v_and_b32 v14, 1, v0
    v_lshl_add_u32 v13, v14, 4, v13
    v_lshl_add_u32 v1, v12, 12, v13
    s_lshl_b32 s21, s37, 15
    s_lshl_b32 s39, s25, 7
    s_add_u32 s21, s21, s39
    s_lshl_b32 s20, s37, 10
    s_add_u32 s20, s20, 4096
    v_and_b32 v2, 63, v0
    v_lshlrev_b32 v2, 4, v2
    s_mul_i32 s22, s24, 20480
    s_add_u32 s23, s22, 20480
    v_bfe_u32 v12, v0, 4, 2
    v_bfe_u32 v13, v0, 2, 2
    v_lshl_add_u32 v12, v12, 2, v13
    v_bfe_u32 v13, v12, 1, 2
    v_lshlrev_b32 v12, 7, v12
    v_and_b32 v14, 3, v0
    v_lshl_add_u32 v12, v14, 3, v12
    v_add_u32 v12, 4096, v12
    v_xor_b32 v14, 0, v13
    v_lshl_add_u32 v4, v14, 5, v12
    v_xor_b32 v14, 1, v13
    v_lshl_add_u32 v5, v14, 5, v12
    v_xor_b32 v14, 2, v13
    v_lshl_add_u32 v6, v14, 5, v12
    v_xor_b32 v14, 3, v13
    v_lshl_add_u32 v7, v14, 5, v12
    s_cmp_eq_u32 s37, 7
    s_cbranch_scc1 k2_stats
    s_cmp_eq_u32 s7, 1
    s_cbranch_scc1 k2_z2
    s_add_u32 s16, s4, 11522048
    s_addc_u32 s17, s5, 0
    s_and_b32 s17, s17, 0xffff
    s_mov_b32 s18, 3538944
    s_mov_b32 s19, 0x20000
    s_add_u32 m0, s20, 0
    s_add_u32 s29, s21, 0
    buffer_load_dwordx4 v1, s[8:11], s29 offen lds
    s_add_u32 s29, s22, 0
    buffer_load_dwordx4 a[0:3], v2, s[12:15], s29 offen offset:0
    s_add_u32 s29, s23, 0
    buffer_load_dwordx4 a[80:83], v2, s[12:15], s29 offen offset:0
    s_add_u32 s29, s22, 0
    buffer_load_dwordx4 a[4:7], v2, s[12:15], s29 offen offset:1024
    s_add_u32 s29, s23, 0
    buffer_load_dwordx4 a[84:87], v2, s[12:15], s29 offen offset:1024
    s_add_u32 m0, s20, 8192
    s_add_u32 s29, s21, 262144
    buffer_load_dwordx4 v1, s[8:11], s29 offen lds
    s_add_u32 s29, s22, 0
    buffer_load_dwordx4 a[8:11], v2, s[12:15], s29 offen offset:2048
    s_add_u32 s29, s23, 0
    buffer_load_dwordx4 a[88:91], v2, s[12:15], s29 offen offset:2048
    s_add_u32 s29, s22, 0
    buffer_load_dwordx4 a[12:15], v2, s[12:15], s29 offen offset:3072
    s_add_u32 s29, s23, 0
    buffer_load_dwordx4 a[92:95], v2, s[12:15], s29 offen offset:3072
    s_add_u32 m0, s20, 16384
    s_add_u32 s29, s21, 524288
    buffer_load_dwordx4 v1, s[8:11], s29 offen lds
    s_add_u32 m0, s20, 24576
    s_add_u32 s29, s21, 786432
    buffer_load_dwordx4 v1, s[8:11], s29 offen lds
    s_add_u32 s29, s22, 4096
    buffer_load_dwordx4 a[16:19], v2, s[12:15], s29 offen offset:0
    s_add_u32 s29, s23, 4096
    buffer_load_dwordx4 a[96:99], v2, s[12:15], s29 offen offset:0
    s_add_u32 s29, s22, 4096
    buffer_load_dwordx4 a[20:23], v2, s[12:15], s29 offen offset:1024
    s_add_u32 s29, s23, 4096
    buffer_load_dwordx4 a[100:103], v2, s[12:15], s29 offen offset:1024
    s_mov_b32 s29, 0
    buffer_load_dword v80, v3, s[40:43], s29 offen
    s_mov_b32 s29, 13824
    buffer_load_dword v81, v3, s[40:43], s29 offen
    s_mov_b32 s29, 27648
    buffer_load_dword v82, v3, s[40:43], s29 offen
    s_mov_b32 s29, 41472
    buffer_load_dword v83, v3, s[40:43], s29 offen
    s_waitcnt vmcnt(19)
    s_barrier
    ds_read_b64_tr_b16 v[48:49], v4 offset:0
    ds_read_b64_tr_b16 v[50:51], v4 offset:2048
    ds_read_b64_tr_b16 v[52:53], v5 offset:0
    ds_read_b64_tr_b16 v[54:55], v5 offset:2048
    ds_read_b64_tr_b16 v[56:57], v6 offset:0
    ds_read_b64_tr_b16 v[58:59], v6 offset:2048
    ds_read_b64_tr_b16 v[60:61], v7 offset:0
    ds_read_b64_tr_b16 v[62:63], v7 offset:2048
    s_add_u32 m0, s20, 32768
    s_add_u32 s29, s21, 1048576
    buffer_load_dwordx4 v1, s[8:11], s29 offen lds
    s_add_u32 m0, s20, 40960
    s_add_u32 s29, s21, 1310720
    buffer_load_dwordx4 v1, s[8:11], s29 offen lds
    s_add_u32 s29, s22, 4096
    buffer_load_dwordx4 a[24:27], v2, s[12:15], s29 offen offset:2048
    ds_read_b64_tr_b16 v[64:65], v4 offset:4096
    ds_read_b64_tr_b16 v[66:67], v4 offset:6144
    ds_read_b64_tr_b16 v[68:69], v5 offset:4096
    ds_read_b64_tr_b16 v[70:71], v5 offset:6144
    ds_read_b64_tr_b16 v[72:73], v6 offset:4096
    ds_read_b64_tr_b16 v[74:75], v6 offset:6144
    ds_read_b64_tr_b16 v[76:77], v7 offset:4096
    ds_read_b64_tr_b16 v[78:79], v7 offset:6144
    s_waitcnt vmcnt(21) lgkmcnt(14)
    v_mfma_f32_16x16x32_bf16 v[16:19], a[0:3], v[48:51], 0
    s_waitcnt vmcnt(20)
    v_mfma_f32_16x16x32_bf16 v[32:35], a[80:83], v[48:51], 0
    s_waitcnt lgkmcnt(12)
    v_mfma_f32_16x16x32_bf16 v[20:23], a[0:3], v[52:55], 0
    s_add_u32 s29, s23, 4096
    buffer_load_dwordx4 a[104:107], v2, s[12:15], s29 offen offset:2048
    v_mfma_f32_16x16x32_bf16 v[36:39], a[80:83], v[52:55], 0
    s_waitcnt lgkmcnt(10)
    v_mfma_f32_16x16x32_bf16 v[24:27], a[0:3], v[56:59], 0
    v_mfma_f32_16x16x32_bf16 v[40:43], a[80:83], v[56:59], 0
    s_add_u32 s29, s22, 4096
    buffer_load_dwordx4 a[28:31], v2, s[12:15], s29 offen offset:3072
    s_waitcnt lgkmcnt(8)
    v_mfma_f32_16x16x32_bf16 v[28:31], a[0:3], v[60:63], 0
    v_mfma_f32_16x16x32_bf16 v[44:47], a[80:83], v[60:63], 0
    s_add_u32 s29, s23, 4096
    buffer_load_dwordx4 a[108:111], v2, s[12:15], s29 offen offset:3072
    s_waitcnt vmcnt(20)
    s_barrier
    ds_read_b64_tr_b16 v[48:49], v4 offset:8192
    ds_read_b64_tr_b16 v[50:51], v4 offset:10240
    ds_read_b64_tr_b16 v[52:53], v5 offset:8192
    ds_read_b64_tr_b16 v[54:55], v5 offset:10240
    ds_read_b64_tr_b16 v[56:57], v6 offset:8192
    ds_read_b64_tr_b16 v[58:59], v6 offset:10240
    ds_read_b64_tr_b16 v[60:61], v7 offset:8192
    ds_read_b64_tr_b16 v[62:63], v7 offset:10240
    s_waitcnt lgkmcnt(14)
    v_mfma_f32_16x16x32_bf16 v[16:19], a[4:7], v[64:67], v[16:19]
    v_mfma_f32_16x16x32_bf16 v[32:35], a[84:87], v[64:67], v[32:35]
    s_waitcnt lgkmcnt(12)
    v_mfma_f32_16x16x32_bf16 v[20:23], a[4:7], v[68:71], v[20:23]
    s_add_u32 m0, s20, 49152
    s_add_u32 s29, s21, 1572864
    buffer_load_dwordx4 v1, s[8:11], s29 offen lds
    v_mfma_f32_16x16x32_bf16 v[36:39], a[84:87], v[68:71], v[36:39]
    s_waitcnt lgkmcnt(10)
    v_mfma_f32_16x16x32_bf16 v[24:27], a[4:7], v[72:75], v[24:27]
    v_mfma_f32_16x16x32_bf16 v[40:43], a[84:87], v[72:75], v[40:43]
    s_add_u32 m0, s20, 57344
    s_add_u32 s29, s21, 1835008
    buffer_load_dwordx4 v1, s[8:11], s29 offen lds
    s_waitcnt lgkmcnt(8)
    v_mfma_f32_16x16x32_bf16 v[28:31], a[4:7], v[76:79], v[28:31]
    v_mfma_f32_16x16x32_bf16 v[44:47], a[84:87], v[76:79], v[44:47]
    s_add_u32 s29, s22, 8192
    buffer_load_dwordx4 a[32:35], v2, s[12:15], s29 offen offset:0
    ds_read_b64_tr_b16 v[64:65], v4 offset:12288
    ds_read_b64_tr_b16 v[66:67], v4 offset:14336
    ds_read_b64_tr_b16 v[68:69], v5 offset:12288
    ds_read_b64_tr_b16 v[70:71], v5 offset:14336
    ds_read_b64_tr_b16 v[72:73], v6 offset:12288
    ds_read_b64_tr_b16 v[74:75], v6 offset:14336
    ds_read_b64_tr_b16 v[76:77], v7 offset:12288
    ds_read_b64_tr_b16 v[78:79], v7 offset:14336
    s_waitcnt vmcnt(22) lgkmcnt(14)
    v_mfma_f32_16x16x32_bf16 v[16:19], a[8:11], v[48:51], v[16:19]
    s_waitcnt vmcnt(21)
    v_mfma_f32_16x16x32_bf16 v[32:35], a[88:91], v[48:51], v[32:35]
    s_waitcnt lgkmcnt(12)
    v_mfma_f32_16x16x32_bf16 v[20:23], a[8:11], v[52:55], v[20:23]
    s_add_u32 s29, s23, 8192
    buffer_load_dwordx4 a[112:115], v2, s[12:15], s29 offen offset:0
    v_mfma_f32_16x16x32_bf16 v[36:39], a[88:91], v[52:55], v[36:39]
    s_waitcnt lgkmcnt(10)
    v_mfma_f32_16x16x32_bf16 v[24:27], a[8:11], v[56:59], v[24:27]
    v_mfma_f32_16x16x32_bf16 v[40:43], a[88:91], v[56:59], v[40:43]
    s_add_u32 s29, s22, 8192
    buffer_load_dwordx4 a[36:39], v2, s[12:15], s29 offen offset:1024
    s_waitcnt lgkmcnt(8)
    v_mfma_f32_16x16x32_bf16 v[28:31], a[8:11], v[60:63], v[28:31]
    v_mfma_f32_16x16x32_bf16 v[44:47], a[88:91], v[60:63], v[44:47]
    s_add_u32 s29, s23, 8192
    buffer_load_dwordx4 a[116:119], v2, s[12:15], s29 offen offset:1024
    s_waitcnt vmcnt(20)
    s_barrier
    ds_read_b64_tr_b16 v[48:49], v4 offset:16384
    ds_read_b64_tr_b16 v[50:51], v4 offset:18432
    ds_read_b64_tr_b16 v[52:53], v5 offset:16384
    ds_read_b64_tr_b16 v[54:55], v5 offset:18432
    ds_read_b64_tr_b16 v[56:57], v6 offset:16384
    ds_read_b64_tr_b16 v[58:59], v6 offset:18432
    ds_read_b64_tr_b16 v[60:61], v7 offset:16384
    ds_read_b64_tr_b16 v[62:63], v7 offset:18432
    s_waitcnt lgkmcnt(14)
    v_mfma_f32_16x16x32_bf16 v[16:19], a[12:15], v[64:67], v[16:19]
    v_mfma_f32_16x16x32_bf16 v[32:35], a[92:95], v[64:67], v[32:35]
    s_waitcnt lgkmcnt(12)
    v_mfma_f32_16x16x32_bf16 v[20:23], a[12:15], v[68:71], v[20:23]
    s_add_u32 m0, s20, 65536
    s_add_u32 s29, s21, 2097152
    buffer_load_dwordx4 v1, s[8:11], s29 offen lds
    v_mfma_f32_16x16x32_bf16 v[36:39], a[92:95], v[68:71], v[36:39]
    s_waitcnt lgkmcnt(10)
    v_mfma_f32_16x16x32_bf16 v[24:27], a[12:15], v[72:75], v[24:27]
    v_mfma_f32_16x16x32_bf16 v[40:43], a[92:95], v[72:75], v[40:43]
    s_add_u32 m0, s20, 73728
    s_add_u32 s29, s21, 2359296
    buffer_load_dwordx4 v1, s[8:11], s29 offen lds
    s_waitcnt lgkmcnt(8)
    v_mfma_f32_16x16x32_bf16 v[28:31], a[12:15], v[76:79], v[28:31]
    v_mfma_f32_16x16x32_bf16 v[44:47], a[92:95], v[76:79], v[44:47]
    s_add_u32 s29, s22, 8192
    buffer_load_dwordx4 a[40:43], v2, s[12:15], s29 offen offset:2048
    ds_read_b64_tr_b16 v[64:65], v4 offset:20480
    ds_read_b64_tr_b16 v[66:67], v4 offset:22528
    ds_read_b64_tr_b16 v[68:69], v5 offset:20480
    ds_read_b64_tr_b16 v[70:71], v5 offset:22528
    ds_read_b64_tr_b16 v[72:73], v6 offset:20480
    ds_read_b64_tr_b16 v[74:75], v6 offset:22528
    ds_read_b64_tr_b16 v[76:77], v7 offset:20480
    ds_read_b64_tr_b16 v[78:79], v7 offset:22528
    s_waitcnt vmcnt(22) lgkmcnt(14)
    v_mfma_f32_16x16x32_bf16 v[16:19], a[16:19], v[48:51], v[16:19]
    s_waitcnt vmcnt(21)
    v_mfma_f32_16x16x32_bf16 v[32:35], a[96:99], v[48:51], v[32:35]
    s_waitcnt lgkmcnt(12)
    v_mfma_f32_16x16x32_bf16 v[20:23], a[16:19], v[52:55], v[20:23]
    s_add_u32 s29, s23, 8192
    buffer_load_dwordx4 a[120:123], v2, s[12:15], s29 offen offset:2048
    v_mfma_f32_16x16x32_bf16 v[36:39], a[96:99], v[52:55], v[36:39]
    s_waitcnt lgkmcnt(10)
    v_mfma_f32_16x16x32_bf16 v[24:27], a[16:19], v[56:59], v[24:27]
    v_mfma_f32_16x16x32_bf16 v[40:43], a[96:99], v[56:59], v[40:43]
    s_add_u32 s29, s22, 8192
    buffer_load_dwordx4 a[44:47], v2, s[12:15], s29 offen offset:3072
    s_waitcnt lgkmcnt(8)
    v_mfma_f32_16x16x32_bf16 v[28:31], a[16:19], v[60:63], v[28:31]
    v_mfma_f32_16x16x32_bf16 v[44:47], a[96:99], v[60:63], v[44:47]
    s_add_u32 s29, s23, 8192
    buffer_load_dwordx4 a[124:127], v2, s[12:15], s29 offen offset:3072
    ds_read_b64_tr_b16 v[48:49], v4 offset:24576
    ds_read_b64_tr_b16 v[50:51], v4 offset:26624
    ds_read_b64_tr_b16 v[52:53], v5 offset:24576
    ds_read_b64_tr_b16 v[54:55], v5 offset:26624
    ds_read_b64_tr_b16 v[56:57], v6 offset:24576
    ds_read_b64_tr_b16 v[58:59], v6 offset:26624
    ds_read_b64_tr_b16 v[60:61], v7 offset:24576
    ds_read_b64_tr_b16 v[62:63], v7 offset:26624
    s_waitcnt vmcnt(23) lgkmcnt(14)
    v_mfma_f32_16x16x32_bf16 v[16:19], a[20:23], v[64:67], v[16:19]
    s_waitcnt vmcnt(22)
    v_mfma_f32_16x16x32_bf16 v[32:35], a[100:103], v[64:67], v[32:35]
    s_waitcnt lgkmcnt(12)
    v_mfma_f32_16x16x32_bf16 v[20:23], a[20:23], v[68:71], v[20:23]
    v_mfma_f32_16x16x32_bf16 v[36:39], a[100:103], v[68:71], v[36:39]
    s_add_u32 s29, s22, 12288
    buffer_load_dwordx4 a[48:51], v2, s[12:15], s29 offen offset:0
    s_waitcnt lgkmcnt(10)
    v_mfma_f32_16x16x32_bf16 v[24:27], a[20:23], v[72:75], v[24:27]
    v_mfma_f32_16x16x32_bf16 v[40:43], a[100:103], v[72:75], v[40:43]
    s_waitcnt lgkmcnt(8)
    v_mfma_f32_16x16x32_bf16 v[28:31], a[20:23], v[76:79], v[28:31]
    v_mfma_f32_16x16x32_bf16 v[44:47], a[100:103], v[76:79], v[44:47]
    s_add_u32 s29, s23, 12288
    buffer_load_dwordx4 a[128:131], v2, s[12:15], s29 offen offset:0
    ds_read_b64_tr_b16 v[64:65], v4 offset:28672
    ds_read_b64_tr_b16 v[66:67], v4 offset:30720
    ds_read_b64_tr_b16 v[68:69], v5 offset:28672
    ds_read_b64_tr_b16 v[70:71], v5 offset:30720
    ds_read_b64_tr_b16 v[72:73], v6 offset:28672
    ds_read_b64_tr_b16 v[74:75], v6 offset:30720
    ds_read_b64_tr_b16 v[76:77], v7 offset:28672
    ds_read_b64_tr_b16 v[78:79], v7 offset:30720
    s_waitcnt vmcnt(17) lgkmcnt(14)
    v_mfma_f32_16x16x32_bf16 v[16:19], a[24:27], v[48:51], v[16:19]
    s_waitcnt vmcnt(16)
    v_mfma_f32_16x16x32_bf16 v[32:35], a[104:107], v[48:51], v[32:35]
    s_waitcnt lgkmcnt(12)
    v_mfma_f32_16x16x32_bf16 v[20:23], a[24:27], v[52:55], v[20:23]
    v_mfma_f32_16x16x32_bf16 v[36:39], a[104:107], v[52:55], v[36:39]
    s_add_u32 s29, s22, 12288
    buffer_load_dwordx4 a[52:55], v2, s[12:15], s29 offen offset:1024
    s_waitcnt lgkmcnt(10)
    v_mfma_f32_16x16x32_bf16 v[24:27], a[24:27], v[56:59], v[24:27]
    v_mfma_f32_16x16x32_bf16 v[40:43], a[104:107], v[56:59], v[40:43]
    s_waitcnt lgkmcnt(8)
    v_mfma_f32_16x16x32_bf16 v[28:31], a[24:27], v[60:63], v[28:31]
    v_mfma_f32_16x16x32_bf16 v[44:47], a[104:107], v[60:63], v[44:47]
    s_add_u32 s29, s23, 12288
    buffer_load_dwordx4 a[132:135], v2, s[12:15], s29 offen offset:1024
    v_add_f32 v80, v80, v81
    v_add_f32 v82, v82, v83
    v_add_f32 v80, v80, v82
    v_lshlrev_b32 v3, 2, v0
    ds_write_b32 v3, v80 offset:0
    s_waitcnt lgkmcnt(0)
    s_waitcnt vmcnt(15)
    s_barrier
    ds_read_b64_tr_b16 v[48:49], v4 offset:32768
    ds_read_b64_tr_b16 v[50:51], v4 offset:34816
    ds_read_b64_tr_b16 v[52:53], v5 offset:32768
    ds_read_b64_tr_b16 v[54:55], v5 offset:34816
    ds_read_b64_tr_b16 v[56:57], v6 offset:32768
    ds_read_b64_tr_b16 v[58:59], v6 offset:34816
    ds_read_b64_tr_b16 v[60:61], v7 offset:32768
    ds_read_b64_tr_b16 v[62:63], v7 offset:34816
    v_mfma_f32_16x16x32_bf16 v[16:19], a[28:31], v[64:67], v[16:19]
    v_mfma_f32_16x16x32_bf16 v[32:35], a[108:111], v[64:67], v[32:35]
    v_mfma_f32_16x16x32_bf16 v[20:23], a[28:31], v[68:71], v[20:23]
    v_mfma_f32_16x16x32_bf16 v[36:39], a[108:111], v[68:71], v[36:39]
    s_add_u32 s29, s22, 12288
    buffer_load_dwordx4 a[56:59], v2, s[12:15], s29 offen offset:2048
    v_mfma_f32_16x16x32_bf16 v[24:27], a[28:31], v[72:75], v[24:27]
    v_mfma_f32_16x16x32_bf16 v[40:43], a[108:111], v[72:75], v[40:43]
    v_mfma_f32_16x16x32_bf16 v[28:31], a[28:31], v[76:79], v[28:31]
    v_mfma_f32_16x16x32_bf16 v[44:47], a[108:111], v[76:79], v[44:47]
    s_add_u32 s29, s23, 12288
    buffer_load_dwordx4 a[136:139], v2, s[12:15], s29 offen offset:2048
    ds_read_b64_tr_b16 v[64:65], v4 offset:36864
    ds_read_b64_tr_b16 v[66:67], v4 offset:38912
    ds_read_b64_tr_b16 v[68:69], v5 offset:36864
    ds_read_b64_tr_b16 v[70:71], v5 offset:38912
    ds_read_b64_tr_b16 v[72:73], v6 offset:36864
    ds_read_b64_tr_b16 v[74:75], v6 offset:38912
    ds_read_b64_tr_b16 v[76:77], v7 offset:36864
    ds_read_b64_tr_b16 v[78:79], v7 offset:38912
    s_waitcnt vmcnt(15) lgkmcnt(14)
    v_mfma_f32_16x16x32_bf16 v[16:19], a[32:35], v[48:51], v[16:19]
    s_waitcnt vmcnt(14)
    v_mfma_f32_16x16x32_bf16 v[32:35], a[112:115], v[48:51], v[32:35]
    s_waitcnt lgkmcnt(12)
    v_mfma_f32_16x16x32_bf16 v[20:23], a[32:35], v[52:55], v[20:23]
    v_mfma_f32_16x16x32_bf16 v[36:39], a[112:115], v[52:55], v[36:39]
    s_add_u32 s29, s22, 12288
    buffer_load_dwordx4 a[60:63], v2, s[12:15], s29 offen offset:3072
    s_waitcnt lgkmcnt(10)
    v_mfma_f32_16x16x32_bf16 v[24:27], a[32:35], v[56:59], v[24:27]
    v_mfma_f32_16x16x32_bf16 v[40:43], a[112:115], v[56:59], v[40:43]
    s_waitcnt lgkmcnt(8)
    v_mfma_f32_16x16x32_bf16 v[28:31], a[32:35], v[60:63], v[28:31]
    v_mfma_f32_16x16x32_bf16 v[44:47], a[112:115], v[60:63], v[44:47]
    s_add_u32 s29, s23, 12288
    buffer_load_dwordx4 a[140:143], v2, s[12:15], s29 offen offset:3072
    v_add_u32 v4, 40960, v4
    v_add_u32 v5, 40960, v5
    v_add_u32 v6, 40960, v6
    v_add_u32 v7, 40960, v7
    ds_read_b64_tr_b16 v[48:49], v4 offset:0
    ds_read_b64_tr_b16 v[50:51], v4 offset:2048
    ds_read_b64_tr_b16 v[52:53], v5 offset:0
    ds_read_b64_tr_b16 v[54:55], v5 offset:2048
    ds_read_b64_tr_b16 v[56:57], v6 offset:0
    ds_read_b64_tr_b16 v[58:59], v6 offset:2048
    ds_read_b64_tr_b16 v[60:61], v7 offset:0
    ds_read_b64_tr_b16 v[62:63], v7 offset:2048
    s_waitcnt vmcnt(15) lgkmcnt(14)
    v_mfma_f32_16x16x32_bf16 v[16:19], a[36:39], v[64:67], v[16:19]
    s_waitcnt vmcnt(14)
    v_mfma_f32_16x16x32_bf16 v[32:35], a[116:119], v[64:67], v[32:35]
    s_waitcnt lgkmcnt(12)
    v_mfma_f32_16x16x32_bf16 v[20:23], a[36:39], v[68:71], v[20:23]
    v_mfma_f32_16x16x32_bf16 v[36:39], a[116:119], v[68:71], v[36:39]
    s_add_u32 s29, s22, 16384
    buffer_load_dwordx4 a[64:67], v2, s[12:15], s29 offen offset:0
    s_waitcnt lgkmcnt(10)
    v_mfma_f32_16x16x32_bf16 v[24:27], a[36:39], v[72:75], v[24:27]
    v_mfma_f32_16x16x32_bf16 v[40:43], a[116:119], v[72:75], v[40:43]
    s_waitcnt lgkmcnt(8)
    v_mfma_f32_16x16x32_bf16 v[28:31], a[36:39], v[76:79], v[28:31]
    v_mfma_f32_16x16x32_bf16 v[44:47], a[116:119], v[76:79], v[44:47]
    s_add_u32 s29, s23, 16384
    buffer_load_dwordx4 a[144:147], v2, s[12:15], s29 offen offset:0
    ds_read_b64_tr_b16 v[64:65], v4 offset:4096
    ds_read_b64_tr_b16 v[66:67], v4 offset:6144
    ds_read_b64_tr_b16 v[68:69], v5 offset:4096
    ds_read_b64_tr_b16 v[70:71], v5 offset:6144
    ds_read_b64_tr_b16 v[72:73], v6 offset:4096
    ds_read_b64_tr_b16 v[74:75], v6 offset:6144
    ds_read_b64_tr_b16 v[76:77], v7 offset:4096
    ds_read_b64_tr_b16 v[78:79], v7 offset:6144
    s_waitcnt vmcnt(13) lgkmcnt(14)
    v_mfma_f32_16x16x32_bf16 v[16:19], a[40:43], v[48:51], v[16:19]
    s_waitcnt vmcnt(12)
    v_mfma_f32_16x16x32_bf16 v[32:35], a[120:123], v[48:51], v[32:35]
    s_waitcnt lgkmcnt(12)
    v_mfma_f32_16x16x32_bf16 v[20:23], a[40:43], v[52:55], v[20:23]
    v_mfma_f32_16x16x32_bf16 v[36:39], a[120:123], v[52:55], v[36:39]
    s_add_u32 s29, s22, 16384
    buffer_load_dwordx4 a[68:71], v2, s[12:15], s29 offen offset:1024
    s_waitcnt lgkmcnt(10)
    v_mfma_f32_16x16x32_bf16 v[24:27], a[40:43], v[56:59], v[24:27]
    v_mfma_f32_16x16x32_bf16 v[40:43], a[120:123], v[56:59], v[40:43]
    s_waitcnt lgkmcnt(8)
    v_mfma_f32_16x16x32_bf16 v[28:31], a[40:43], v[60:63], v[28:31]
    v_mfma_f32_16x16x32_bf16 v[44:47], a[120:123], v[60:63], v[44:47]
    s_add_u32 s29, s23, 16384
    buffer_load_dwordx4 a[148:151], v2, s[12:15], s29 offen offset:1024
    s_barrier
    ds_read_b64_tr_b16 v[48:49], v4 offset:8192
    ds_read_b64_tr_b16 v[50:51], v4 offset:10240
    ds_read_b64_tr_b16 v[52:53], v5 offset:8192
    ds_read_b64_tr_b16 v[54:55], v5 offset:10240
    ds_read_b64_tr_b16 v[56:57], v6 offset:8192
    ds_read_b64_tr_b16 v[58:59], v6 offset:10240
    ds_read_b64_tr_b16 v[60:61], v7 offset:8192
    ds_read_b64_tr_b16 v[62:63], v7 offset:10240
    s_waitcnt vmcnt(13) lgkmcnt(14)
    v_mfma_f32_16x16x32_bf16 v[16:19], a[44:47], v[64:67], v[16:19]
    s_waitcnt vmcnt(12)
    v_mfma_f32_16x16x32_bf16 v[32:35], a[124:127], v[64:67], v[32:35]
    s_waitcnt lgkmcnt(12)
    v_mfma_f32_16x16x32_bf16 v[20:23], a[44:47], v[68:71], v[20:23]
    v_mfma_f32_16x16x32_bf16 v[36:39], a[124:127], v[68:71], v[36:39]
    s_add_u32 s29, s22, 16384
    buffer_load_dwordx4 a[72:75], v2, s[12:15], s29 offen offset:2048
    s_waitcnt lgkmcnt(10)
    v_mfma_f32_16x16x32_bf16 v[24:27], a[44:47], v[72:75], v[24:27]
    v_mfma_f32_16x16x32_bf16 v[40:43], a[124:127], v[72:75], v[40:43]
    s_waitcnt lgkmcnt(8)
    v_mfma_f32_16x16x32_bf16 v[28:31], a[44:47], v[76:79], v[28:31]
    v_mfma_f32_16x16x32_bf16 v[44:47], a[124:127], v[76:79], v[44:47]
    s_add_u32 s29, s23, 16384
    buffer_load_dwordx4 a[152:155], v2, s[12:15], s29 offen offset:2048
    ds_read_b64_tr_b16 v[64:65], v4 offset:12288
    ds_read_b64_tr_b16 v[66:67], v4 offset:14336
    ds_read_b64_tr_b16 v[68:69], v5 offset:12288
    ds_read_b64_tr_b16 v[70:71], v5 offset:14336
    ds_read_b64_tr_b16 v[72:73], v6 offset:12288
    ds_read_b64_tr_b16 v[74:75], v6 offset:14336
    ds_read_b64_tr_b16 v[76:77], v7 offset:12288
    ds_read_b64_tr_b16 v[78:79], v7 offset:14336
    s_waitcnt vmcnt(13) lgkmcnt(14)
    v_mfma_f32_16x16x32_bf16 v[16:19], a[48:51], v[48:51], v[16:19]
    s_waitcnt vmcnt(12)
    v_mfma_f32_16x16x32_bf16 v[32:35], a[128:131], v[48:51], v[32:35]
    s_waitcnt lgkmcnt(12)
    v_mfma_f32_16x16x32_bf16 v[20:23], a[48:51], v[52:55], v[20:23]
    v_mfma_f32_16x16x32_bf16 v[36:39], a[128:131], v[52:55], v[36:39]
    s_add_u32 s29, s22, 16384
    buffer_load_dwordx4 a[76:79], v2, s[12:15], s29 offen offset:3072
    s_waitcnt lgkmcnt(10)
    v_mfma_f32_16x16x32_bf16 v[24:27], a[48:51], v[56:59], v[24:27]
    v_mfma_f32_16x16x32_bf16 v[40:43], a[128:131], v[56:59], v[40:43]
    s_waitcnt lgkmcnt(8)
    v_mfma_f32_16x16x32_bf16 v[28:31], a[48:51], v[60:63], v[28:31]
    v_mfma_f32_16x16x32_bf16 v[44:47], a[128:131], v[60:63], v[44:47]
    s_add_u32 s29, s23, 16384
    buffer_load_dwordx4 a[156:159], v2, s[12:15], s29 offen offset:3072
    ds_read_b64_tr_b16 v[48:49], v4 offset:16384
    ds_read_b64_tr_b16 v[50:51], v4 offset:18432
    ds_read_b64_tr_b16 v[52:53], v5 offset:16384
    ds_read_b64_tr_b16 v[54:55], v5 offset:18432
    ds_read_b64_tr_b16 v[56:57], v6 offset:16384
    ds_read_b64_tr_b16 v[58:59], v6 offset:18432
    ds_read_b64_tr_b16 v[60:61], v7 offset:16384
    ds_read_b64_tr_b16 v[62:63], v7 offset:18432
    s_waitcnt vmcnt(13) lgkmcnt(14)
    v_mfma_f32_16x16x32_bf16 v[16:19], a[52:55], v[64:67], v[16:19]
    s_waitcnt vmcnt(12)
    v_mfma_f32_16x16x32_bf16 v[32:35], a[132:135], v[64:67], v[32:35]
    s_waitcnt lgkmcnt(12)
    v_mfma_f32_16x16x32_bf16 v[20:23], a[52:55], v[68:71], v[20:23]
    v_mfma_f32_16x16x32_bf16 v[36:39], a[132:135], v[68:71], v[36:39]
    s_waitcnt lgkmcnt(10)
    v_mfma_f32_16x16x32_bf16 v[24:27], a[52:55], v[72:75], v[24:27]
    v_mfma_f32_16x16x32_bf16 v[40:43], a[132:135], v[72:75], v[40:43]
    s_waitcnt lgkmcnt(8)
    v_mfma_f32_16x16x32_bf16 v[28:31], a[52:55], v[76:79], v[28:31]
    v_mfma_f32_16x16x32_bf16 v[44:47], a[132:135], v[76:79], v[44:47]
    ds_read_b64_tr_b16 v[64:65], v4 offset:20480
    ds_read_b64_tr_b16 v[66:67], v4 offset:22528
    ds_read_b64_tr_b16 v[68:69], v5 offset:20480
    ds_read_b64_tr_b16 v[70:71], v5 offset:22528
    ds_read_b64_tr_b16 v[72:73], v6 offset:20480
    ds_read_b64_tr_b16 v[74:75], v6 offset:22528
    ds_read_b64_tr_b16 v[76:77], v7 offset:20480
    ds_read_b64_tr_b16 v[78:79], v7 offset:22528
    s_waitcnt vmcnt(11) lgkmcnt(14)
    v_mfma_f32_16x16x32_bf16 v[16:19], a[56:59], v[48:51], v[16:19]
    s_waitcnt vmcnt(10)
    v_mfma_f32_16x16x32_bf16 v[32:35], a[136:139], v[48:51], v[32:35]
    s_waitcnt lgkmcnt(12)
    v_mfma_f32_16x16x32_bf16 v[20:23], a[56:59], v[52:55], v[20:23]
    v_mfma_f32_16x16x32_bf16 v[36:39], a[136:139], v[52:55], v[36:39]
    s_waitcnt lgkmcnt(10)
    v_mfma_f32_16x16x32_bf16 v[24:27], a[56:59], v[56:59], v[24:27]
    v_mfma_f32_16x16x32_bf16 v[40:43], a[136:139], v[56:59], v[40:43]
    s_waitcnt lgkmcnt(8)
    v_mfma_f32_16x16x32_bf16 v[28:31], a[56:59], v[60:63], v[28:31]
    v_mfma_f32_16x16x32_bf16 v[44:47], a[136:139], v[60:63], v[44:47]
    ds_read_b64_tr_b16 v[48:49], v4 offset:24576
    ds_read_b64_tr_b16 v[50:51], v4 offset:26624
    ds_read_b64_tr_b16 v[52:53], v5 offset:24576
    ds_read_b64_tr_b16 v[54:55], v5 offset:26624
    ds_read_b64_tr_b16 v[56:57], v6 offset:24576
    ds_read_b64_tr_b16 v[58:59], v6 offset:26624
    ds_read_b64_tr_b16 v[60:61], v7 offset:24576
    ds_read_b64_tr_b16 v[62:63], v7 offset:26624
    s_waitcnt vmcnt(9) lgkmcnt(14)
    v_mfma_f32_16x16x32_bf16 v[16:19], a[60:63], v[64:67], v[16:19]
    s_waitcnt vmcnt(8)
    v_mfma_f32_16x16x32_bf16 v[32:35], a[140:143], v[64:67], v[32:35]
    s_waitcnt lgkmcnt(12)
    v_mfma_f32_16x16x32_bf16 v[20:23], a[60:63], v[68:71], v[20:23]
    v_mfma_f32_16x16x32_bf16 v[36:39], a[140:143], v[68:71], v[36:39]
    s_waitcnt lgkmcnt(10)
    v_mfma_f32_16x16x32_bf16 v[24:27], a[60:63], v[72:75], v[24:27]
    v_mfma_f32_16x16x32_bf16 v[40:43], a[140:143], v[72:75], v[40:43]
    s_waitcnt lgkmcnt(8)
    v_mfma_f32_16x16x32_bf16 v[28:31], a[60:63], v[76:79], v[28:31]
    v_mfma_f32_16x16x32_bf16 v[44:47], a[140:143], v[76:79], v[44:47]
    ds_read_b64_tr_b16 v[64:65], v4 offset:28672
    ds_read_b64_tr_b16 v[66:67], v4 offset:30720
    ds_read_b64_tr_b16 v[68:69], v5 offset:28672
    ds_read_b64_tr_b16 v[70:71], v5 offset:30720
    ds_read_b64_tr_b16 v[72:73], v6 offset:28672
    ds_read_b64_tr_b16 v[74:75], v6 offset:30720
    ds_read_b64_tr_b16 v[76:77], v7 offset:28672
    ds_read_b64_tr_b16 v[78:79], v7 offset:30720
    s_waitcnt vmcnt(7) lgkmcnt(14)
    v_mfma_f32_16x16x32_bf16 v[16:19], a[64:67], v[48:51], v[16:19]
    s_waitcnt vmcnt(6)
    v_mfma_f32_16x16x32_bf16 v[32:35], a[144:147], v[48:51], v[32:35]
    s_waitcnt lgkmcnt(12)
    v_mfma_f32_16x16x32_bf16 v[20:23], a[64:67], v[52:55], v[20:23]
    v_mfma_f32_16x16x32_bf16 v[36:39], a[144:147], v[52:55], v[36:39]
    s_waitcnt lgkmcnt(10)
    v_mfma_f32_16x16x32_bf16 v[24:27], a[64:67], v[56:59], v[24:27]
    v_mfma_f32_16x16x32_bf16 v[40:43], a[144:147], v[56:59], v[40:43]
    s_waitcnt lgkmcnt(8)
    v_mfma_f32_16x16x32_bf16 v[28:31], a[64:67], v[60:63], v[28:31]
    v_mfma_f32_16x16x32_bf16 v[44:47], a[144:147], v[60:63], v[44:47]
    ds_read_b64_tr_b16 v[48:49], v4 offset:32768
    ds_read_b64_tr_b16 v[50:51], v4 offset:34816
    ds_read_b64_tr_b16 v[52:53], v5 offset:32768
    ds_read_b64_tr_b16 v[54:55], v5 offset:34816
    ds_read_b64_tr_b16 v[56:57], v6 offset:32768
    ds_read_b64_tr_b16 v[58:59], v6 offset:34816
    ds_read_b64_tr_b16 v[60:61], v7 offset:32768
    ds_read_b64_tr_b16 v[62:63], v7 offset:34816
    s_waitcnt vmcnt(5) lgkmcnt(14)
    v_mfma_f32_16x16x32_bf16 v[16:19], a[68:71], v[64:67], v[16:19]
    s_waitcnt vmcnt(4)
    v_mfma_f32_16x16x32_bf16 v[32:35], a[148:151], v[64:67], v[32:35]
    s_waitcnt lgkmcnt(12)
    v_mfma_f32_16x16x32_bf16 v[20:23], a[68:71], v[68:71], v[20:23]
    v_mfma_f32_16x16x32_bf16 v[36:39], a[148:151], v[68:71], v[36:39]
    s_waitcnt lgkmcnt(10)
    v_mfma_f32_16x16x32_bf16 v[24:27], a[68:71], v[72:75], v[24:27]
    v_mfma_f32_16x16x32_bf16 v[40:43], a[148:151], v[72:75], v[40:43]
    s_waitcnt lgkmcnt(8)
    v_mfma_f32_16x16x32_bf16 v[28:31], a[68:71], v[76:79], v[28:31]
    v_mfma_f32_16x16x32_bf16 v[44:47], a[148:151], v[76:79], v[44:47]
    ds_read_b64_tr_b16 v[64:65], v4 offset:36864
    ds_read_b64_tr_b16 v[66:67], v4 offset:38912
    ds_read_b64_tr_b16 v[68:69], v5 offset:36864
    ds_read_b64_tr_b16 v[70:71], v5 offset:38912
    ds_read_b64_tr_b16 v[72:73], v6 offset:36864
    ds_read_b64_tr_b16 v[74:75], v6 offset:38912
    ds_read_b64_tr_b16 v[76:77], v7 offset:36864
    ds_read_b64_tr_b16 v[78:79], v7 offset:38912
    s_waitcnt vmcnt(3) lgkmcnt(14)
    v_mfma_f32_16x16x32_bf16 v[16:19], a[72:75], v[48:51], v[16:19]
    s_waitcnt vmcnt(2)
    v_mfma_f32_16x16x32_bf16 v[32:35], a[152:155], v[48:51], v[32:35]
    s_waitcnt lgkmcnt(12)
    v_mfma_f32_16x16x32_bf16 v[20:23], a[72:75], v[52:55], v[20:23]
    v_mfma_f32_16x16x32_bf16 v[36:39], a[152:155], v[52:55], v[36:39]
    s_waitcnt lgkmcnt(10)
    v_mfma_f32_16x16x32_bf16 v[24:27], a[72:75], v[56:59], v[24:27]
    v_mfma_f32_16x16x32_bf16 v[40:43], a[152:155], v[56:59], v[40:43]
    s_waitcnt lgkmcnt(8)
    v_mfma_f32_16x16x32_bf16 v[28:31], a[72:75], v[60:63], v[28:31]
    v_mfma_f32_16x16x32_bf16 v[44:47], a[152:155], v[60:63], v[44:47]
    s_waitcnt vmcnt(1) lgkmcnt(6)
    v_mfma_f32_16x16x32_bf16 v[16:19], a[76:79], v[64:67], v[16:19]
    s_waitcnt vmcnt(0)
    v_mfma_f32_16x16x32_bf16 v[32:35], a[156:159], v[64:67], v[32:35]
    s_waitcnt lgkmcnt(4)
    v_mfma_f32_16x16x32_bf16 v[20:23], a[76:79], v[68:71], v[20:23]
    v_mfma_f32_16x16x32_bf16 v[36:39], a[156:159], v[68:71], v[36:39]
    s_waitcnt lgkmcnt(2)
    v_mfma_f32_16x16x32_bf16 v[24:27], a[76:79], v[72:75], v[24:27]
    v_mfma_f32_16x16x32_bf16 v[40:43], a[156:159], v[72:75], v[40:43]
    s_waitcnt lgkmcnt(0)
    v_mfma_f32_16x16x32_bf16 v[28:31], a[76:79], v[76:79], v[28:31]
    v_mfma_f32_16x16x32_bf16 v[44:47], a[156:159], v[76:79], v[44:47]
    s_barrier
    s_cmp_eq_u32 s36, 3
    s_cselect_b32 s39, 6, 99
    s_cmp_eq_u32 s37, s39
    s_cbranch_scc1 k2_exit
    v_and_b32 v8, 15, v0
    v_bfe_u32 v9, v0, 4, 2
    v_mov_b32 v15, 0xc0135761
    s_mov_b32 s31, 0xbdd2d3e8
    v_lshlrev_b32 v10, 2, v8
    ds_read_b32 v48, v10 offset:2048
    ds_read_b32 v52, v10 offset:2304
    ds_read_b32 v49, v10 offset:2112
    ds_read_b32 v53, v10 offset:2368
    ds_read_b32 v50, v10 offset:2176
    ds_read_b32 v54, v10 offset:2432
    ds_read_b32 v51, v10 offset:2240
    ds_read_b32 v55, v10 offset:2496
    v_lshlrev_b32 v11, 4, v9
    s_lshl_b32 s27, s26, 2
    v_add_u32 v11, s27, v11
    ds_read_b128 v[56:59], v11 offset:0
    ds_read_b128 v[60:63], v11 offset:1024
    ds_read_b128 v[64:67], v11 offset:64
    ds_read_b128 v[68:71], v11 offset:1088
    v_and_b32 v10, 63, v0
    v_lshlrev_b32 v10, 4, v10
    v_lshrrev_b32 v12, 1, v10
    s_lshl_b32 s27, s37, 12
    v_add_u32 v12, s27, v12
    s_lshr_b32 s27, s24, 1
    s_lshl_b32 s27, s27, 7
    s_lshl_b32 s28, s25, 2
    s_add_u32 s27, s27, s28
    s_lshl_b32 s27, s27, 10
    s_add_u32 s28, s27, 65536
    v_mov_b32 v14, 0xbdd2d3e8
    s_waitcnt lgkmcnt(3)
    v_pk_fma_f32 v[16:17], v[48:49], v[56:57], v[16:17] op_sel:[0,0,0] op_sel_hi:[0,1,1] neg_lo:[1,0,0] neg_hi:[1,0,0]
    v_pk_fma_f32 v[18:19], v[48:49], v[58:59], v[18:19] op_sel:[0,0,0] op_sel_hi:[0,1,1] neg_lo:[1,0,0] neg_hi:[1,0,0]
    s_waitcnt lgkmcnt(1)
    v_pk_fma_f32 v[32:33], v[48:49], v[64:65], v[32:33] op_sel:[0,0,0] op_sel_hi:[0,1,1] neg_lo:[1,0,0] neg_hi:[1,0,0]
    v_pk_fma_f32 v[34:35], v[48:49], v[66:67], v[34:35] op_sel:[0,0,0] op_sel_hi:[0,1,1] neg_lo:[1,0,0] neg_hi:[1,0,0]
    v_pk_fma_f32 v[16:17], v[16:17], v[52:53], v[60:61] op_sel:[0,0,0] op_sel_hi:[1,0,1]
    v_pk_fma_f32 v[18:19], v[18:19], v[52:53], v[62:63] op_sel:[0,0,0] op_sel_hi:[1,0,1]
    s_waitcnt lgkmcnt(0)
    v_pk_fma_f32 v[32:33], v[32:33], v[52:53], v[68:69] op_sel:[0,0,0] op_sel_hi:[1,0,1]
    v_pk_fma_f32 v[34:35], v[34:35], v[52:53], v[70:71] op_sel:[0,0,0] op_sel_hi:[1,0,1]
    v_pk_mul_f32 v[80:81], v[16:17], v[16:17]
    v_pk_mul_f32 v[82:83], v[18:19], v[18:19]
    v_pk_mul_f32 v[84:85], v[32:33], v[32:33]
    v_pk_mul_f32 v[86:87], v[34:35], v[34:35]
    v_pk_fma_f32 v[80:81], v[80:81], v[14:15], v[14:15] op_sel:[0,0,1] op_sel_hi:[1,0,1]
    v_pk_fma_f32 v[82:83], v[82:83], v[14:15], v[14:15] op_sel:[0,0,1] op_sel_hi:[1,0,1]
    v_pk_fma_f32 v[84:85], v[84:85], v[14:15], v[14:15] op_sel:[0,0,1] op_sel_hi:[1,0,1]
    v_pk_fma_f32 v[86:87], v[86:87], v[14:15], v[14:15] op_sel:[0,0,1] op_sel_hi:[1,0,1]
    v_pk_mul_f32 v[80:81], v[80:81], v[16:17]
    v_pk_mul_f32 v[82:83], v[82:83], v[18:19]
    v_pk_mul_f32 v[84:85], v[84:85], v[32:33]
    v_pk_mul_f32 v[86:87], v[86:87], v[34:35]
    v_exp_f32 v80, v80
    v_exp_f32 v81, v81
    v_exp_f32 v82, v82
    v_exp_f32 v83, v83
    v_exp_f32 v84, v84
    v_exp_f32 v85, v85
    v_exp_f32 v86, v86
    v_exp_f32 v87, v87
    v_pk_add_f32 v[80:81], v[80:81], 1.0 op_sel_hi:[1,0]
    v_pk_add_f32 v[82:83], v[82:83], 1.0 op_sel_hi:[1,0]
    v_pk_add_f32 v[84:85], v[84:85], 1.0 op_sel_hi:[1,0]
    v_pk_add_f32 v[86:87], v[86:87], 1.0 op_sel_hi:[1,0]
    v_rcp_f32 v80, v80
    v_rcp_f32 v81, v81
    v_rcp_f32 v82, v82
    v_rcp_f32 v83, v83
    v_rcp_f32 v84, v84
    v_rcp_f32 v85, v85
    v_rcp_f32 v86, v86
    v_rcp_f32 v87, v87
    v_pk_mul_f32 v[16:17], v[16:17], v[80:81]
    v_pk_mul_f32 v[18:19], v[18:19], v[82:83]
    v_pk_mul_f32 v[32:33], v[32:33], v[84:85]
    v_pk_mul_f32 v[34:35], v[34:35], v[86:87]
    v_cvt_pk_bf16_f32 v88, v16, v17
    v_cvt_pk_bf16_f32 v89, v18, v19
    v_cvt_pk_bf16_f32 v90, v32, v33
    v_cvt_pk_bf16_f32 v91, v34, v35
    buffer_store_dwordx4 v[88:91], v10, s[16:19], s27 offen offset:0 sc1
    v_pk_fma_f32 v[20:21], v[48:49], v[56:57], v[20:21] op_sel:[1,0,0] op_sel_hi:[1,1,1] neg_lo:[1,0,0] neg_hi:[1,0,0]
    v_pk_fma_f32 v[22:23], v[48:49], v[58:59], v[22:23] op_sel:[1,0,0] op_sel_hi:[1,1,1] neg_lo:[1,0,0] neg_hi:[1,0,0]
    v_pk_fma_f32 v[36:37], v[48:49], v[64:65], v[36:37] op_sel:[1,0,0] op_sel_hi:[1,1,1] neg_lo:[1,0,0] neg_hi:[1,0,0]
    v_pk_fma_f32 v[38:39], v[48:49], v[66:67], v[38:39] op_sel:[1,0,0] op_sel_hi:[1,1,1] neg_lo:[1,0,0] neg_hi:[1,0,0]
    v_pk_fma_f32 v[20:21], v[20:21], v[52:53], v[60:61] op_sel:[0,1,0] op_sel_hi:[1,1,1]
    v_pk_fma_f32 v[22:23], v[22:23], v[52:53], v[62:63] op_sel:[0,1,0] op_sel_hi:[1,1,1]
    v_pk_fma_f32 v[36:37], v[36:37], v[52:53], v[68:69] op_sel:[0,1,0] op_sel_hi:[1,1,1]
    v_pk_fma_f32 v[38:39], v[38:39], v[52:53], v[70:71] op_sel:[0,1,0] op_sel_hi:[1,1,1]
    v_pk_mul_f32 v[80:81], v[20:21], v[20:21]
    v_pk_mul_f32 v[82:83], v[22:23], v[22:23]
    v_pk_mul_f32 v[84:85], v[36:37], v[36:37]
    v_pk_mul_f32 v[86:87], v[38:39], v[38:39]
    v_pk_fma_f32 v[80:81], v[80:81], v[14:15], v[14:15] op_sel:[0,0,1] op_sel_hi:[1,0,1]
    v_pk_fma_f32 v[82:83], v[82:83], v[14:15], v[14:15] op_sel:[0,0,1] op_sel_hi:[1,0,1]
    v_pk_fma_f32 v[84:85], v[84:85], v[14:15], v[14:15] op_sel:[0,0,1] op_sel_hi:[1,0,1]
    v_pk_fma_f32 v[86:87], v[86:87], v[14:15], v[14:15] op_sel:[0,0,1] op_sel_hi:[1,0,1]
    v_pk_mul_f32 v[80:81], v[80:81], v[20:21]
    v_pk_mul_f32 v[82:83], v[82:83], v[22:23]
    v_pk_mul_f32 v[84:85], v[84:85], v[36:37]
    v_pk_mul_f32 v[86:87], v[86:87], v[38:39]
    v_exp_f32 v80, v80
    v_exp_f32 v81, v81
    v_exp_f32 v82, v82
    v_exp_f32 v83, v83
    v_exp_f32 v84, v84
    v_exp_f32 v85, v85
    v_exp_f32 v86, v86
    v_exp_f32 v87, v87
    v_pk_add_f32 v[80:81], v[80:81], 1.0 op_sel_hi:[1,0]
    v_pk_add_f32 v[82:83], v[82:83], 1.0 op_sel_hi:[1,0]
    v_pk_add_f32 v[84:85], v[84:85], 1.0 op_sel_hi:[1,0]
    v_pk_add_f32 v[86:87], v[86:87], 1.0 op_sel_hi:[1,0]
    v_rcp_f32 v80, v80
    v_rcp_f32 v81, v81
    v_rcp_f32 v82, v82
    v_rcp_f32 v83, v83
    v_rcp_f32 v84, v84
    v_rcp_f32 v85, v85
    v_rcp_f32 v86, v86
    v_rcp_f32 v87, v87
    v_pk_mul_f32 v[20:21], v[20:21], v[80:81]
    v_pk_mul_f32 v[22:23], v[22:23], v[82:83]
    v_pk_mul_f32 v[36:37], v[36:37], v[84:85]
    v_pk_mul_f32 v[38:39], v[38:39], v[86:87]
    v_cvt_pk_bf16_f32 v92, v20, v21
    v_cvt_pk_bf16_f32 v93, v22, v23
    v_cvt_pk_bf16_f32 v94, v36, v37
    v_cvt_pk_bf16_f32 v95, v38, v39
    buffer_store_dwordx4 v[92:95], v10, s[16:19], s27 offen offset:1024 sc1
    v_pk_fma_f32 v[24:25], v[50:51], v[56:57], v[24:25] op_sel:[0,0,0] op_sel_hi:[0,1,1] neg_lo:[1,0,0] neg_hi:[1,0,0]
    v_pk_fma_f32 v[26:27], v[50:51], v[58:59], v[26:27] op_sel:[0,0,0] op_sel_hi:[0,1,1] neg_lo:[1,0,0] neg_hi:[1,0,0]
    v_pk_fma_f32 v[40:41], v[50:51], v[64:65], v[40:41] op_sel:[0,0,0] op_sel_hi:[0,1,1] neg_lo:[1,0,0] neg_hi:[1,0,0]
    v_pk_fma_f32 v[42:43], v[50:51], v[66:67], v[42:43] op_sel:[0,0,0] op_sel_hi:[0,1,1] neg_lo:[1,0,0] neg_hi:[1,0,0]
    v_pk_fma_f32 v[24:25], v[24:25], v[54:55], v[60:61] op_sel:[0,0,0] op_sel_hi:[1,0,1]
    v_pk_fma_f32 v[26:27], v[26:27], v[54:55], v[62:63] op_sel:[0,0,0] op_sel_hi:[1,0,1]
    v_pk_fma_f32 v[40:41], v[40:41], v[54:55], v[68:69] op_sel:[0,0,0] op_sel_hi:[1,0,1]
    v_pk_fma_f32 v[42:43], v[42:43], v[54:55], v[70:71] op_sel:[0,0,0] op_sel_hi:[1,0,1]
    v_pk_mul_f32 v[80:81], v[24:25], v[24:25]
    v_pk_mul_f32 v[82:83], v[26:27], v[26:27]
    v_pk_mul_f32 v[84:85], v[40:41], v[40:41]
    v_pk_mul_f32 v[86:87], v[42:43], v[42:43]
    v_pk_fma_f32 v[80:81], v[80:81], v[14:15], v[14:15] op_sel:[0,0,1] op_sel_hi:[1,0,1]
    v_pk_fma_f32 v[82:83], v[82:83], v[14:15], v[14:15] op_sel:[0,0,1] op_sel_hi:[1,0,1]
    v_pk_fma_f32 v[84:85], v[84:85], v[14:15], v[14:15] op_sel:[0,0,1] op_sel_hi:[1,0,1]
    v_pk_fma_f32 v[86:87], v[86:87], v[14:15], v[14:15] op_sel:[0,0,1] op_sel_hi:[1,0,1]
    v_pk_mul_f32 v[80:81], v[80:81], v[24:25]
    v_pk_mul_f32 v[82:83], v[82:83], v[26:27]
    v_pk_mul_f32 v[84:85], v[84:85], v[40:41]
    v_pk_mul_f32 v[86:87], v[86:87], v[42:43]
    v_exp_f32 v80, v80
    v_exp_f32 v81, v81
    v_exp_f32 v82, v82
    v_exp_f32 v83, v83
    v_exp_f32 v84, v84
    v_exp_f32 v85, v85
    v_exp_f32 v86, v86
    v_exp_f32 v87, v87
    v_pk_add_f32 v[80:81], v[80:81], 1.0 op_sel_hi:[1,0]
    v_pk_add_f32 v[82:83], v[82:83], 1.0 op_sel_hi:[1,0]
    v_pk_add_f32 v[84:85], v[84:85], 1.0 op_sel_hi:[1,0]
    v_pk_add_f32 v[86:87], v[86:87], 1.0 op_sel_hi:[1,0]
    v_rcp_f32 v80, v80
    v_rcp_f32 v81, v81
    v_rcp_f32 v82, v82
    v_rcp_f32 v83, v83
    v_rcp_f32 v84, v84
    v_rcp_f32 v85, v85
    v_rcp_f32 v86, v86
    v_rcp_f32 v87, v87
    v_pk_mul_f32 v[24:25], v[24:25], v[80:81]
    v_pk_mul_f32 v[26:27], v[26:27], v[82:83]
    v_pk_mul_f32 v[40:41], v[40:41], v[84:85]
    v_pk_mul_f32 v[42:43], v[42:43], v[86:87]
    v_cvt_pk_bf16_f32 v88, v24, v25
    v_cvt_pk_bf16_f32 v89, v26, v27
    v_cvt_pk_bf16_f32 v90, v40, v41
    v_cvt_pk_bf16_f32 v91, v42, v43
    buffer_store_dwordx4 v[88:91], v10, s[16:19], s27 offen offset:2048 sc1
    v_pk_fma_f32 v[28:29], v[50:51], v[56:57], v[28:29] op_sel:[1,0,0] op_sel_hi:[1,1,1] neg_lo:[1,0,0] neg_hi:[1,0,0]
    v_pk_fma_f32 v[30:31], v[50:51], v[58:59], v[30:31] op_sel:[1,0,0] op_sel_hi:[1,1,1] neg_lo:[1,0,0] neg_hi:[1,0,0]
    v_pk_fma_f32 v[44:45], v[50:51], v[64:65], v[44:45] op_sel:[1,0,0] op_sel_hi:[1,1,1] neg_lo:[1,0,0] neg_hi:[1,0,0]
    v_pk_fma_f32 v[46:47], v[50:51], v[66:67], v[46:47] op_sel:[1,0,0] op_sel_hi:[1,1,1] neg_lo:[1,0,0] neg_hi:[1,0,0]
    v_pk_fma_f32 v[28:29], v[28:29], v[54:55], v[60:61] op_sel:[0,1,0] op_sel_hi:[1,1,1]
    v_pk_fma_f32 v[30:31], v[30:31], v[54:55], v[62:63] op_sel:[0,1,0] op_sel_hi:[1,1,1]
    v_pk_fma_f32 v[44:45], v[44:45], v[54:55], v[68:69] op_sel:[0,1,0] op_sel_hi:[1,1,1]
    v_pk_fma_f32 v[46:47], v[46:47], v[54:55], v[70:71] op_sel:[0,1,0] op_sel_hi:[1,1,1]
    v_pk_mul_f32 v[80:81], v[28:29], v[28:29]
    v_pk_mul_f32 v[82:83], v[30:31], v[30:31]
    v_pk_mul_f32 v[84:85], v[44:45], v[44:45]
    v_pk_mul_f32 v[86:87], v[46:47], v[46:47]
    v_pk_fma_f32 v[80:81], v[80:81], v[14:15], v[14:15] op_sel:[0,0,1] op_sel_hi:[1,0,1]
    v_pk_fma_f32 v[82:83], v[82:83], v[14:15], v[14:15] op_sel:[0,0,1] op_sel_hi:[1,0,1]
    v_pk_fma_f32 v[84:85], v[84:85], v[14:15], v[14:15] op_sel:[0,0,1] op_sel_hi:[1,0,1]
    v_pk_fma_f32 v[86:87], v[86:87], v[14:15], v[14:15] op_sel:[0,0,1] op_sel_hi:[1,0,1]
    v_pk_mul_f32 v[80:81], v[80:81], v[28:29]
    v_pk_mul_f32 v[82:83], v[82:83], v[30:31]
    v_pk_mul_f32 v[84:85], v[84:85], v[44:45]
    v_pk_mul_f32 v[86:87], v[86:87], v[46:47]
    v_exp_f32 v80, v80
    v_exp_f32 v81, v81
    v_exp_f32 v82, v82
    v_exp_f32 v83, v83
    v_exp_f32 v84, v84
    v_exp_f32 v85, v85
    v_exp_f32 v86, v86
    v_exp_f32 v87, v87
    v_pk_add_f32 v[80:81], v[80:81], 1.0 op_sel_hi:[1,0]
    v_pk_add_f32 v[82:83], v[82:83], 1.0 op_sel_hi:[1,0]
    v_pk_add_f32 v[84:85], v[84:85], 1.0 op_sel_hi:[1,0]
    v_pk_add_f32 v[86:87], v[86:87], 1.0 op_sel_hi:[1,0]
    v_rcp_f32 v80, v80
    v_rcp_f32 v81, v81
    v_rcp_f32 v82, v82
    v_rcp_f32 v83, v83
    v_rcp_f32 v84, v84
    v_rcp_f32 v85, v85
    v_rcp_f32 v86, v86
    v_rcp_f32 v87, v87
    v_pk_mul_f32 v[28:29], v[28:29], v[80:81]
    v_pk_mul_f32 v[30:31], v[30:31], v[82:83]
    v_pk_mul_f32 v[44:45], v[44:45], v[84:85]
    v_pk_mul_f32 v[46:47], v[46:47], v[86:87]
    v_cvt_pk_bf16_f32 v92, v28, v29
    v_cvt_pk_bf16_f32 v93, v30, v31
    v_cvt_pk_bf16_f32 v94, v44, v45
    v_cvt_pk_bf16_f32 v95, v46, v47
    buffer_store_dwordx4 v[92:95], v10, s[16:19], s27 offen offset:3072 sc1
    s_endpgm
k2_z2:
    s_nop 7
    s_nop 7
    s_add_u32 s16, s4, 15060992
    s_addc_u32 s17, s5, 0
    s_and_b32 s17, s17, 0xffff
    s_mov_b32 s18, 3538944
    s_mov_b32 s19, 0x20000
    s_add_u32 m0, s20, 0
    s_add_u32 s29, s21, 0
    buffer_load_dwordx4 v1, s[8:11], s29 offen lds
    s_add_u32 s29, s22, 0
    buffer_load_dwordx4 a[0:3], v2, s[12:15], s29 offen offset:0
    s_add_u32 s29, s23, 0
    buffer_load_dwordx4 a[80:83], v2, s[12:15], s29 offen offset:0
    s_add_u32 s29, s22, 0
    buffer_load_dwordx4 a[4:7], v2, s[12:15], s29 offen offset:1024
    s_add_u32 s29, s23, 0
    buffer_load_dwordx4 a[84:87], v2, s[12:15], s29 offen offset:1024
    s_add_u32 m0, s20, 8192
    s_add_u32 s29, s21, 262144
    buffer_load_dwordx4 v1, s[8:11], s29 offen lds
    s_add_u32 s29, s22, 0
    buffer_load_dwordx4 a[8:11], v2, s[12:15], s29 offen offset:2048
    s_add_u32 s29, s23, 0
    buffer_load_dwordx4 a[88:91], v2, s[12:15], s29 offen offset:2048
    s_add_u32 s29, s22, 0
    buffer_load_dwordx4 a[12:15], v2, s[12:15], s29 offen offset:3072
    s_add_u32 s29, s23, 0
    buffer_load_dwordx4 a[92:95], v2, s[12:15], s29 offen offset:3072
    s_add_u32 m0, s20, 16384
    s_add_u32 s29, s21, 524288
    buffer_load_dwordx4 v1, s[8:11], s29 offen lds
    s_add_u32 m0, s20, 24576
    s_add_u32 s29, s21, 786432
    buffer_load_dwordx4 v1, s[8:11], s29 offen lds
    s_add_u32 s29, s22, 4096
    buffer_load_dwordx4 a[16:19], v2, s[12:15], s29 offen offset:0
    s_add_u32 s29, s23, 4096
    buffer_load_dwordx4 a[96:99], v2, s[12:15], s29 offen offset:0
    s_add_u32 s29, s22, 4096
    buffer_load_dwordx4 a[20:23], v2, s[12:15], s29 offen offset:1024
    s_add_u32 s29, s23, 4096
    buffer_load_dwordx4 a[100:103], v2, s[12:15], s29 offen offset:1024
    s_mov_b32 s29, 0
    buffer_load_dword v80, v3, s[40:43], s29 offen
    s_mov_b32 s29, 13824
    buffer_load_dword v81, v3, s[40:43], s29 offen
    s_mov_b32 s29, 27648
    buffer_load_dword v82, v3, s[40:43], s29 offen
    s_mov_b32 s29, 41472
    buffer_load_dword v83, v3, s[40:43], s29 offen
    s_waitcnt vmcnt(19)
    s_barrier
    ds_read_b64_tr_b16 v[48:49], v4 offset:0
    ds_read_b64_tr_b16 v[50:51], v4 offset:2048
    ds_read_b64_tr_b16 v[52:53], v5 offset:0
    ds_read_b64_tr_b16 v[54:55], v5 offset:2048
    ds_read_b64_tr_b16 v[56:57], v6 offset:0
    ds_read_b64_tr_b16 v[58:59], v6 offset:2048
    ds_read_b64_tr_b16 v[60:61], v7 offset:0
    ds_read_b64_tr_b16 v[62:63], v7 offset:2048
    s_add_u32 m0, s20, 32768
    s_add_u32 s29, s21, 1048576
    buffer_load_dwordx4 v1, s[8:11], s29 offen lds
    s_add_u32 m0, s20, 40960
    s_add_u32 s29, s21, 1310720
    buffer_load_dwordx4 v1, s[8:11], s29 offen lds
    s_add_u32 s29, s22, 4096
    buffer_load_dwordx4 a[24:27], v2, s[12:15], s29 offen offset:2048
    ds_read_b64_tr_b16 v[64:65], v4 offset:4096
    ds_read_b64_tr_b16 v[66:67], v4 offset:6144
    ds_read_b64_tr_b16 v[68:69], v5 offset:4096
    ds_read_b64_tr_b16 v[70:71], v5 offset:6144
    ds_read_b64_tr_b16 v[72:73], v6 offset:4096
    ds_read_b64_tr_b16 v[74:75], v6 offset:6144
    ds_read_b64_tr_b16 v[76:77], v7 offset:4096
    ds_read_b64_tr_b16 v[78:79], v7 offset:6144
    s_waitcnt vmcnt(21) lgkmcnt(14)
    v_mfma_f32_16x16x32_bf16 v[16:19], v[48:51], a[0:3], 0
    s_waitcnt vmcnt(20)
    v_mfma_f32_16x16x32_bf16 v[32:35], v[48:51], a[80:83], 0
    s_waitcnt lgkmcnt(12)
    v_mfma_f32_16x16x32_bf16 v[20:23], v[52:55], a[0:3], 0
    s_add_u32 s29, s23, 4096
    buffer_load_dwordx4 a[104:107], v2, s[12:15], s29 offen offset:2048
    v_mfma_f32_16x16x32_bf16 v[36:39], v[52:55], a[80:83], 0
    s_waitcnt lgkmcnt(10)
    v_mfma_f32_16x16x32_bf16 v[24:27], v[56:59], a[0:3], 0
    v_mfma_f32_16x16x32_bf16 v[40:43], v[56:59], a[80:83], 0
    s_add_u32 s29, s22, 4096
    buffer_load_dwordx4 a[28:31], v2, s[12:15], s29 offen offset:3072
    s_waitcnt lgkmcnt(8)
    v_mfma_f32_16x16x32_bf16 v[28:31], v[60:63], a[0:3], 0
    v_mfma_f32_16x16x32_bf16 v[44:47], v[60:63], a[80:83], 0
    s_add_u32 s29, s23, 4096
    buffer_load_dwordx4 a[108:111], v2, s[12:15], s29 offen offset:3072
    s_waitcnt vmcnt(20)
    s_barrier
    ds_read_b64_tr_b16 v[48:49], v4 offset:8192
    ds_read_b64_tr_b16 v[50:51], v4 offset:10240
    ds_read_b64_tr_b16 v[52:53], v5 offset:8192
    ds_read_b64_tr_b16 v[54:55], v5 offset:10240
    ds_read_b64_tr_b16 v[56:57], v6 offset:8192
    ds_read_b64_tr_b16 v[58:59], v6 offset:10240
    ds_read_b64_tr_b16 v[60:61], v7 offset:8192
    ds_read_b64_tr_b16 v[62:63], v7 offset:10240
    s_waitcnt lgkmcnt(14)
    v_mfma_f32_16x16x32_bf16 v[16:19], v[64:67], a[4:7], v[16:19]
    v_mfma_f32_16x16x32_bf16 v[32:35], v[64:67], a[84:87], v[32:35]
    s_waitcnt lgkmcnt(12)
    v_mfma_f32_16x16x32_bf16 v[20:23], v[68:71], a[4:7], v[20:23]
    s_add_u32 m0, s20, 49152
    s_add_u32 s29, s21, 1572864
    buffer_load_dwordx4 v1, s[8:11], s29 offen lds
    v_mfma_f32_16x16x32_bf16 v[36:39], v[68:71], a[84:87], v[36:39]
    s_waitcnt lgkmcnt(10)
    v_mfma_f32_16x16x32_bf16 v[24:27], v[72:75], a[4:7], v[24:27]
    v_mfma_f32_16x16x32_bf16 v[40:43], v[72:75], a[84:87], v[40:43]
    s_add_u32 m0, s20, 57344
    s_add_u32 s29, s21, 1835008
    buffer_load_dwordx4 v1, s[8:11], s29 offen lds
    s_waitcnt lgkmcnt(8)
    v_mfma_f32_16x16x32_bf16 v[28:31], v[76:79], a[4:7], v[28:31]
    v_mfma_f32_16x16x32_bf16 v[44:47], v[76:79], a[84:87], v[44:47]
    s_add_u32 s29, s22, 8192
    buffer_load_dwordx4 a[32:35], v2, s[12:15], s29 offen offset:0
    ds_read_b64_tr_b16 v[64:65], v4 offset:12288
    ds_read_b64_tr_b16 v[66:67], v4 offset:14336
    ds_read_b64_tr_b16 v[68:69], v5 offset:12288
    ds_read_b64_tr_b16 v[70:71], v5 offset:14336
    ds_read_b64_tr_b16 v[72:73], v6 offset:12288
    ds_read_b64_tr_b16 v[74:75], v6 offset:14336
    ds_read_b64_tr_b16 v[76:77], v7 offset:12288
    ds_read_b64_tr_b16 v[78:79], v7 offset:14336
    s_waitcnt vmcnt(22) lgkmcnt(14)
    v_mfma_f32_16x16x32_bf16 v[16:19], v[48:51], a[8:11], v[16:19]
    s_waitcnt vmcnt(21)
    v_mfma_f32_16x16x32_bf16 v[32:35], v[48:51], a[88:91], v[32:35]
    s_waitcnt lgkmcnt(12)
    v_mfma_f32_16x16x32_bf16 v[20:23], v[52:55], a[8:11], v[20:23]
    s_add_u32 s29, s23, 8192
    buffer_load_dwordx4 a[112:115], v2, s[12:15], s29 offen offset:0
    v_mfma_f32_16x16x32_bf16 v[36:39], v[52:55], a[88:91], v[36:39]
    s_waitcnt lgkmcnt(10)
    v_mfma_f32_16x16x32_bf16 v[24:27], v[56:59], a[8:11], v[24:27]
    v_mfma_f32_16x16x32_bf16 v[40:43], v[56:59], a[88:91], v[40:43]
    s_add_u32 s29, s22, 8192
    buffer_load_dwordx4 a[36:39], v2, s[12:15], s29 offen offset:1024
    s_waitcnt lgkmcnt(8)
    v_mfma_f32_16x16x32_bf16 v[28:31], v[60:63], a[8:11], v[28:31]
    v_mfma_f32_16x16x32_bf16 v[44:47], v[60:63], a[88:91], v[44:47]
    s_add_u32 s29, s23, 8192
    buffer_load_dwordx4 a[116:119], v2, s[12:15], s29 offen offset:1024
    s_waitcnt vmcnt(20)
    s_barrier
    ds_read_b64_tr_b16 v[48:49], v4 offset:16384
    ds_read_b64_tr_b16 v[50:51], v4 offset:18432
    ds_read_b64_tr_b16 v[52:53], v5 offset:16384
    ds_read_b64_tr_b16 v[54:55], v5 offset:18432
    ds_read_b64_tr_b16 v[56:57], v6 offset:16384
    ds_read_b64_tr_b16 v[58:59], v6 offset:18432
    ds_read_b64_tr_b16 v[60:61], v7 offset:16384
    ds_read_b64_tr_b16 v[62:63], v7 offset:18432
    s_waitcnt lgkmcnt(14)
    v_mfma_f32_16x16x32_bf16 v[16:19], v[64:67], a[12:15], v[16:19]
    v_mfma_f32_16x16x32_bf16 v[32:35], v[64:67], a[92:95], v[32:35]
    s_waitcnt lgkmcnt(12)
    v_mfma_f32_16x16x32_bf16 v[20:23], v[68:71], a[12:15], v[20:23]
    s_add_u32 m0, s20, 65536
    s_add_u32 s29, s21, 2097152
    buffer_load_dwordx4 v1, s[8:11], s29 offen lds
    v_mfma_f32_16x16x32_bf16 v[36:39], v[68:71], a[92:95], v[36:39]
    s_waitcnt lgkmcnt(10)
    v_mfma_f32_16x16x32_bf16 v[24:27], v[72:75], a[12:15], v[24:27]
    v_mfma_f32_16x16x32_bf16 v[40:43], v[72:75], a[92:95], v[40:43]
    s_add_u32 m0, s20, 73728
    s_add_u32 s29, s21, 2359296
    buffer_load_dwordx4 v1, s[8:11], s29 offen lds
    s_waitcnt lgkmcnt(8)
    v_mfma_f32_16x16x32_bf16 v[28:31], v[76:79], a[12:15], v[28:31]
    v_mfma_f32_16x16x32_bf16 v[44:47], v[76:79], a[92:95], v[44:47]
    s_add_u32 s29, s22, 8192
    buffer_load_dwordx4 a[40:43], v2, s[12:15], s29 offen offset:2048
    ds_read_b64_tr_b16 v[64:65], v4 offset:20480
    ds_read_b64_tr_b16 v[66:67], v4 offset:22528
    ds_read_b64_tr_b16 v[68:69], v5 offset:20480
    ds_read_b64_tr_b16 v[70:71], v5 offset:22528
    ds_read_b64_tr_b16 v[72:73], v6 offset:20480
    ds_read_b64_tr_b16 v[74:75], v6 offset:22528
    ds_read_b64_tr_b16 v[76:77], v7 offset:20480
    ds_read_b64_tr_b16 v[78:79], v7 offset:22528
    s_waitcnt vmcnt(22) lgkmcnt(14)
    v_mfma_f32_16x16x32_bf16 v[16:19], v[48:51], a[16:19], v[16:19]
    s_waitcnt vmcnt(21)
    v_mfma_f32_16x16x32_bf16 v[32:35], v[48:51], a[96:99], v[32:35]
    s_waitcnt lgkmcnt(12)
    v_mfma_f32_16x16x32_bf16 v[20:23], v[52:55], a[16:19], v[20:23]
    s_add_u32 s29, s23, 8192
    buffer_load_dwordx4 a[120:123], v2, s[12:15], s29 offen offset:2048
    v_mfma_f32_16x16x32_bf16 v[36:39], v[52:55], a[96:99], v[36:39]
    s_waitcnt lgkmcnt(10)
    v_mfma_f32_16x16x32_bf16 v[24:27], v[56:59], a[16:19], v[24:27]
    v_mfma_f32_16x16x32_bf16 v[40:43], v[56:59], a[96:99], v[40:43]
    s_add_u32 s29, s22, 8192
    buffer_load_dwordx4 a[44:47], v2, s[12:15], s29 offen offset:3072
    s_waitcnt lgkmcnt(8)
    v_mfma_f32_16x16x32_bf16 v[28:31], v[60:63], a[16:19], v[28:31]
    v_mfma_f32_16x16x32_bf16 v[44:47], v[60:63], a[96:99], v[44:47]
    s_add_u32 s29, s23, 8192
    buffer_load_dwordx4 a[124:127], v2, s[12:15], s29 offen offset:3072
    ds_read_b64_tr_b16 v[48:49], v4 offset:24576
    ds_read_b64_tr_b16 v[50:51], v4 offset:26624
    ds_read_b64_tr_b16 v[52:53], v5 offset:24576
    ds_read_b64_tr_b16 v[54:55], v5 offset:26624
    ds_read_b64_tr_b16 v[56:57], v6 offset:24576
    ds_read_b64_tr_b16 v[58:59], v6 offset:26624
    ds_read_b64_tr_b16 v[60:61], v7 offset:24576
    ds_read_b64_tr_b16 v[62:63], v7 offset:26624
    s_waitcnt vmcnt(23) lgkmcnt(14)
    v_mfma_f32_16x16x32_bf16 v[16:19], v[64:67], a[20:23], v[16:19]
    s_waitcnt vmcnt(22)
    v_mfma_f32_16x16x32_bf16 v[32:35], v[64:67], a[100:103], v[32:35]
    s_waitcnt lgkmcnt(12)
    v_mfma_f32_16x16x32_bf16 v[20:23], v[68:71], a[20:23], v[20:23]
    v_mfma_f32_16x16x32_bf16 v[36:39], v[68:71], a[100:103], v[36:39]
    s_add_u32 s29, s22, 12288
    buffer_load_dwordx4 a[48:51], v2, s[12:15], s29 offen offset:0
    s_waitcnt lgkmcnt(10)
    v_mfma_f32_16x16x32_bf16 v[24:27], v[72:75], a[20:23], v[24:27]
    v_mfma_f32_16x16x32_bf16 v[40:43], v[72:75], a[100:103], v[40:43]
    s_waitcnt lgkmcnt(8)
    v_mfma_f32_16x16x32_bf16 v[28:31], v[76:79], a[20:23], v[28:31]
    v_mfma_f32_16x16x32_bf16 v[44:47], v[76:79], a[100:103], v[44:47]
    s_add_u32 s29, s23, 12288
    buffer_load_dwordx4 a[128:131], v2, s[12:15], s29 offen offset:0
    ds_read_b64_tr_b16 v[64:65], v4 offset:28672
    ds_read_b64_tr_b16 v[66:67], v4 offset:30720
    ds_read_b64_tr_b16 v[68:69], v5 offset:28672
    ds_read_b64_tr_b16 v[70:71], v5 offset:30720
    ds_read_b64_tr_b16 v[72:73], v6 offset:28672
    ds_read_b64_tr_b16 v[74:75], v6 offset:30720
    ds_read_b64_tr_b16 v[76:77], v7 offset:28672
    ds_read_b64_tr_b16 v[78:79], v7 offset:30720
    s_waitcnt vmcnt(17) lgkmcnt(14)
    v_mfma_f32_16x16x32_bf16 v[16:19], v[48:51], a[24:27], v[16:19]
    s_waitcnt vmcnt(16)
    v_mfma_f32_16x16x32_bf16 v[32:35], v[48:51], a[104:107], v[32:35]
    s_waitcnt lgkmcnt(12)
    v_mfma_f32_16x16x32_bf16 v[20:23], v[52:55], a[24:27], v[20:23]
    v_mfma_f32_16x16x32_bf16 v[36:39], v[52:55], a[104:107], v[36:39]
    s_add_u32 s29, s22, 12288
    buffer_load_dwordx4 a[52:55], v2, s[12:15], s29 offen offset:1024
    s_waitcnt lgkmcnt(10)
    v_mfma_f32_16x16x32_bf16 v[24:27], v[56:59], a[24:27], v[24:27]
    v_mfma_f32_16x16x32_bf16 v[40:43], v[56:59], a[104:107], v[40:43]
    s_waitcnt lgkmcnt(8)
    v_mfma_f32_16x16x32_bf16 v[28:31], v[60:63], a[24:27], v[28:31]
    v_mfma_f32_16x16x32_bf16 v[44:47], v[60:63], a[104:107], v[44:47]
    s_add_u32 s29, s23, 12288
    buffer_load_dwordx4 a[132:135], v2, s[12:15], s29 offen offset:1024
    v_add_f32 v80, v80, v81
    v_add_f32 v82, v82, v83
    v_add_f32 v80, v80, v82
    v_lshlrev_b32 v3, 2, v0
    ds_write_b32 v3, v80 offset:0
    s_waitcnt lgkmcnt(0)
    s_waitcnt vmcnt(15)
    s_barrier
    ds_read_b64_tr_b16 v[48:49], v4 offset:32768
    ds_read_b64_tr_b16 v[50:51], v4 offset:34816
    ds_read_b64_tr_b16 v[52:53], v5 offset:32768
    ds_read_b64_tr_b16 v[54:55], v5 offset:34816
    ds_read_b64_tr_b16 v[56:57], v6 offset:32768
    ds_read_b64_tr_b16 v[58:59], v6 offset:34816
    ds_read_b64_tr_b16 v[60:61], v7 offset:32768
    ds_read_b64_tr_b16 v[62:63], v7 offset:34816
    v_mfma_f32_16x16x32_bf16 v[16:19], v[64:67], a[28:31], v[16:19]
    v_mfma_f32_16x16x32_bf16 v[32:35], v[64:67], a[108:111], v[32:35]
    v_mfma_f32_16x16x32_bf16 v[20:23], v[68:71], a[28:31], v[20:23]
    v_mfma_f32_16x16x32_bf16 v[36:39], v[68:71], a[108:111], v[36:39]
    s_add_u32 s29, s22, 12288
    buffer_load_dwordx4 a[56:59], v2, s[12:15], s29 offen offset:2048
    v_mfma_f32_16x16x32_bf16 v[24:27], v[72:75], a[28:31], v[24:27]
    v_mfma_f32_16x16x32_bf16 v[40:43], v[72:75], a[108:111], v[40:43]
    v_mfma_f32_16x16x32_bf16 v[28:31], v[76:79], a[28:31], v[28:31]
    v_mfma_f32_16x16x32_bf16 v[44:47], v[76:79], a[108:111], v[44:47]
    s_add_u32 s29, s23, 12288
    buffer_load_dwordx4 a[136:139], v2, s[12:15], s29 offen offset:2048
    ds_read_b64_tr_b16 v[64:65], v4 offset:36864
    ds_read_b64_tr_b16 v[66:67], v4 offset:38912
    ds_read_b64_tr_b16 v[68:69], v5 offset:36864
    ds_read_b64_tr_b16 v[70:71], v5 offset:38912
    ds_read_b64_tr_b16 v[72:73], v6 offset:36864
    ds_read_b64_tr_b16 v[74:75], v6 offset:38912
    ds_read_b64_tr_b16 v[76:77], v7 offset:36864
    ds_read_b64_tr_b16 v[78:79], v7 offset:38912
    s_waitcnt vmcnt(15) lgkmcnt(14)
    v_mfma_f32_16x16x32_bf16 v[16:19], v[48:51], a[32:35], v[16:19]
    s_waitcnt vmcnt(14)
    v_mfma_f32_16x16x32_bf16 v[32:35], v[48:51], a[112:115], v[32:35]
    s_waitcnt lgkmcnt(12)
    v_mfma_f32_16x16x32_bf16 v[20:23], v[52:55], a[32:35], v[20:23]
    v_mfma_f32_16x16x32_bf16 v[36:39], v[52:55], a[112:115], v[36:39]
    s_add_u32 s29, s22, 12288
    buffer_load_dwordx4 a[60:63], v2, s[12:15], s29 offen offset:3072
    s_waitcnt lgkmcnt(10)
    v_mfma_f32_16x16x32_bf16 v[24:27], v[56:59], a[32:35], v[24:27]
    v_mfma_f32_16x16x32_bf16 v[40:43], v[56:59], a[112:115], v[40:43]
    s_waitcnt lgkmcnt(8)
    v_mfma_f32_16x16x32_bf16 v[28:31], v[60:63], a[32:35], v[28:31]
    v_mfma_f32_16x16x32_bf16 v[44:47], v[60:63], a[112:115], v[44:47]
    s_add_u32 s29, s23, 12288
    buffer_load_dwordx4 a[140:143], v2, s[12:15], s29 offen offset:3072
    v_add_u32 v4, 40960, v4
    v_add_u32 v5, 40960, v5
    v_add_u32 v6, 40960, v6
    v_add_u32 v7, 40960, v7
    ds_read_b64_tr_b16 v[48:49], v4 offset:0
    ds_read_b64_tr_b16 v[50:51], v4 offset:2048
    ds_read_b64_tr_b16 v[52:53], v5 offset:0
    ds_read_b64_tr_b16 v[54:55], v5 offset:2048
    ds_read_b64_tr_b16 v[56:57], v6 offset:0
    ds_read_b64_tr_b16 v[58:59], v6 offset:2048
    ds_read_b64_tr_b16 v[60:61], v7 offset:0
    ds_read_b64_tr_b16 v[62:63], v7 offset:2048
    s_waitcnt vmcnt(15) lgkmcnt(14)
    v_mfma_f32_16x16x32_bf16 v[16:19], v[64:67], a[36:39], v[16:19]
    s_waitcnt vmcnt(14)
    v_mfma_f32_16x16x32_bf16 v[32:35], v[64:67], a[116:119], v[32:35]
    s_waitcnt lgkmcnt(12)
    v_mfma_f32_16x16x32_bf16 v[20:23], v[68:71], a[36:39], v[20:23]
    v_mfma_f32_16x16x32_bf16 v[36:39], v[68:71], a[116:119], v[36:39]
    s_add_u32 s29, s22, 16384
    buffer_load_dwordx4 a[64:67], v2, s[12:15], s29 offen offset:0
    s_waitcnt lgkmcnt(10)
    v_mfma_f32_16x16x32_bf16 v[24:27], v[72:75], a[36:39], v[24:27]
    v_mfma_f32_16x16x32_bf16 v[40:43], v[72:75], a[116:119], v[40:43]
    s_waitcnt lgkmcnt(8)
    v_mfma_f32_16x16x32_bf16 v[28:31], v[76:79], a[36:39], v[28:31]
    v_mfma_f32_16x16x32_bf16 v[44:47], v[76:79], a[116:119], v[44:47]
    s_add_u32 s29, s23, 16384
    buffer_load_dwordx4 a[144:147], v2, s[12:15], s29 offen offset:0
    ds_read_b64_tr_b16 v[64:65], v4 offset:4096
    ds_read_b64_tr_b16 v[66:67], v4 offset:6144
    ds_read_b64_tr_b16 v[68:69], v5 offset:4096
    ds_read_b64_tr_b16 v[70:71], v5 offset:6144
    ds_read_b64_tr_b16 v[72:73], v6 offset:4096
    ds_read_b64_tr_b16 v[74:75], v6 offset:6144
    ds_read_b64_tr_b16 v[76:77], v7 offset:4096
    ds_read_b64_tr_b16 v[78:79], v7 offset:6144
    s_waitcnt vmcnt(13) lgkmcnt(14)
    v_mfma_f32_16x16x32_bf16 v[16:19], v[48:51], a[40:43], v[16:19]
    s_waitcnt vmcnt(12)
    v_mfma_f32_16x16x32_bf16 v[32:35], v[48:51], a[120:123], v[32:35]
    s_waitcnt lgkmcnt(12)
    v_mfma_f32_16x16x32_bf16 v[20:23], v[52:55], a[40:43], v[20:23]
    v_mfma_f32_16x16x32_bf16 v[36:39], v[52:55], a[120:123], v[36:39]
    s_add_u32 s29, s22, 16384
    buffer_load_dwordx4 a[68:71], v2, s[12:15], s29 offen offset:1024
    s_waitcnt lgkmcnt(10)
    v_mfma_f32_16x16x32_bf16 v[24:27], v[56:59], a[40:43], v[24:27]
    v_mfma_f32_16x16x32_bf16 v[40:43], v[56:59], a[120:123], v[40:43]
    s_waitcnt lgkmcnt(8)
    v_mfma_f32_16x16x32_bf16 v[28:31], v[60:63], a[40:43], v[28:31]
    v_mfma_f32_16x16x32_bf16 v[44:47], v[60:63], a[120:123], v[44:47]
    s_add_u32 s29, s23, 16384
    buffer_load_dwordx4 a[148:151], v2, s[12:15], s29 offen offset:1024
    s_barrier
    ds_read_b64_tr_b16 v[48:49], v4 offset:8192
    ds_read_b64_tr_b16 v[50:51], v4 offset:10240
    ds_read_b64_tr_b16 v[52:53], v5 offset:8192
    ds_read_b64_tr_b16 v[54:55], v5 offset:10240
    ds_read_b64_tr_b16 v[56:57], v6 offset:8192
    ds_read_b64_tr_b16 v[58:59], v6 offset:10240
    ds_read_b64_tr_b16 v[60:61], v7 offset:8192
    ds_read_b64_tr_b16 v[62:63], v7 offset:10240
    s_waitcnt vmcnt(13) lgkmcnt(14)
    v_mfma_f32_16x16x32_bf16 v[16:19], v[64:67], a[44:47], v[16:19]
    s_waitcnt vmcnt(12)
    v_mfma_f32_16x16x32_bf16 v[32:35], v[64:67], a[124:127], v[32:35]
    s_waitcnt lgkmcnt(12)
    v_mfma_f32_16x16x32_bf16 v[20:23], v[68:71], a[44:47], v[20:23]
    v_mfma_f32_16x16x32_bf16 v[36:39], v[68:71], a[124:127], v[36:39]
    s_add_u32 s29, s22, 16384
    buffer_load_dwordx4 a[72:75], v2, s[12:15], s29 offen offset:2048
    s_waitcnt lgkmcnt(10)
    v_mfma_f32_16x16x32_bf16 v[24:27], v[72:75], a[44:47], v[24:27]
    v_mfma_f32_16x16x32_bf16 v[40:43], v[72:75], a[124:127], v[40:43]
    s_waitcnt lgkmcnt(8)
    v_mfma_f32_16x16x32_bf16 v[28:31], v[76:79], a[44:47], v[28:31]
    v_mfma_f32_16x16x32_bf16 v[44:47], v[76:79], a[124:127], v[44:47]
    s_add_u32 s29, s23, 16384
    buffer_load_dwordx4 a[152:155], v2, s[12:15], s29 offen offset:2048
    ds_read_b64_tr_b16 v[64:65], v4 offset:12288
    ds_read_b64_tr_b16 v[66:67], v4 offset:14336
    ds_read_b64_tr_b16 v[68:69], v5 offset:12288
    ds_read_b64_tr_b16 v[70:71], v5 offset:14336
    ds_read_b64_tr_b16 v[72:73], v6 offset:12288
    ds_read_b64_tr_b16 v[74:75], v6 offset:14336
    ds_read_b64_tr_b16 v[76:77], v7 offset:12288
    ds_read_b64_tr_b16 v[78:79], v7 offset:14336
    s_waitcnt vmcnt(13) lgkmcnt(14)
    v_mfma_f32_16x16x32_bf16 v[16:19], v[48:51], a[48:51], v[16:19]
    s_waitcnt vmcnt(12)
    v_mfma_f32_16x16x32_bf16 v[32:35], v[48:51], a[128:131], v[32:35]
    s_waitcnt lgkmcnt(12)
    v_mfma_f32_16x16x32_bf16 v[20:23], v[52:55], a[48:51], v[20:23]
    v_mfma_f32_16x16x32_bf16 v[36:39], v[52:55], a[128:131], v[36:39]
    s_add_u32 s29, s22, 16384
    buffer_load_dwordx4 a[76:79], v2, s[12:15], s29 offen offset:3072
    s_waitcnt lgkmcnt(10)
    v_mfma_f32_16x16x32_bf16 v[24:27], v[56:59], a[48:51], v[24:27]
    v_mfma_f32_16x16x32_bf16 v[40:43], v[56:59], a[128:131], v[40:43]
    s_waitcnt lgkmcnt(8)
    v_mfma_f32_16x16x32_bf16 v[28:31], v[60:63], a[48:51], v[28:31]
    v_mfma_f32_16x16x32_bf16 v[44:47], v[60:63], a[128:131], v[44:47]
    s_add_u32 s29, s23, 16384
    buffer_load_dwordx4 a[156:159], v2, s[12:15], s29 offen offset:3072
    ds_read_b64_tr_b16 v[48:49], v4 offset:16384
    ds_read_b64_tr_b16 v[50:51], v4 offset:18432
    ds_read_b64_tr_b16 v[52:53], v5 offset:16384
    ds_read_b64_tr_b16 v[54:55], v5 offset:18432
    ds_read_b64_tr_b16 v[56:57], v6 offset:16384
    ds_read_b64_tr_b16 v[58:59], v6 offset:18432
    ds_read_b64_tr_b16 v[60:61], v7 offset:16384
    ds_read_b64_tr_b16 v[62:63], v7 offset:18432
    s_waitcnt vmcnt(13) lgkmcnt(14)
    v_mfma_f32_16x16x32_bf16 v[16:19], v[64:67], a[52:55], v[16:19]
    s_waitcnt vmcnt(12)
    v_mfma_f32_16x16x32_bf16 v[32:35], v[64:67], a[132:135], v[32:35]
    s_waitcnt lgkmcnt(12)
    v_mfma_f32_16x16x32_bf16 v[20:23], v[68:71], a[52:55], v[20:23]
    v_mfma_f32_16x16x32_bf16 v[36:39], v[68:71], a[132:135], v[36:39]
    s_waitcnt lgkmcnt(10)
    v_mfma_f32_16x16x32_bf16 v[24:27], v[72:75], a[52:55], v[24:27]
    v_mfma_f32_16x16x32_bf16 v[40:43], v[72:75], a[132:135], v[40:43]
    s_waitcnt lgkmcnt(8)
    v_mfma_f32_16x16x32_bf16 v[28:31], v[76:79], a[52:55], v[28:31]
    v_mfma_f32_16x16x32_bf16 v[44:47], v[76:79], a[132:135], v[44:47]
    ds_read_b64_tr_b16 v[64:65], v4 offset:20480
    ds_read_b64_tr_b16 v[66:67], v4 offset:22528
    ds_read_b64_tr_b16 v[68:69], v5 offset:20480
    ds_read_b64_tr_b16 v[70:71], v5 offset:22528
    ds_read_b64_tr_b16 v[72:73], v6 offset:20480
    ds_read_b64_tr_b16 v[74:75], v6 offset:22528
    ds_read_b64_tr_b16 v[76:77], v7 offset:20480
    ds_read_b64_tr_b16 v[78:79], v7 offset:22528
    s_waitcnt vmcnt(11) lgkmcnt(14)
    v_mfma_f32_16x16x32_bf16 v[16:19], v[48:51], a[56:59], v[16:19]
    s_waitcnt vmcnt(10)
    v_mfma_f32_16x16x32_bf16 v[32:35], v[48:51], a[136:139], v[32:35]
    s_waitcnt lgkmcnt(12)
    v_mfma_f32_16x16x32_bf16 v[20:23], v[52:55], a[56:59], v[20:23]
    v_mfma_f32_16x16x32_bf16 v[36:39], v[52:55], a[136:139], v[36:39]
    s_waitcnt lgkmcnt(10)
    v_mfma_f32_16x16x32_bf16 v[24:27], v[56:59], a[56:59], v[24:27]
    v_mfma_f32_16x16x32_bf16 v[40:43], v[56:59], a[136:139], v[40:43]
    s_waitcnt lgkmcnt(8)
    v_mfma_f32_16x16x32_bf16 v[28:31], v[60:63], a[56:59], v[28:31]
    v_mfma_f32_16x16x32_bf16 v[44:47], v[60:63], a[136:139], v[44:47]
    ds_read_b64_tr_b16 v[48:49], v4 offset:24576
    ds_read_b64_tr_b16 v[50:51], v4 offset:26624
    ds_read_b64_tr_b16 v[52:53], v5 offset:24576
    ds_read_b64_tr_b16 v[54:55], v5 offset:26624
    ds_read_b64_tr_b16 v[56:57], v6 offset:24576
    ds_read_b64_tr_b16 v[58:59], v6 offset:26624
    ds_read_b64_tr_b16 v[60:61], v7 offset:24576
    ds_read_b64_tr_b16 v[62:63], v7 offset:26624
    s_waitcnt vmcnt(9) lgkmcnt(14)
    v_mfma_f32_16x16x32_bf16 v[16:19], v[64:67], a[60:63], v[16:19]
    s_waitcnt vmcnt(8)
    v_mfma_f32_16x16x32_bf16 v[32:35], v[64:67], a[140:143], v[32:35]
    s_waitcnt lgkmcnt(12)
    v_mfma_f32_16x16x32_bf16 v[20:23], v[68:71], a[60:63], v[20:23]
    v_mfma_f32_16x16x32_bf16 v[36:39], v[68:71], a[140:143], v[36:39]
    s_waitcnt lgkmcnt(10)
    v_mfma_f32_16x16x32_bf16 v[24:27], v[72:75], a[60:63], v[24:27]
    v_mfma_f32_16x16x32_bf16 v[40:43], v[72:75], a[140:143], v[40:43]
    s_waitcnt lgkmcnt(8)
    v_mfma_f32_16x16x32_bf16 v[28:31], v[76:79], a[60:63], v[28:31]
    v_mfma_f32_16x16x32_bf16 v[44:47], v[76:79], a[140:143], v[44:47]
    ds_read_b64_tr_b16 v[64:65], v4 offset:28672
    ds_read_b64_tr_b16 v[66:67], v4 offset:30720
    ds_read_b64_tr_b16 v[68:69], v5 offset:28672
    ds_read_b64_tr_b16 v[70:71], v5 offset:30720
    ds_read_b64_tr_b16 v[72:73], v6 offset:28672
    ds_read_b64_tr_b16 v[74:75], v6 offset:30720
    ds_read_b64_tr_b16 v[76:77], v7 offset:28672
    ds_read_b64_tr_b16 v[78:79], v7 offset:30720
    s_waitcnt vmcnt(7) lgkmcnt(14)
    v_mfma_f32_16x16x32_bf16 v[16:19], v[48:51], a[64:67], v[16:19]
    s_waitcnt vmcnt(6)
    v_mfma_f32_16x16x32_bf16 v[32:35], v[48:51], a[144:147], v[32:35]
    s_waitcnt lgkmcnt(12)
    v_mfma_f32_16x16x32_bf16 v[20:23], v[52:55], a[64:67], v[20:23]
    v_mfma_f32_16x16x32_bf16 v[36:39], v[52:55], a[144:147], v[36:39]
    s_waitcnt lgkmcnt(10)
    v_mfma_f32_16x16x32_bf16 v[24:27], v[56:59], a[64:67], v[24:27]
    v_mfma_f32_16x16x32_bf16 v[40:43], v[56:59], a[144:147], v[40:43]
    s_waitcnt lgkmcnt(8)
    v_mfma_f32_16x16x32_bf16 v[28:31], v[60:63], a[64:67], v[28:31]
    v_mfma_f32_16x16x32_bf16 v[44:47], v[60:63], a[144:147], v[44:47]
    ds_read_b64_tr_b16 v[48:49], v4 offset:32768
    ds_read_b64_tr_b16 v[50:51], v4 offset:34816
    ds_read_b64_tr_b16 v[52:53], v5 offset:32768
    ds_read_b64_tr_b16 v[54:55], v5 offset:34816
    ds_read_b64_tr_b16 v[56:57], v6 offset:32768
    ds_read_b64_tr_b16 v[58:59], v6 offset:34816
    ds_read_b64_tr_b16 v[60:61], v7 offset:32768
    ds_read_b64_tr_b16 v[62:63], v7 offset:34816
    s_waitcnt vmcnt(5) lgkmcnt(14)
    v_mfma_f32_16x16x32_bf16 v[16:19], v[64:67], a[68:71], v[16:19]
    s_waitcnt vmcnt(4)
    v_mfma_f32_16x16x32_bf16 v[32:35], v[64:67], a[148:151], v[32:35]
    s_waitcnt lgkmcnt(12)
    v_mfma_f32_16x16x32_bf16 v[20:23], v[68:71], a[68:71], v[20:23]
    v_mfma_f32_16x16x32_bf16 v[36:39], v[68:71], a[148:151], v[36:39]
    s_waitcnt lgkmcnt(10)
    v_mfma_f32_16x16x32_bf16 v[24:27], v[72:75], a[68:71], v[24:27]
    v_mfma_f32_16x16x32_bf16 v[40:43], v[72:75], a[148:151], v[40:43]
    s_waitcnt lgkmcnt(8)
    v_mfma_f32_16x16x32_bf16 v[28:31], v[76:79], a[68:71], v[28:31]
    v_mfma_f32_16x16x32_bf16 v[44:47], v[76:79], a[148:151], v[44:47]
    ds_read_b64_tr_b16 v[64:65], v4 offset:36864
    ds_read_b64_tr_b16 v[66:67], v4 offset:38912
    ds_read_b64_tr_b16 v[68:69], v5 offset:36864
    ds_read_b64_tr_b16 v[70:71], v5 offset:38912
    ds_read_b64_tr_b16 v[72:73], v6 offset:36864
    ds_read_b64_tr_b16 v[74:75], v6 offset:38912
    ds_read_b64_tr_b16 v[76:77], v7 offset:36864
    ds_read_b64_tr_b16 v[78:79], v7 offset:38912
    s_waitcnt vmcnt(3) lgkmcnt(14)
    v_mfma_f32_16x16x32_bf16 v[16:19], v[48:51], a[72:75], v[16:19]
    s_waitcnt vmcnt(2)
    v_mfma_f32_16x16x32_bf16 v[32:35], v[48:51], a[152:155], v[32:35]
    s_waitcnt lgkmcnt(12)
    v_mfma_f32_16x16x32_bf16 v[20:23], v[52:55], a[72:75], v[20:23]
    v_mfma_f32_16x16x32_bf16 v[36:39], v[52:55], a[152:155], v[36:39]
    s_waitcnt lgkmcnt(10)
    v_mfma_f32_16x16x32_bf16 v[24:27], v[56:59], a[72:75], v[24:27]
    v_mfma_f32_16x16x32_bf16 v[40:43], v[56:59], a[152:155], v[40:43]
    s_waitcnt lgkmcnt(8)
    v_mfma_f32_16x16x32_bf16 v[28:31], v[60:63], a[72:75], v[28:31]
    v_mfma_f32_16x16x32_bf16 v[44:47], v[60:63], a[152:155], v[44:47]
    s_waitcnt vmcnt(1) lgkmcnt(6)
    v_mfma_f32_16x16x32_bf16 v[16:19], v[64:67], a[76:79], v[16:19]
    s_waitcnt vmcnt(0)
    v_mfma_f32_16x16x32_bf16 v[32:35], v[64:67], a[156:159], v[32:35]
    s_waitcnt lgkmcnt(4)
    v_mfma_f32_16x16x32_bf16 v[20:23], v[68:71], a[76:79], v[20:23]
    v_mfma_f32_16x16x32_bf16 v[36:39], v[68:71], a[156:159], v[36:39]
    s_waitcnt lgkmcnt(2)
    v_mfma_f32_16x16x32_bf16 v[24:27], v[72:75], a[76:79], v[24:27]
    v_mfma_f32_16x16x32_bf16 v[40:43], v[72:75], a[156:159], v[40:43]
    s_waitcnt lgkmcnt(0)
    v_mfma_f32_16x16x32_bf16 v[28:31], v[76:79], a[76:79], v[28:31]
    v_mfma_f32_16x16x32_bf16 v[44:47], v[76:79], a[156:159], v[44:47]
    s_barrier
    s_cmp_eq_u32 s36, 3
    s_cselect_b32 s39, 6, 99
    s_cmp_eq_u32 s37, s39
    s_cbranch_scc1 k2_exit
    v_and_b32 v8, 15, v0
    v_bfe_u32 v9, v0, 4, 2
    v_mov_b32 v15, 0xc0135761
    s_mov_b32 s31, 0xbdd2d3e8
    v_lshlrev_b32 v10, 4, v9
    ds_read_b128 v[48:51], v10 offset:2048
    ds_read_b128 v[64:67], v10 offset:2304
    ds_read_b128 v[52:55], v10 offset:2112
    ds_read_b128 v[68:71], v10 offset:2368
    ds_read_b128 v[56:59], v10 offset:2176
    ds_read_b128 v[72:75], v10 offset:2432
    ds_read_b128 v[60:63], v10 offset:2240
    ds_read_b128 v[76:79], v10 offset:2496
    v_lshlrev_b32 v11, 2, v8
    s_lshl_b32 s27, s26, 2
    v_add_u32 v11, s27, v11
    ds_read_b32 v4, v11 offset:0
    ds_read_b32 v6, v11 offset:1024
    ds_read_b32 v5, v11 offset:64
    ds_read_b32 v7, v11 offset:1088
    v_and_b32 v10, 63, v0
    v_lshlrev_b32 v10, 4, v10
    v_lshrrev_b32 v12, 1, v10
    s_lshl_b32 s27, s37, 12
    v_add_u32 v12, s27, v12
    s_sub_u32 s27, s24, 54
    s_lshl_b32 s27, s27, 6
    s_lshl_b32 s28, s25, 1
    s_add_u32 s27, s27, s28
    s_lshl_b32 s27, s27, 10
    s_add_u32 s28, s27, 65536
    v_mov_b32 v14, 0xbdd2d3e8
    s_waitcnt lgkmcnt(1)
    v_pk_fma_f32 v[16:17], v[48:49], v[4:5], v[16:17] op_sel:[0,0,0] op_sel_hi:[1,0,1] neg_lo:[1,0,0] neg_hi:[1,0,0]
    v_pk_fma_f32 v[18:19], v[50:51], v[4:5], v[18:19] op_sel:[0,0,0] op_sel_hi:[1,0,1] neg_lo:[1,0,0] neg_hi:[1,0,0]
    v_pk_fma_f32 v[32:33], v[48:49], v[4:5], v[32:33] op_sel:[0,1,0] op_sel_hi:[1,1,1] neg_lo:[1,0,0] neg_hi:[1,0,0]
    v_pk_fma_f32 v[34:35], v[50:51], v[4:5], v[34:35] op_sel:[0,1,0] op_sel_hi:[1,1,1] neg_lo:[1,0,0] neg_hi:[1,0,0]
    s_waitcnt lgkmcnt(0)
    v_pk_fma_f32 v[16:17], v[16:17], v[64:65], v[6:7] op_sel:[0,0,0] op_sel_hi:[1,1,0]
    v_pk_fma_f32 v[18:19], v[18:19], v[66:67], v[6:7] op_sel:[0,0,0] op_sel_hi:[1,1,0]
    v_pk_fma_f32 v[32:33], v[32:33], v[64:65], v[6:7] op_sel:[0,0,1] op_sel_hi:[1,1,1]
    v_pk_fma_f32 v[34:35], v[34:35], v[66:67], v[6:7] op_sel:[0,0,1] op_sel_hi:[1,1,1]
    v_pk_mul_f32 v[80:81], v[16:17], v[16:17]
    v_pk_mul_f32 v[82:83], v[18:19], v[18:19]
    v_pk_mul_f32 v[84:85], v[32:33], v[32:33]
    v_pk_mul_f32 v[86:87], v[34:35], v[34:35]
    v_pk_fma_f32 v[80:81], v[80:81], v[14:15], v[14:15] op_sel:[0,0,1] op_sel_hi:[1,0,1]
    v_pk_fma_f32 v[82:83], v[82:83], v[14:15], v[14:15] op_sel:[0,0,1] op_sel_hi:[1,0,1]
    v_pk_fma_f32 v[84:85], v[84:85], v[14:15], v[14:15] op_sel:[0,0,1] op_sel_hi:[1,0,1]
    v_pk_fma_f32 v[86:87], v[86:87], v[14:15], v[14:15] op_sel:[0,0,1] op_sel_hi:[1,0,1]
    v_pk_mul_f32 v[80:81], v[80:81], v[16:17]
    v_pk_mul_f32 v[82:83], v[82:83], v[18:19]
    v_pk_mul_f32 v[84:85], v[84:85], v[32:33]
    v_pk_mul_f32 v[86:87], v[86:87], v[34:35]
    v_exp_f32 v80, v80
    v_exp_f32 v81, v81
    v_exp_f32 v82, v82
    v_exp_f32 v83, v83
    v_exp_f32 v84, v84
    v_exp_f32 v85, v85
    v_exp_f32 v86, v86
    v_exp_f32 v87, v87
    v_pk_add_f32 v[80:81], v[80:81], 1.0 op_sel_hi:[1,0]
    v_pk_add_f32 v[82:83], v[82:83], 1.0 op_sel_hi:[1,0]
    v_pk_add_f32 v[84:85], v[84:85], 1.0 op_sel_hi:[1,0]
    v_pk_add_f32 v[86:87], v[86:87], 1.0 op_sel_hi:[1,0]
    v_rcp_f32 v80, v80
    v_rcp_f32 v81, v81
    v_rcp_f32 v82, v82
    v_rcp_f32 v83, v83
    v_rcp_f32 v84, v84
    v_rcp_f32 v85, v85
    v_rcp_f32 v86, v86
    v_rcp_f32 v87, v87
    v_pk_mul_f32 v[16:17], v[16:17], v[80:81]
    v_pk_mul_f32 v[18:19], v[18:19], v[82:83]
    v_pk_mul_f32 v[32:33], v[32:33], v[84:85]
    v_pk_mul_f32 v[34:35], v[34:35], v[86:87]
    v_cvt_pk_bf16_f32 v88, v16, v17
    v_cvt_pk_bf16_f32 v89, v18, v19
    ds_write_b64 v12, v[88:89] offset:4096
    v_cvt_pk_bf16_f32 v92, v32, v33
    v_cvt_pk_bf16_f32 v93, v34, v35
    ds_write_b64 v12, v[92:93] offset:6144
    s_waitcnt lgkmcnt(0)
    s_barrier
    v_pk_fma_f32 v[20:21], v[52:53], v[4:5], v[20:21] op_sel:[0,0,0] op_sel_hi:[1,0,1] neg_lo:[1,0,0] neg_hi:[1,0,0]
    v_pk_fma_f32 v[22:23], v[54:55], v[4:5], v[22:23] op_sel:[0,0,0] op_sel_hi:[1,0,1] neg_lo:[1,0,0] neg_hi:[1,0,0]
    v_pk_fma_f32 v[36:37], v[52:53], v[4:5], v[36:37] op_sel:[0,1,0] op_sel_hi:[1,1,1] neg_lo:[1,0,0] neg_hi:[1,0,0]
    v_pk_fma_f32 v[38:39], v[54:55], v[4:5], v[38:39] op_sel:[0,1,0] op_sel_hi:[1,1,1] neg_lo:[1,0,0] neg_hi:[1,0,0]
    v_pk_fma_f32 v[20:21], v[20:21], v[68:69], v[6:7] op_sel:[0,0,0] op_sel_hi:[1,1,0]
    v_pk_fma_f32 v[22:23], v[22:23], v[70:71], v[6:7] op_sel:[0,0,0] op_sel_hi:[1,1,0]
    v_pk_fma_f32 v[36:37], v[36:37], v[68:69], v[6:7] op_sel:[0,0,1] op_sel_hi:[1,1,1]
    v_pk_fma_f32 v[38:39], v[38:39], v[70:71], v[6:7] op_sel:[0,0,1] op_sel_hi:[1,1,1]
    v_pk_mul_f32 v[80:81], v[20:21], v[20:21]
    v_pk_mul_f32 v[82:83], v[22:23], v[22:23]
    v_pk_mul_f32 v[84:85], v[36:37], v[36:37]
    v_pk_mul_f32 v[86:87], v[38:39], v[38:39]
    v_pk_fma_f32 v[80:81], v[80:81], v[14:15], v[14:15] op_sel:[0,0,1] op_sel_hi:[1,0,1]
    v_pk_fma_f32 v[82:83], v[82:83], v[14:15], v[14:15] op_sel:[0,0,1] op_sel_hi:[1,0,1]
    v_pk_fma_f32 v[84:85], v[84:85], v[14:15], v[14:15] op_sel:[0,0,1] op_sel_hi:[1,0,1]
    v_pk_fma_f32 v[86:87], v[86:87], v[14:15], v[14:15] op_sel:[0,0,1] op_sel_hi:[1,0,1]
    v_pk_mul_f32 v[80:81], v[80:81], v[20:21]
    v_pk_mul_f32 v[82:83], v[82:83], v[22:23]
    v_pk_mul_f32 v[84:85], v[84:85], v[36:37]
    v_pk_mul_f32 v[86:87], v[86:87], v[38:39]
    v_exp_f32 v80, v80
    v_exp_f32 v81, v81
    v_exp_f32 v82, v82
    v_exp_f32 v83, v83
    v_exp_f32 v84, v84
    v_exp_f32 v85, v85
    v_exp_f32 v86, v86
    v_exp_f32 v87, v87
    v_pk_add_f32 v[80:81], v[80:81], 1.0 op_sel_hi:[1,0]
    v_pk_add_f32 v[82:83], v[82:83], 1.0 op_sel_hi:[1,0]
    v_pk_add_f32 v[84:85], v[84:85], 1.0 op_sel_hi:[1,0]
    v_pk_add_f32 v[86:87], v[86:87], 1.0 op_sel_hi:[1,0]
    v_rcp_f32 v80, v80
    v_rcp_f32 v81, v81
    v_rcp_f32 v82, v82
    v_rcp_f32 v83, v83
    v_rcp_f32 v84, v84
    v_rcp_f32 v85, v85
    v_rcp_f32 v86, v86
    v_rcp_f32 v87, v87
    v_pk_mul_f32 v[20:21], v[20:21], v[80:81]
    v_pk_mul_f32 v[22:23], v[22:23], v[82:83]
    v_pk_mul_f32 v[36:37], v[36:37], v[84:85]
    v_pk_mul_f32 v[38:39], v[38:39], v[86:87]
    v_cvt_pk_bf16_f32 v90, v20, v21
    v_cvt_pk_bf16_f32 v91, v22, v23
    ds_write_b64 v12, v[90:91] offset:4608
    v_cvt_pk_bf16_f32 v94, v36, v37
    v_cvt_pk_bf16_f32 v95, v38, v39
    ds_write_b64 v12, v[94:95] offset:6656
    buffer_store_dwordx4 v[88:91], v10, s[16:19], s27 offen offset:0 sc1
    buffer_store_dwordx4 v[92:95], v10, s[16:19], s28 offen offset:0 sc1
    s_waitcnt lgkmcnt(0)
    s_barrier
    v_pk_fma_f32 v[24:25], v[56:57], v[4:5], v[24:25] op_sel:[0,0,0] op_sel_hi:[1,0,1] neg_lo:[1,0,0] neg_hi:[1,0,0]
    v_pk_fma_f32 v[26:27], v[58:59], v[4:5], v[26:27] op_sel:[0,0,0] op_sel_hi:[1,0,1] neg_lo:[1,0,0] neg_hi:[1,0,0]
    v_pk_fma_f32 v[40:41], v[56:57], v[4:5], v[40:41] op_sel:[0,1,0] op_sel_hi:[1,1,1] neg_lo:[1,0,0] neg_hi:[1,0,0]
    v_pk_fma_f32 v[42:43], v[58:59], v[4:5], v[42:43] op_sel:[0,1,0] op_sel_hi:[1,1,1] neg_lo:[1,0,0] neg_hi:[1,0,0]
    v_pk_fma_f32 v[24:25], v[24:25], v[72:73], v[6:7] op_sel:[0,0,0] op_sel_hi:[1,1,0]
    v_pk_fma_f32 v[26:27], v[26:27], v[74:75], v[6:7] op_sel:[0,0,0] op_sel_hi:[1,1,0]
    v_pk_fma_f32 v[40:41], v[40:41], v[72:73], v[6:7] op_sel:[0,0,1] op_sel_hi:[1,1,1]
    v_pk_fma_f32 v[42:43], v[42:43], v[74:75], v[6:7] op_sel:[0,0,1] op_sel_hi:[1,1,1]
    v_pk_mul_f32 v[80:81], v[24:25], v[24:25]
    v_pk_mul_f32 v[82:83], v[26:27], v[26:27]
    v_pk_mul_f32 v[84:85], v[40:41], v[40:41]
    v_pk_mul_f32 v[86:87], v[42:43], v[42:43]
    v_pk_fma_f32 v[80:81], v[80:81], v[14:15], v[14:15] op_sel:[0,0,1] op_sel_hi:[1,0,1]
    v_pk_fma_f32 v[82:83], v[82:83], v[14:15], v[14:15] op_sel:[0,0,1] op_sel_hi:[1,0,1]
    v_pk_fma_f32 v[84:85], v[84:85], v[14:15], v[14:15] op_sel:[0,0,1] op_sel_hi:[1,0,1]
    v_pk_fma_f32 v[86:87], v[86:87], v[14:15], v[14:15] op_sel:[0,0,1] op_sel_hi:[1,0,1]
    v_pk_mul_f32 v[80:81], v[80:81], v[24:25]
    v_pk_mul_f32 v[82:83], v[82:83], v[26:27]
    v_pk_mul_f32 v[84:85], v[84:85], v[40:41]
    v_pk_mul_f32 v[86:87], v[86:87], v[42:43]
    v_exp_f32 v80, v80
    v_exp_f32 v81, v81
    v_exp_f32 v82, v82
    v_exp_f32 v83, v83
    v_exp_f32 v84, v84
    v_exp_f32 v85, v85
    v_exp_f32 v86, v86
    v_exp_f32 v87, v87
    v_pk_add_f32 v[80:81], v[80:81], 1.0 op_sel_hi:[1,0]
    v_pk_add_f32 v[82:83], v[82:83], 1.0 op_sel_hi:[1,0]
    v_pk_add_f32 v[84:85], v[84:85], 1.0 op_sel_hi:[1,0]
    v_pk_add_f32 v[86:87], v[86:87], 1.0 op_sel_hi:[1,0]
    v_rcp_f32 v80, v80
    v_rcp_f32 v81, v81
    v_rcp_f32 v82, v82
    v_rcp_f32 v83, v83
    v_rcp_f32 v84, v84
    v_rcp_f32 v85, v85
    v_rcp_f32 v86, v86
    v_rcp_f32 v87, v87
    v_pk_mul_f32 v[24:25], v[24:25], v[80:81]
    v_pk_mul_f32 v[26:27], v[26:27], v[82:83]
    v_pk_mul_f32 v[40:41], v[40:41], v[84:85]
    v_pk_mul_f32 v[42:43], v[42:43], v[86:87]
    v_cvt_pk_bf16_f32 v88, v24, v25
    v_cvt_pk_bf16_f32 v89, v26, v27
    ds_write_b64 v12, v[88:89] offset:5120
    v_cvt_pk_bf16_f32 v92, v40, v41
    v_cvt_pk_bf16_f32 v93, v42, v43
    ds_write_b64 v12, v[92:93] offset:7168
    s_waitcnt lgkmcnt(0)
    s_barrier
    v_pk_fma_f32 v[28:29], v[60:61], v[4:5], v[28:29] op_sel:[0,0,0] op_sel_hi:[1,0,1] neg_lo:[1,0,0] neg_hi:[1,0,0]
    v_pk_fma_f32 v[30:31], v[62:63], v[4:5], v[30:31] op_sel:[0,0,0] op_sel_hi:[1,0,1] neg_lo:[1,0,0] neg_hi:[1,0,0]
    v_pk_fma_f32 v[44:45], v[60:61], v[4:5], v[44:45] op_sel:[0,1,0] op_sel_hi:[1,1,1] neg_lo:[1,0,0] neg_hi:[1,0,0]
    v_pk_fma_f32 v[46:47], v[62:63], v[4:5], v[46:47] op_sel:[0,1,0] op_sel_hi:[1,1,1] neg_lo:[1,0,0] neg_hi:[1,0,0]
    v_pk_fma_f32 v[28:29], v[28:29], v[76:77], v[6:7] op_sel:[0,0,0] op_sel_hi:[1,1,0]
    v_pk_fma_f32 v[30:31], v[30:31], v[78:79], v[6:7] op_sel:[0,0,0] op_sel_hi:[1,1,0]
    v_pk_fma_f32 v[44:45], v[44:45], v[76:77], v[6:7] op_sel:[0,0,1] op_sel_hi:[1,1,1]
    v_pk_fma_f32 v[46:47], v[46:47], v[78:79], v[6:7] op_sel:[0,0,1] op_sel_hi:[1,1,1]
    v_pk_mul_f32 v[80:81], v[28:29], v[28:29]
    v_pk_mul_f32 v[82:83], v[30:31], v[30:31]
    v_pk_mul_f32 v[84:85], v[44:45], v[44:45]
    v_pk_mul_f32 v[86:87], v[46:47], v[46:47]
    v_pk_fma_f32 v[80:81], v[80:81], v[14:15], v[14:15] op_sel:[0,0,1] op_sel_hi:[1,0,1]
    v_pk_fma_f32 v[82:83], v[82:83], v[14:15], v[14:15] op_sel:[0,0,1] op_sel_hi:[1,0,1]
    v_pk_fma_f32 v[84:85], v[84:85], v[14:15], v[14:15] op_sel:[0,0,1] op_sel_hi:[1,0,1]
    v_pk_fma_f32 v[86:87], v[86:87], v[14:15], v[14:15] op_sel:[0,0,1] op_sel_hi:[1,0,1]
    v_pk_mul_f32 v[80:81], v[80:81], v[28:29]
    v_pk_mul_f32 v[82:83], v[82:83], v[30:31]
    v_pk_mul_f32 v[84:85], v[84:85], v[44:45]
    v_pk_mul_f32 v[86:87], v[86:87], v[46:47]
    v_exp_f32 v80, v80
    v_exp_f32 v81, v81
    v_exp_f32 v82, v82
    v_exp_f32 v83, v83
    v_exp_f32 v84, v84
    v_exp_f32 v85, v85
    v_exp_f32 v86, v86
    v_exp_f32 v87, v87
    v_pk_add_f32 v[80:81], v[80:81], 1.0 op_sel_hi:[1,0]
    v_pk_add_f32 v[82:83], v[82:83], 1.0 op_sel_hi:[1,0]
    v_pk_add_f32 v[84:85], v[84:85], 1.0 op_sel_hi:[1,0]
    v_pk_add_f32 v[86:87], v[86:87], 1.0 op_sel_hi:[1,0]
    v_rcp_f32 v80, v80
    v_rcp_f32 v81, v81
    v_rcp_f32 v82, v82
    v_rcp_f32 v83, v83
    v_rcp_f32 v84, v84
    v_rcp_f32 v85, v85
    v_rcp_f32 v86, v86
    v_rcp_f32 v87, v87
    v_pk_mul_f32 v[28:29], v[28:29], v[80:81]
    v_pk_mul_f32 v[30:31], v[30:31], v[82:83]
    v_pk_mul_f32 v[44:45], v[44:45], v[84:85]
    v_pk_mul_f32 v[46:47], v[46:47], v[86:87]
    v_cvt_pk_bf16_f32 v90, v28, v29
    v_cvt_pk_bf16_f32 v91, v30, v31
    ds_write_b64 v12, v[90:91] offset:5632
    v_cvt_pk_bf16_f32 v94, v44, v45
    v_cvt_pk_bf16_f32 v95, v46, v47
    ds_write_b64 v12, v[94:95] offset:7680
    buffer_store_dwordx4 v[88:91], v10, s[16:19], s27 offen offset:1024 sc1
    buffer_store_dwordx4 v[92:95], v10, s[16:19], s28 offen offset:1024 sc1
    s_waitcnt lgkmcnt(0)
    s_barrier
    s_endpgm
k2_stats:
    s_nop 7
    s_nop 7
    v_mov_b32 v8, 0x3f803f80
    v_mov_b32 v9, 0x3f803f80
    v_mov_b32 v10, 0x3f803f80
    v_mov_b32 v11, 0x3f803f80
    s_add_u32 m0, s20, 0
    s_add_u32 s29, s21, 0
    buffer_load_dwordx4 v1, s[8:11], s29 offen lds
    s_add_u32 m0, s20, 8192
    s_add_u32 s29, s21, 262144
    buffer_load_dwordx4 v1, s[8:11], s29 offen lds
    s_add_u32 m0, s20, 16384
    s_add_u32 s29, s21, 524288
    buffer_load_dwordx4 v1, s[8:11], s29 offen lds
    s_add_u32 m0, s20, 24576
    s_add_u32 s29, s21, 786432
    buffer_load_dwordx4 v1, s[8:11], s29 offen lds
    s_mov_b32 s29, 0
    buffer_load_dword v80, v3, s[40:43], s29 offen
    s_mov_b32 s29, 13824
    buffer_load_dword v81, v3, s[40:43], s29 offen
    s_mov_b32 s29, 27648
    buffer_load_dword v82, v3, s[40:43], s29 offen
    s_mov_b32 s29, 41472
    buffer_load_dword v83, v3, s[40:43], s29 offen
    s_waitcnt vmcnt(7)
    s_barrier
    ds_read_b64_tr_b16 v[48:49], v4 offset:0
    ds_read_b64_tr_b16 v[50:51], v4 offset:2048
    ds_read_b64_tr_b16 v[52:53], v5 offset:0
    ds_read_b64_tr_b16 v[54:55], v5 offset:2048
    ds_read_b64_tr_b16 v[56:57], v6 offset:0
    ds_read_b64_tr_b16 v[58:59], v6 offset:2048
    ds_read_b64_tr_b16 v[60:61], v7 offset:0
    ds_read_b64_tr_b16 v[62:63], v7 offset:2048
    s_add_u32 m0, s20, 32768
    s_add_u32 s29, s21, 1048576
    buffer_load_dwordx4 v1, s[8:11], s29 offen lds
    ds_read_b64_tr_b16 v[64:65], v4 offset:4096
    ds_read_b64_tr_b16 v[66:67], v4 offset:6144
    ds_read_b64_tr_b16 v[68:69], v5 offset:4096
    ds_read_b64_tr_b16 v[70:71], v5 offset:6144
    ds_read_b64_tr_b16 v[72:73], v6 offset:4096
    ds_read_b64_tr_b16 v[74:75], v6 offset:6144
    ds_read_b64_tr_b16 v[76:77], v7 offset:4096
    ds_read_b64_tr_b16 v[78:79], v7 offset:6144
    s_waitcnt lgkmcnt(14)
    v_mfma_f32_16x16x32_bf16 v[16:19], v[48:51], v[48:51], 0
    v_mfma_f32_16x16x32_bf16 v[32:35], v[8:11], v[48:51], 0
    s_waitcnt lgkmcnt(12)
    v_mfma_f32_16x16x32_bf16 v[20:23], v[52:55], v[52:55], 0
    v_mfma_f32_16x16x32_bf16 v[36:39], v[8:11], v[52:55], 0
    s_waitcnt lgkmcnt(10)
    v_mfma_f32_16x16x32_bf16 v[24:27], v[56:59], v[56:59], 0
    v_mfma_f32_16x16x32_bf16 v[40:43], v[8:11], v[56:59], 0
    s_waitcnt lgkmcnt(8)
    v_mfma_f32_16x16x32_bf16 v[28:31], v[60:63], v[60:63], 0
    v_mfma_f32_16x16x32_bf16 v[44:47], v[8:11], v[60:63], 0
    s_add_u32 m0, s20, 40960
    s_add_u32 s29, s21, 1310720
    buffer_load_dwordx4 v1, s[8:11], s29 offen lds
    s_waitcnt vmcnt(8)
    s_barrier
    ds_read_b64_tr_b16 v[48:49], v4 offset:8192
    ds_read_b64_tr_b16 v[50:51], v4 offset:10240
    ds_read_b64_tr_b16 v[52:53], v5 offset:8192
    ds_read_b64_tr_b16 v[54:55], v5 offset:10240
    ds_read_b64_tr_b16 v[56:57], v6 offset:8192
    ds_read_b64_tr_b16 v[58:59], v6 offset:10240
    ds_read_b64_tr_b16 v[60:61], v7 offset:8192
    ds_read_b64_tr_b16 v[62:63], v7 offset:10240
    s_waitcnt lgkmcnt(14)
    v_mfma_f32_16x16x32_bf16 v[16:19], v[64:67], v[64:67], v[16:19]
    v_mfma_f32_16x16x32_bf16 v[32:35], v[8:11], v[64:67], v[32:35]
    s_waitcnt lgkmcnt(12)
    v_mfma_f32_16x16x32_bf16 v[20:23], v[68:71], v[68:71], v[20:23]
    v_mfma_f32_16x16x32_bf16 v[36:39], v[8:11], v[68:71], v[36:39]
    s_waitcnt lgkmcnt(10)
    v_mfma_f32_16x16x32_bf16 v[24:27], v[72:75], v[72:75], v[24:27]
    v_mfma_f32_16x16x32_bf16 v[40:43], v[8:11], v[72:75], v[40:43]
    s_waitcnt lgkmcnt(8)
    v_mfma_f32_16x16x32_bf16 v[28:31], v[76:79], v[76:79], v[28:31]
    v_mfma_f32_16x16x32_bf16 v[44:47], v[8:11], v[76:79], v[44:47]
    s_add_u32 m0, s20, 49152
    s_add_u32 s29, s21, 1572864
    buffer_load_dwordx4 v1, s[8:11], s29 offen lds
    ds_read_b64_tr_b16 v[64:65], v4 offset:12288
    ds_read_b64_tr_b16 v[66:67], v4 offset:14336
    ds_read_b64_tr_b16 v[68:69], v5 offset:12288
    ds_read_b64_tr_b16 v[70:71], v5 offset:14336
    ds_read_b64_tr_b16 v[72:73], v6 offset:12288
    ds_read_b64_tr_b16 v[74:75], v6 offset:14336
    ds_read_b64_tr_b16 v[76:77], v7 offset:12288
    ds_read_b64_tr_b16 v[78:79], v7 offset:14336
    s_waitcnt lgkmcnt(14)
    v_mfma_f32_16x16x32_bf16 v[16:19], v[48:51], v[48:51], v[16:19]
    v_mfma_f32_16x16x32_bf16 v[32:35], v[8:11], v[48:51], v[32:35]
    s_waitcnt lgkmcnt(12)
    v_mfma_f32_16x16x32_bf16 v[20:23], v[52:55], v[52:55], v[20:23]
    v_mfma_f32_16x16x32_bf16 v[36:39], v[8:11], v[52:55], v[36:39]
    s_waitcnt lgkmcnt(10)
    v_mfma_f32_16x16x32_bf16 v[24:27], v[56:59], v[56:59], v[24:27]
    v_mfma_f32_16x16x32_bf16 v[40:43], v[8:11], v[56:59], v[40:43]
    s_waitcnt lgkmcnt(8)
    v_mfma_f32_16x16x32_bf16 v[28:31], v[60:63], v[60:63], v[28:31]
    v_mfma_f32_16x16x32_bf16 v[44:47], v[8:11], v[60:63], v[44:47]
    s_add_u32 m0, s20, 57344
    s_add_u32 s29, s21, 1835008
    buffer_load_dwordx4 v1, s[8:11], s29 offen lds
    s_waitcnt vmcnt(8)
    s_barrier
    ds_read_b64_tr_b16 v[48:49], v4 offset:16384
    ds_read_b64_tr_b16 v[50:51], v4 offset:18432
    ds_read_b64_tr_b16 v[52:53], v5 offset:16384
    ds_read_b64_tr_b16 v[54:55], v5 offset:18432
    ds_read_b64_tr_b16 v[56:57], v6 offset:16384
    ds_read_b64_tr_b16 v[58:59], v6 offset:18432
    ds_read_b64_tr_b16 v[60:61], v7 offset:16384
    ds_read_b64_tr_b16 v[62:63], v7 offset:18432
    s_waitcnt lgkmcnt(14)
    v_mfma_f32_16x16x32_bf16 v[16:19], v[64:67], v[64:67], v[16:19]
    v_mfma_f32_16x16x32_bf16 v[32:35], v[8:11], v[64:67], v[32:35]
    s_waitcnt lgkmcnt(12)
    v_mfma_f32_16x16x32_bf16 v[20:23], v[68:71], v[68:71], v[20:23]
    v_mfma_f32_16x16x32_bf16 v[36:39], v[8:11], v[68:71], v[36:39]
    s_waitcnt lgkmcnt(10)
    v_mfma_f32_16x16x32_bf16 v[24:27], v[72:75], v[72:75], v[24:27]
    v_mfma_f32_16x16x32_bf16 v[40:43], v[8:11], v[72:75], v[40:43]
    s_waitcnt lgkmcnt(8)
    v_mfma_f32_16x16x32_bf16 v[28:31], v[76:79], v[76:79], v[28:31]
    v_mfma_f32_16x16x32_bf16 v[44:47], v[8:11], v[76:79], v[44:47]
    s_add_u32 m0, s20, 65536
    s_add_u32 s29, s21, 2097152
    buffer_load_dwordx4 v1, s[8:11], s29 offen lds
    ds_read_b64_tr_b16 v[64:65], v4 offset:20480
    ds_read_b64_tr_b16 v[66:67], v4 offset:22528
    ds_read_b64_tr_b16 v[68:69], v5 offset:20480
    ds_read_b64_tr_b16 v[70:71], v5 offset:22528
    ds_read_b64_tr_b16 v[72:73], v6 offset:20480
    ds_read_b64_tr_b16 v[74:75], v6 offset:22528
    ds_read_b64_tr_b16 v[76:77], v7 offset:20480
    ds_read_b64_tr_b16 v[78:79], v7 offset:22528
    s_waitcnt lgkmcnt(14)
    v_mfma_f32_16x16x32_bf16 v[16:19], v[48:51], v[48:51], v[16:19]
    v_mfma_f32_16x16x32_bf16 v[32:35], v[8:11], v[48:51], v[32:35]
    s_waitcnt lgkmcnt(12)
    v_mfma_f32_16x16x32_bf16 v[20:23], v[52:55], v[52:55], v[20:23]
    v_mfma_f32_16x16x32_bf16 v[36:39], v[8:11], v[52:55], v[36:39]
    s_waitcnt lgkmcnt(10)
    v_mfma_f32_16x16x32_bf16 v[24:27], v[56:59], v[56:59], v[24:27]
    v_mfma_f32_16x16x32_bf16 v[40:43], v[8:11], v[56:59], v[40:43]
    s_waitcnt lgkmcnt(8)
    v_mfma_f32_16x16x32_bf16 v[28:31], v[60:63], v[60:63], v[28:31]
    v_mfma_f32_16x16x32_bf16 v[44:47], v[8:11], v[60:63], v[44:47]
    s_add_u32 m0, s20, 73728
    s_add_u32 s29, s21, 2359296
    buffer_load_dwordx4 v1, s[8:11], s29 offen lds
    ds_read_b64_tr_b16 v[48:49], v4 offset:24576
    ds_read_b64_tr_b16 v[50:51], v4 offset:26624
    ds_read_b64_tr_b16 v[52:53], v5 offset:24576
    ds_read_b64_tr_b16 v[54:55], v5 offset:26624
    ds_read_b64_tr_b16 v[56:57], v6 offset:24576
    ds_read_b64_tr_b16 v[58:59], v6 offset:26624
    ds_read_b64_tr_b16 v[60:61], v7 offset:24576
    ds_read_b64_tr_b16 v[62:63], v7 offset:26624
    s_waitcnt lgkmcnt(14)
    v_mfma_f32_16x16x32_bf16 v[16:19], v[64:67], v[64:67], v[16:19]
    v_mfma_f32_16x16x32_bf16 v[32:35], v[8:11], v[64:67], v[32:35]
    s_waitcnt lgkmcnt(12)
    v_mfma_f32_16x16x32_bf16 v[20:23], v[68:71], v[68:71], v[20:23]
    v_mfma_f32_16x16x32_bf16 v[36:39], v[8:11], v[68:71], v[36:39]
    s_waitcnt lgkmcnt(10)
    v_mfma_f32_16x16x32_bf16 v[24:27], v[72:75], v[72:75], v[24:27]
    v_mfma_f32_16x16x32_bf16 v[40:43], v[8:11], v[72:75], v[40:43]
    s_waitcnt lgkmcnt(8)
    v_mfma_f32_16x16x32_bf16 v[28:31], v[76:79], v[76:79], v[28:31]
    v_mfma_f32_16x16x32_bf16 v[44:47], v[8:11], v[76:79], v[44:47]
    ds_read_b64_tr_b16 v[64:65], v4 offset:28672
    ds_read_b64_tr_b16 v[66:67], v4 offset:30720
    ds_read_b64_tr_b16 v[68:69], v5 offset:28672
    ds_read_b64_tr_b16 v[70:71], v5 offset:30720
    ds_read_b64_tr_b16 v[72:73], v6 offset:28672
    ds_read_b64_tr_b16 v[74:75], v6 offset:30720
    ds_read_b64_tr_b16 v[76:77], v7 offset:28672
    ds_read_b64_tr_b16 v[78:79], v7 offset:30720
    s_waitcnt lgkmcnt(14)
    v_mfma_f32_16x16x32_bf16 v[16:19], v[48:51], v[48:51], v[16:19]
    v_mfma_f32_16x16x32_bf16 v[32:35], v[8:11], v[48:51], v[32:35]
    s_waitcnt lgkmcnt(12)
    v_mfma_f32_16x16x32_bf16 v[20:23], v[52:55], v[52:55], v[20:23]
    v_mfma_f32_16x16x32_bf16 v[36:39], v[8:11], v[52:55], v[36:39]
    s_waitcnt lgkmcnt(10)
    v_mfma_f32_16x16x32_bf16 v[24:27], v[56:59], v[56:59], v[24:27]
    v_mfma_f32_16x16x32_bf16 v[40:43], v[8:11], v[56:59], v[40:43]
    s_waitcnt lgkmcnt(8)
    v_mfma_f32_16x16x32_bf16 v[28:31], v[60:63], v[60:63], v[28:31]
    v_mfma_f32_16x16x32_bf16 v[44:47], v[8:11], v[60:63], v[44:47]
    s_waitcnt vmcnt(8)
    v_add_f32 v80, v80, v81
    s_waitcnt vmcnt(6)
    v_add_f32 v82, v82, v83
    v_add_f32 v80, v80, v82
    v_lshlrev_b32 v3, 2, v0
    ds_write_b32 v3, v80 offset:0
    s_waitcnt lgkmcnt(0)
    s_waitcnt vmcnt(3)
    s_barrier
    ds_read_b64_tr_b16 v[48:49], v4 offset:32768
    ds_read_b64_tr_b16 v[50:51], v4 offset:34816
    ds_read_b64_tr_b16 v[52:53], v5 offset:32768
    ds_read_b64_tr_b16 v[54:55], v5 offset:34816
    ds_read_b64_tr_b16 v[56:57], v6 offset:32768
    ds_read_b64_tr_b16 v[58:59], v6 offset:34816
    ds_read_b64_tr_b16 v[60:61], v7 offset:32768
    ds_read_b64_tr_b16 v[62:63], v7 offset:34816
    v_mfma_f32_16x16x32_bf16 v[16:19], v[64:67], v[64:67], v[16:19]
    v_mfma_f32_16x16x32_bf16 v[32:35], v[8:11], v[64:67], v[32:35]
    v_mfma_f32_16x16x32_bf16 v[20:23], v[68:71], v[68:71], v[20:23]
    v_mfma_f32_16x16x32_bf16 v[36:39], v[8:11], v[68:71], v[36:39]
    v_mfma_f32_16x16x32_bf16 v[24:27], v[72:75], v[72:75], v[24:27]
    v_mfma_f32_16x16x32_bf16 v[40:43], v[8:11], v[72:75], v[40:43]
    v_mfma_f32_16x16x32_bf16 v[28:31], v[76:79], v[76:79], v[28:31]
    v_mfma_f32_16x16x32_bf16 v[44:47], v[8:11], v[76:79], v[44:47]
    ds_read_b64_tr_b16 v[64:65], v4 offset:36864
    ds_read_b64_tr_b16 v[66:67], v4 offset:38912
    ds_read_b64_tr_b16 v[68:69], v5 offset:36864
    ds_read_b64_tr_b16 v[70:71], v5 offset:38912
    ds_read_b64_tr_b16 v[72:73], v6 offset:36864
    ds_read_b64_tr_b16 v[74:75], v6 offset:38912
    ds_read_b64_tr_b16 v[76:77], v7 offset:36864
    ds_read_b64_tr_b16 v[78:79], v7 offset:38912
    s_waitcnt lgkmcnt(14)
    v_mfma_f32_16x16x32_bf16 v[16:19], v[48:51], v[48:51], v[16:19]
    v_mfma_f32_16x16x32_bf16 v[32:35], v[8:11], v[48:51], v[32:35]
    s_waitcnt lgkmcnt(12)
    v_mfma_f32_16x16x32_bf16 v[20:23], v[52:55], v[52:55], v[20:23]
    v_mfma_f32_16x16x32_bf16 v[36:39], v[8:11], v[52:55], v[36:39]
    s_waitcnt lgkmcnt(10)
    v_mfma_f32_16x16x32_bf16 v[24:27], v[56:59], v[56:59], v[24:27]
    v_mfma_f32_16x16x32_bf16 v[40:43], v[8:11], v[56:59], v[40:43]
    s_waitcnt lgkmcnt(8)
    v_mfma_f32_16x16x32_bf16 v[28:31], v[60:63], v[60:63], v[28:31]
    v_mfma_f32_16x16x32_bf16 v[44:47], v[8:11], v[60:63], v[44:47]
    v_add_u32 v4, 40960, v4
    v_add_u32 v5, 40960, v5
    v_add_u32 v6, 40960, v6
    v_add_u32 v7, 40960, v7
    ds_read_b64_tr_b16 v[48:49], v4 offset:0
    ds_read_b64_tr_b16 v[50:51], v4 offset:2048
    ds_read_b64_tr_b16 v[52:53], v5 offset:0
    ds_read_b64_tr_b16 v[54:55], v5 offset:2048
    ds_read_b64_tr_b16 v[56:57], v6 offset:0
    ds_read_b64_tr_b16 v[58:59], v6 offset:2048
    ds_read_b64_tr_b16 v[60:61], v7 offset:0
    ds_read_b64_tr_b16 v[62:63], v7 offset:2048
    s_waitcnt lgkmcnt(14)
    v_mfma_f32_16x16x32_bf16 v[16:19], v[64:67], v[64:67], v[16:19]
    v_mfma_f32_16x16x32_bf16 v[32:35], v[8:11], v[64:67], v[32:35]
    s_waitcnt lgkmcnt(12)
    v_mfma_f32_16x16x32_bf16 v[20:23], v[68:71], v[68:71], v[20:23]
    v_mfma_f32_16x16x32_bf16 v[36:39], v[8:11], v[68:71], v[36:39]
    s_waitcnt lgkmcnt(10)
    v_mfma_f32_16x16x32_bf16 v[24:27], v[72:75], v[72:75], v[24:27]
    v_mfma_f32_16x16x32_bf16 v[40:43], v[8:11], v[72:75], v[40:43]
    s_waitcnt lgkmcnt(8)
    v_mfma_f32_16x16x32_bf16 v[28:31], v[76:79], v[76:79], v[28:31]
    v_mfma_f32_16x16x32_bf16 v[44:47], v[8:11], v[76:79], v[44:47]
    ds_read_b64_tr_b16 v[64:65], v4 offset:4096
    ds_read_b64_tr_b16 v[66:67], v4 offset:6144
    ds_read_b64_tr_b16 v[68:69], v5 offset:4096
    ds_read_b64_tr_b16 v[70:71], v5 offset:6144
    ds_read_b64_tr_b16 v[72:73], v6 offset:4096
    ds_read_b64_tr_b16 v[74:75], v6 offset:6144
    ds_read_b64_tr_b16 v[76:77], v7 offset:4096
    ds_read_b64_tr_b16 v[78:79], v7 offset:6144
    s_waitcnt lgkmcnt(14)
    v_mfma_f32_16x16x32_bf16 v[16:19], v[48:51], v[48:51], v[16:19]
    v_mfma_f32_16x16x32_bf16 v[32:35], v[8:11], v[48:51], v[32:35]
    s_waitcnt lgkmcnt(12)
    v_mfma_f32_16x16x32_bf16 v[20:23], v[52:55], v[52:55], v[20:23]
    v_mfma_f32_16x16x32_bf16 v[36:39], v[8:11], v[52:55], v[36:39]
    s_waitcnt lgkmcnt(10)
    v_mfma_f32_16x16x32_bf16 v[24:27], v[56:59], v[56:59], v[24:27]
    v_mfma_f32_16x16x32_bf16 v[40:43], v[8:11], v[56:59], v[40:43]
    s_waitcnt lgkmcnt(8)
    v_mfma_f32_16x16x32_bf16 v[28:31], v[60:63], v[60:63], v[28:31]
    v_mfma_f32_16x16x32_bf16 v[44:47], v[8:11], v[60:63], v[44:47]
    s_waitcnt vmcnt(0)
    s_barrier
    s_setprio 3
    ds_read_b64_tr_b16 v[48:49], v4 offset:8192
    ds_read_b64_tr_b16 v[50:51], v4 offset:10240
    ds_read_b64_tr_b16 v[52:53], v5 offset:8192
    ds_read_b64_tr_b16 v[54:55], v5 offset:10240
    ds_read_b64_tr_b16 v[56:57], v6 offset:8192
    ds_read_b64_tr_b16 v[58:59], v6 offset:10240
    ds_read_b64_tr_b16 v[60:61], v7 offset:8192
    ds_read_b64_tr_b16 v[62:63], v7 offset:10240
    s_waitcnt lgkmcnt(14)
    v_mfma_f32_16x16x32_bf16 v[16:19], v[64:67], v[64:67], v[16:19]
    v_mfma_f32_16x16x32_bf16 v[32:35], v[8:11], v[64:67], v[32:35]
    s_waitcnt lgkmcnt(12)
    v_mfma_f32_16x16x32_bf16 v[20:23], v[68:71], v[68:71], v[20:23]
    v_mfma_f32_16x16x32_bf16 v[36:39], v[8:11], v[68:71], v[36:39]
    s_waitcnt lgkmcnt(10)
    v_mfma_f32_16x16x32_bf16 v[24:27], v[72:75], v[72:75], v[24:27]
    v_mfma_f32_16x16x32_bf16 v[40:43], v[8:11], v[72:75], v[40:43]
    s_waitcnt lgkmcnt(8)
    v_mfma_f32_16x16x32_bf16 v[28:31], v[76:79], v[76:79], v[28:31]
    v_mfma_f32_16x16x32_bf16 v[44:47], v[8:11], v[76:79], v[44:47]
    ds_read_b64_tr_b16 v[64:65], v4 offset:12288
    ds_read_b64_tr_b16 v[66:67], v4 offset:14336
    ds_read_b64_tr_b16 v[68:69], v5 offset:12288
    ds_read_b64_tr_b16 v[70:71], v5 offset:14336
    ds_read_b64_tr_b16 v[72:73], v6 offset:12288
    ds_read_b64_tr_b16 v[74:75], v6 offset:14336
    ds_read_b64_tr_b16 v[76:77], v7 offset:12288
    ds_read_b64_tr_b16 v[78:79], v7 offset:14336
    s_waitcnt lgkmcnt(14)
    v_mfma_f32_16x16x32_bf16 v[16:19], v[48:51], v[48:51], v[16:19]
    v_mfma_f32_16x16x32_bf16 v[32:35], v[8:11], v[48:51], v[32:35]
    s_waitcnt lgkmcnt(12)
    v_mfma_f32_16x16x32_bf16 v[20:23], v[52:55], v[52:55], v[20:23]
    v_mfma_f32_16x16x32_bf16 v[36:39], v[8:11], v[52:55], v[36:39]
    s_waitcnt lgkmcnt(10)
    v_mfma_f32_16x16x32_bf16 v[24:27], v[56:59], v[56:59], v[24:27]
    v_mfma_f32_16x16x32_bf16 v[40:43], v[8:11], v[56:59], v[40:43]
    s_waitcnt lgkmcnt(8)
    v_mfma_f32_16x16x32_bf16 v[28:31], v[60:63], v[60:63], v[28:31]
    v_mfma_f32_16x16x32_bf16 v[44:47], v[8:11], v[60:63], v[44:47]
    ds_read_b64_tr_b16 v[48:49], v4 offset:16384
    ds_read_b64_tr_b16 v[50:51], v4 offset:18432
    ds_read_b64_tr_b16 v[52:53], v5 offset:16384
    ds_read_b64_tr_b16 v[54:55], v5 offset:18432
    ds_read_b64_tr_b16 v[56:57], v6 offset:16384
    ds_read_b64_tr_b16 v[58:59], v6 offset:18432
    ds_read_b64_tr_b16 v[60:61], v7 offset:16384
    ds_read_b64_tr_b16 v[62:63], v7 offset:18432
    s_waitcnt lgkmcnt(14)
    v_mfma_f32_16x16x32_bf16 v[16:19], v[64:67], v[64:67], v[16:19]
    v_mfma_f32_16x16x32_bf16 v[32:35], v[8:11], v[64:67], v[32:35]
    s_waitcnt lgkmcnt(12)
    v_mfma_f32_16x16x32_bf16 v[20:23], v[68:71], v[68:71], v[20:23]
    v_mfma_f32_16x16x32_bf16 v[36:39], v[8:11], v[68:71], v[36:39]
    s_waitcnt lgkmcnt(10)
    v_mfma_f32_16x16x32_bf16 v[24:27], v[72:75], v[72:75], v[24:27]
    v_mfma_f32_16x16x32_bf16 v[40:43], v[8:11], v[72:75], v[40:43]
    s_waitcnt lgkmcnt(8)
    v_mfma_f32_16x16x32_bf16 v[28:31], v[76:79], v[76:79], v[28:31]
    v_mfma_f32_16x16x32_bf16 v[44:47], v[8:11], v[76:79], v[44:47]
    ds_read_b64_tr_b16 v[64:65], v4 offset:20480
    ds_read_b64_tr_b16 v[66:67], v4 offset:22528
    ds_read_b64_tr_b16 v[68:69], v5 offset:20480
    ds_read_b64_tr_b16 v[70:71], v5 offset:22528
    ds_read_b64_tr_b16 v[72:73], v6 offset:20480
    ds_read_b64_tr_b16 v[74:75], v6 offset:22528
    ds_read_b64_tr_b16 v[76:77], v7 offset:20480
    ds_read_b64_tr_b16 v[78:79], v7 offset:22528
    s_waitcnt lgkmcnt(14)
    v_mfma_f32_16x16x32_bf16 v[16:19], v[48:51], v[48:51], v[16:19]
    v_mfma_f32_16x16x32_bf16 v[32:35], v[8:11], v[48:51], v[32:35]
    s_waitcnt lgkmcnt(12)
    v_mfma_f32_16x16x32_bf16 v[20:23], v[52:55], v[52:55], v[20:23]
    v_mfma_f32_16x16x32_bf16 v[36:39], v[8:11], v[52:55], v[36:39]
    s_waitcnt lgkmcnt(10)
    v_mfma_f32_16x16x32_bf16 v[24:27], v[56:59], v[56:59], v[24:27]
    v_mfma_f32_16x16x32_bf16 v[40:43], v[8:11], v[56:59], v[40:43]
    s_waitcnt lgkmcnt(8)
    v_mfma_f32_16x16x32_bf16 v[28:31], v[60:63], v[60:63], v[28:31]
    v_mfma_f32_16x16x32_bf16 v[44:47], v[8:11], v[60:63], v[44:47]
    ds_read_b64_tr_b16 v[48:49], v4 offset:24576
    ds_read_b64_tr_b16 v[50:51], v4 offset:26624
    ds_read_b64_tr_b16 v[52:53], v5 offset:24576
    ds_read_b64_tr_b16 v[54:55], v5 offset:26624
    ds_read_b64_tr_b16 v[56:57], v6 offset:24576
    ds_read_b64_tr_b16 v[58:59], v6 offset:26624
    ds_read_b64_tr_b16 v[60:61], v7 offset:24576
    ds_read_b64_tr_b16 v[62:63], v7 offset:26624
    s_waitcnt lgkmcnt(14)
    v_mfma_f32_16x16x32_bf16 v[16:19], v[64:67], v[64:67], v[16:19]
    v_mfma_f32_16x16x32_bf16 v[32:35], v[8:11], v[64:67], v[32:35]
    s_waitcnt lgkmcnt(12)
    v_mfma_f32_16x16x32_bf16 v[20:23], v[68:71], v[68:71], v[20:23]
    v_mfma_f32_16x16x32_bf16 v[36:39], v[8:11], v[68:71], v[36:39]
    s_waitcnt lgkmcnt(10)
    v_mfma_f32_16x16x32_bf16 v[24:27], v[72:75], v[72:75], v[24:27]
    v_mfma_f32_16x16x32_bf16 v[40:43], v[8:11], v[72:75], v[40:43]
    s_waitcnt lgkmcnt(8)
    v_mfma_f32_16x16x32_bf16 v[28:31], v[76:79], v[76:79], v[28:31]
    v_mfma_f32_16x16x32_bf16 v[44:47], v[8:11], v[76:79], v[44:47]
    ds_read_b64_tr_b16 v[64:65], v4 offset:28672
    ds_read_b64_tr_b16 v[66:67], v4 offset:30720
    ds_read_b64_tr_b16 v[68:69], v5 offset:28672
    ds_read_b64_tr_b16 v[70:71], v5 offset:30720
    ds_read_b64_tr_b16 v[72:73], v6 offset:28672
    ds_read_b64_tr_b16 v[74:75], v6 offset:30720
    ds_read_b64_tr_b16 v[76:77], v7 offset:28672
    ds_read_b64_tr_b16 v[78:79], v7 offset:30720
    s_waitcnt lgkmcnt(14)
    v_mfma_f32_16x16x32_bf16 v[16:19], v[48:51], v[48:51], v[16:19]
    v_mfma_f32_16x16x32_bf16 v[32:35], v[8:11], v[48:51], v[32:35]
    s_waitcnt lgkmcnt(12)
    v_mfma_f32_16x16x32_bf16 v[20:23], v[52:55], v[52:55], v[20:23]
    v_mfma_f32_16x16x32_bf16 v[36:39], v[8:11], v[52:55], v[36:39]
    s_waitcnt lgkmcnt(10)
    v_mfma_f32_16x16x32_bf16 v[24:27], v[56:59], v[56:59], v[24:27]
    v_mfma_f32_16x16x32_bf16 v[40:43], v[8:11], v[56:59], v[40:43]
    s_waitcnt lgkmcnt(8)
    v_mfma_f32_16x16x32_bf16 v[28:31], v[60:63], v[60:63], v[28:31]
    v_mfma_f32_16x16x32_bf16 v[44:47], v[8:11], v[60:63], v[44:47]
    ds_read_b64_tr_b16 v[48:49], v4 offset:32768
    ds_read_b64_tr_b16 v[50:51], v4 offset:34816
    ds_read_b64_tr_b16 v[52:53], v5 offset:32768
    ds_read_b64_tr_b16 v[54:55], v5 offset:34816
    ds_read_b64_tr_b16 v[56:57], v6 offset:32768
    ds_read_b64_tr_b16 v[58:59], v6 offset:34816
    ds_read_b64_tr_b16 v[60:61], v7 offset:32768
    ds_read_b64_tr_b16 v[62:63], v7 offset:34816
    s_waitcnt lgkmcnt(14)
    v_mfma_f32_16x16x32_bf16 v[16:19], v[64:67], v[64:67], v[16:19]
    v_mfma_f32_16x16x32_bf16 v[32:35], v[8:11], v[64:67], v[32:35]
    s_waitcnt lgkmcnt(12)
    v_mfma_f32_16x16x32_bf16 v[20:23], v[68:71], v[68:71], v[20:23]
    v_mfma_f32_16x16x32_bf16 v[36:39], v[8:11], v[68:71], v[36:39]
    s_waitcnt lgkmcnt(10)
    v_mfma_f32_16x16x32_bf16 v[24:27], v[72:75], v[72:75], v[24:27]
    v_mfma_f32_16x16x32_bf16 v[40:43], v[8:11], v[72:75], v[40:43]
    s_waitcnt lgkmcnt(8)
    v_mfma_f32_16x16x32_bf16 v[28:31], v[76:79], v[76:79], v[28:31]
    v_mfma_f32_16x16x32_bf16 v[44:47], v[8:11], v[76:79], v[44:47]
    ds_read_b64_tr_b16 v[64:65], v4 offset:36864
    ds_read_b64_tr_b16 v[66:67], v4 offset:38912
    ds_read_b64_tr_b16 v[68:69], v5 offset:36864
    ds_read_b64_tr_b16 v[70:71], v5 offset:38912
    ds_read_b64_tr_b16 v[72:73], v6 offset:36864
    ds_read_b64_tr_b16 v[74:75], v6 offset:38912
    ds_read_b64_tr_b16 v[76:77], v7 offset:36864
    ds_read_b64_tr_b16 v[78:79], v7 offset:38912
    s_waitcnt lgkmcnt(14)
    v_mfma_f32_16x16x32_bf16 v[16:19], v[48:51], v[48:51], v[16:19]
    v_mfma_f32_16x16x32_bf16 v[32:35], v[8:11], v[48:51], v[32:35]
    s_waitcnt lgkmcnt(12)
    v_mfma_f32_16x16x32_bf16 v[20:23], v[52:55], v[52:55], v[20:23]
    v_mfma_f32_16x16x32_bf16 v[36:39], v[8:11], v[52:55], v[36:39]
    s_waitcnt lgkmcnt(10)
    v_mfma_f32_16x16x32_bf16 v[24:27], v[56:59], v[56:59], v[24:27]
    v_mfma_f32_16x16x32_bf16 v[40:43], v[8:11], v[56:59], v[40:43]
    s_waitcnt lgkmcnt(8)
    v_mfma_f32_16x16x32_bf16 v[28:31], v[60:63], v[60:63], v[28:31]
    v_mfma_f32_16x16x32_bf16 v[44:47], v[8:11], v[60:63], v[44:47]
    s_waitcnt lgkmcnt(6)
    v_mfma_f32_16x16x32_bf16 v[16:19], v[64:67], v[64:67], v[16:19]
    v_mfma_f32_16x16x32_bf16 v[32:35], v[8:11], v[64:67], v[32:35]
    s_waitcnt lgkmcnt(4)
    v_mfma_f32_16x16x32_bf16 v[20:23], v[68:71], v[68:71], v[20:23]
    v_mfma_f32_16x16x32_bf16 v[36:39], v[8:11], v[68:71], v[36:39]
    s_waitcnt lgkmcnt(2)
    v_mfma_f32_16x16x32_bf16 v[24:27], v[72:75], v[72:75], v[24:27]
    v_mfma_f32_16x16x32_bf16 v[40:43], v[8:11], v[72:75], v[40:43]
    s_waitcnt lgkmcnt(0)
    v_mfma_f32_16x16x32_bf16 v[28:31], v[76:79], v[76:79], v[28:31]
    v_mfma_f32_16x16x32_bf16 v[44:47], v[8:11], v[76:79], v[44:47]
    v_and_b32 v12, 15, v0
    v_bfe_u32 v13, v0, 4, 2
    v_and_b32 v14, 1, v0
    v_cmp_eq_u32 s[28:29], 1, v14
    v_and_b32 v14, 2, v0
    v_cmp_eq_u32 s[30:31], 2, v14
    v_cndmask_b32 v16, v16, v17, s[28:29]
    v_cndmask_b32 v18, v18, v19, s[28:29]
    v_cndmask_b32 v16, v16, v18, s[30:31]
    v_mul_f32 v32, 0x3acccccd, v32
    v_mul_f32 v16, 0x3acccccd, v16
    v_fma_f32 v16, -v32, v32, v16
    v_max_f32 v16, 0, v16
    v_cvt_pk_bf16_f32 v16, v16, v16
    v_lshlrev_b32 v16, 16, v16
    v_add_f32 v16, 0x3727c5ac, v16
    v_cvt_pk_bf16_f32 v16, v16, v16
    v_lshlrev_b32 v16, 16, v16
    v_sqrt_f32 v16, v16
    s_nop 0
    v_cvt_pk_bf16_f32 v16, v16, v16
    v_lshlrev_b32 v16, 16, v16
    v_rcp_f32 v16, v16
    v_cvt_pk_bf16_f32 v32, v32, v32
    v_lshlrev_b32 v32, 16, v32
    v_cndmask_b32 v20, v20, v21, s[28:29]
    v_cndmask_b32 v22, v22, v23, s[28:29]
    v_cndmask_b32 v20, v20, v22, s[30:31]
    v_mul_f32 v36, 0x3acccccd, v36
    v_mul_f32 v20, 0x3acccccd, v20
    v_fma_f32 v20, -v36, v36, v20
    v_max_f32 v20, 0, v20
    v_cvt_pk_bf16_f32 v20, v20, v20
    v_lshlrev_b32 v20, 16, v20
    v_add_f32 v20, 0x3727c5ac, v20
    v_cvt_pk_bf16_f32 v20, v20, v20
    v_lshlrev_b32 v20, 16, v20
    v_sqrt_f32 v20, v20
    s_nop 0
    v_cvt_pk_bf16_f32 v20, v20, v20
    v_lshlrev_b32 v20, 16, v20
    v_rcp_f32 v20, v20
    v_cvt_pk_bf16_f32 v36, v36, v36
    v_lshlrev_b32 v36, 16, v36
    v_cndmask_b32 v24, v24, v25, s[28:29]
    v_cndmask_b32 v26, v26, v27, s[28:29]
    v_cndmask_b32 v24, v24, v26, s[30:31]
    v_mul_f32 v40, 0x3acccccd, v40
    v_mul_f32 v24, 0x3acccccd, v24
    v_fma_f32 v24, -v40, v40, v24
    v_max_f32 v24, 0, v24
    v_cvt_pk_bf16_f32 v24, v24, v24
    v_lshlrev_b32 v24, 16, v24
    v_add_f32 v24, 0x3727c5ac, v24
    v_cvt_pk_bf16_f32 v24, v24, v24
    v_lshlrev_b32 v24, 16, v24
    v_sqrt_f32 v24, v24
    s_nop 0
    v_cvt_pk_bf16_f32 v24, v24, v24
    v_lshlrev_b32 v24, 16, v24
    v_rcp_f32 v24, v24
    v_cvt_pk_bf16_f32 v40, v40, v40
    v_lshlrev_b32 v40, 16, v40
    v_cndmask_b32 v28, v28, v29, s[28:29]
    v_cndmask_b32 v30, v30, v31, s[28:29]
    v_cndmask_b32 v28, v28, v30, s[30:31]
    v_mul_f32 v44, 0x3acccccd, v44
    v_mul_f32 v28, 0x3acccccd, v28
    v_fma_f32 v28, -v44, v44, v28
    v_max_f32 v28, 0, v28
    v_cvt_pk_bf16_f32 v28, v28, v28
    v_lshlrev_b32 v28, 16, v28
    v_add_f32 v28, 0x3727c5ac, v28
    v_cvt_pk_bf16_f32 v28, v28, v28
    v_lshlrev_b32 v28, 16, v28
    v_sqrt_f32 v28, v28
    s_nop 0
    v_cvt_pk_bf16_f32 v28, v28, v28
    v_lshlrev_b32 v28, 16, v28
    v_rcp_f32 v28, v28
    v_cvt_pk_bf16_f32 v44, v44, v44
    v_lshlrev_b32 v44, 16, v44
    v_lshrrev_b32 v14, 2, v12
    v_cmp_eq_u32 vcc, v14, v13
    v_lshlrev_b32 v12, 2, v12
    s_and_saveexec_b64 s[28:29], vcc
    ds_write_b32 v12, v32 offset:2048
    ds_write_b32 v12, v16 offset:2304
    ds_write_b32 v12, v36 offset:2112
    ds_write_b32 v12, v20 offset:2368
    ds_write_b32 v12, v40 offset:2176
    ds_write_b32 v12, v24 offset:2432
    ds_write_b32 v12, v44 offset:2240
    ds_write_b32 v12, v28 offset:2496
    s_waitcnt lgkmcnt(0)
    s_barrier
    s_mov_b64 exec, -1
    s_cmp_eq_u32 s7, 0
    s_cbranch_scc1 k2_exit
    v_and_b32 v4, 3, v0
    v_lshlrev_b32 v4, 7, v4
    v_bfe_u32 v5, v0, 2, 4
    v_lshl_add_u32 v4, v5, 3, v4
    v_add_u32 v4, 4096, v4
    s_cmp_eq_u32 s36, 3
    s_cselect_b32 s39, 1, 0
    s_barrier
    ds_read_b64_tr_b16 v[48:49], v4 offset:0
    ds_read_b64_tr_b16 v[50:51], v4 offset:2048
    ds_read_b64_tr_b16 v[52:53], v4 offset:4096
    ds_read_b64_tr_b16 v[54:55], v4 offset:6144
    ds_read_b64_tr_b16 v[56:57], v4 offset:8192
    ds_read_b64_tr_b16 v[58:59], v4 offset:10240
    ds_read_b64_tr_b16 v[60:61], v4 offset:12288
    ds_read_b64_tr_b16 v[62:63], v4 offset:14336
    ds_read_b64_tr_b16 v[64:65], v4 offset:16384
    ds_read_b64_tr_b16 v[66:67], v4 offset:18432
    ds_read_b64_tr_b16 v[68:69], v4 offset:20480
    ds_read_b64_tr_b16 v[70:71], v4 offset:22528
    ds_read_b64_tr_b16 v[72:73], v4 offset:24576
    ds_read_b64_tr_b16 v[74:75], v4 offset:26624
    s_waitcnt lgkmcnt(0)
    s_cmp_eq_u32 s39, 0
    s_cbranch_scc1 k2_gemm1_kernel_z61
    v_mov_b32 v72, 0
    v_mov_b32 v73, 0
    v_mov_b32 v74, 0
    v_mov_b32 v75, 0
    s_nop 1
k2_gemm1_kernel_z61:
    v_mfma_f32_16x16x32_bf16 v[16:19], v[48:51], v[48:51], 0
    v_mfma_f32_16x16x32_bf16 v[32:35], v[8:11], v[48:51], 0
    v_mfma_f32_16x16x32_bf16 v[16:19], v[52:55], v[52:55], v[16:19]
    v_mfma_f32_16x16x32_bf16 v[32:35], v[8:11], v[52:55], v[32:35]
    v_mfma_f32_16x16x32_bf16 v[16:19], v[56:59], v[56:59], v[16:19]
    v_mfma_f32_16x16x32_bf16 v[32:35], v[8:11], v[56:59], v[32:35]
    v_mfma_f32_16x16x32_bf16 v[16:19], v[60:63], v[60:63], v[16:19]
    v_mfma_f32_16x16x32_bf16 v[32:35], v[8:11], v[60:63], v[32:35]
    v_mfma_f32_16x16x32_bf16 v[16:19], v[64:67], v[64:67], v[16:19]
    v_mfma_f32_16x16x32_bf16 v[32:35], v[8:11], v[64:67], v[32:35]
    v_mfma_f32_16x16x32_bf16 v[16:19], v[68:71], v[68:71], v[16:19]
    v_mfma_f32_16x16x32_bf16 v[32:35], v[8:11], v[68:71], v[32:35]
    v_mfma_f32_16x16x32_bf16 v[16:19], v[72:75], v[72:75], v[16:19]
    v_mfma_f32_16x16x32_bf16 v[32:35], v[8:11], v[72:75], v[32:35]
    s_barrier
    ds_read_b64_tr_b16 v[48:49], v4 offset:512
    ds_read_b64_tr_b16 v[50:51], v4 offset:2560
    ds_read_b64_tr_b16 v[52:53], v4 offset:4608
    ds_read_b64_tr_b16 v[54:55], v4 offset:6656
    ds_read_b64_tr_b16 v[56:57], v4 offset:8704
    ds_read_b64_tr_b16 v[58:59], v4 offset:10752
    ds_read_b64_tr_b16 v[60:61], v4 offset:12800
    ds_read_b64_tr_b16 v[62:63], v4 offset:14848
    ds_read_b64_tr_b16 v[64:65], v4 offset:16896
    ds_read_b64_tr_b16 v[66:67], v4 offset:18944
    ds_read_b64_tr_b16 v[68:69], v4 offset:20992
    ds_read_b64_tr_b16 v[70:71], v4 offset:23040
    ds_read_b64_tr_b16 v[72:73], v4 offset:25088
    ds_read_b64_tr_b16 v[74:75], v4 offset:27136
    s_waitcnt lgkmcnt(0)
    s_cmp_eq_u32 s39, 0
    s_cbranch_scc1 k2_gemm1_kernel_z62
    v_mov_b32 v72, 0
    v_mov_b32 v73, 0
    v_mov_b32 v74, 0
    v_mov_b32 v75, 0
    s_nop 1
k2_gemm1_kernel_z62:
    v_mfma_f32_16x16x32_bf16 v[20:23], v[48:51], v[48:51], 0
    v_mfma_f32_16x16x32_bf16 v[36:39], v[8:11], v[48:51], 0
    v_mfma_f32_16x16x32_bf16 v[20:23], v[52:55], v[52:55], v[20:23]
    v_mfma_f32_16x16x32_bf16 v[36:39], v[8:11], v[52:55], v[36:39]
    v_mfma_f32_16x16x32_bf16 v[20:23], v[56:59], v[56:59], v[20:23]
    v_mfma_f32_16x16x32_bf16 v[36:39], v[8:11], v[56:59], v[36:39]
    v_mfma_f32_16x16x32_bf16 v[20:23], v[60:63], v[60:63], v[20:23]
    v_mfma_f32_16x16x32_bf16 v[36:39], v[8:11], v[60:63], v[36:39]
    v_mfma_f32_16x16x32_bf16 v[20:23], v[64:67], v[64:67], v[20:23]
    v_mfma_f32_16x16x32_bf16 v[36:39], v[8:11], v[64:67], v[36:39]
    v_mfma_f32_16x16x32_bf16 v[20:23], v[68:71], v[68:71], v[20:23]
    v_mfma_f32_16x16x32_bf16 v[36:39], v[8:11], v[68:71], v[36:39]
    v_mfma_f32_16x16x32_bf16 v[20:23], v[72:75], v[72:75], v[20:23]
    v_mfma_f32_16x16x32_bf16 v[36:39], v[8:11], v[72:75], v[36:39]
    s_barrier
    ds_read_b64_tr_b16 v[48:49], v4 offset:1024
    ds_read_b64_tr_b16 v[50:51], v4 offset:3072
    ds_read_b64_tr_b16 v[52:53], v4 offset:5120
    ds_read_b64_tr_b16 v[54:55], v4 offset:7168
    ds_read_b64_tr_b16 v[56:57], v4 offset:9216
    ds_read_b64_tr_b16 v[58:59], v4 offset:11264
    ds_read_b64_tr_b16 v[60:61], v4 offset:13312
    ds_read_b64_tr_b16 v[62:63], v4 offset:15360
    ds_read_b64_tr_b16 v[64:65], v4 offset:17408
    ds_read_b64_tr_b16 v[66:67], v4 offset:19456
    ds_read_b64_tr_b16 v[68:69], v4 offset:21504
    ds_read_b64_tr_b16 v[70:71], v4 offset:23552
    ds_read_b64_tr_b16 v[72:73], v4 offset:25600
    ds_read_b64_tr_b16 v[74:75], v4 offset:27648
    s_waitcnt lgkmcnt(0)
    s_cmp_eq_u32 s39, 0
    s_cbranch_scc1 k2_gemm1_kernel_z63
    v_mov_b32 v72, 0
    v_mov_b32 v73, 0
    v_mov_b32 v74, 0
    v_mov_b32 v75, 0
    s_nop 1
k2_gemm1_kernel_z63:
    v_mfma_f32_16x16x32_bf16 v[24:27], v[48:51], v[48:51], 0
    v_mfma_f32_16x16x32_bf16 v[40:43], v[8:11], v[48:51], 0
    v_mfma_f32_16x16x32_bf16 v[24:27], v[52:55], v[52:55], v[24:27]
    v_mfma_f32_16x16x32_bf16 v[40:43], v[8:11], v[52:55], v[40:43]
    v_mfma_f32_16x16x32_bf16 v[24:27], v[56:59], v[56:59], v[24:27]
    v_mfma_f32_16x16x32_bf16 v[40:43], v[8:11], v[56:59], v[40:43]
    v_mfma_f32_16x16x32_bf16 v[24:27], v[60:63], v[60:63], v[24:27]
    v_mfma_f32_16x16x32_bf16 v[40:43], v[8:11], v[60:63], v[40:43]
    v_mfma_f32_16x16x32_bf16 v[24:27], v[64:67], v[64:67], v[24:27]
    v_mfma_f32_16x16x32_bf16 v[40:43], v[8:11], v[64:67], v[40:43]
    v_mfma_f32_16x16x32_bf16 v[24:27], v[68:71], v[68:71], v[24:27]
    v_mfma_f32_16x16x32_bf16 v[40:43], v[8:11], v[68:71], v[40:43]
    v_mfma_f32_16x16x32_bf16 v[24:27], v[72:75], v[72:75], v[24:27]
    v_mfma_f32_16x16x32_bf16 v[40:43], v[8:11], v[72:75], v[40:43]
    s_barrier
    ds_read_b64_tr_b16 v[48:49], v4 offset:1536
    ds_read_b64_tr_b16 v[50:51], v4 offset:3584
    ds_read_b64_tr_b16 v[52:53], v4 offset:5632
    ds_read_b64_tr_b16 v[54:55], v4 offset:7680
    ds_read_b64_tr_b16 v[56:57], v4 offset:9728
    ds_read_b64_tr_b16 v[58:59], v4 offset:11776
    ds_read_b64_tr_b16 v[60:61], v4 offset:13824
    ds_read_b64_tr_b16 v[62:63], v4 offset:15872
    ds_read_b64_tr_b16 v[64:65], v4 offset:17920
    ds_read_b64_tr_b16 v[66:67], v4 offset:19968
    ds_read_b64_tr_b16 v[68:69], v4 offset:22016
    ds_read_b64_tr_b16 v[70:71], v4 offset:24064
    ds_read_b64_tr_b16 v[72:73], v4 offset:26112
    ds_read_b64_tr_b16 v[74:75], v4 offset:28160
    s_waitcnt lgkmcnt(0)
    s_cmp_eq_u32 s39, 0
    s_cbranch_scc1 k2_gemm1_kernel_z64
    v_mov_b32 v72, 0
    v_mov_b32 v73, 0
    v_mov_b32 v74, 0
    v_mov_b32 v75, 0
    s_nop 1
k2_gemm1_kernel_z64:
    v_mfma_f32_16x16x32_bf16 v[28:31], v[48:51], v[48:51], 0
    v_mfma_f32_16x16x32_bf16 v[44:47], v[8:11], v[48:51], 0
    v_mfma_f32_16x16x32_bf16 v[28:31], v[52:55], v[52:55], v[28:31]
    v_mfma_f32_16x16x32_bf16 v[44:47], v[8:11], v[52:55], v[44:47]
    v_mfma_f32_16x16x32_bf16 v[28:31], v[56:59], v[56:59], v[28:31]
    v_mfma_f32_16x16x32_bf16 v[44:47], v[8:11], v[56:59], v[44:47]
    v_mfma_f32_16x16x32_bf16 v[28:31], v[60:63], v[60:63], v[28:31]
    v_mfma_f32_16x16x32_bf16 v[44:47], v[8:11], v[60:63], v[44:47]
    v_mfma_f32_16x16x32_bf16 v[28:31], v[64:67], v[64:67], v[28:31]
    v_mfma_f32_16x16x32_bf16 v[44:47], v[8:11], v[64:67], v[44:47]
    v_mfma_f32_16x16x32_bf16 v[28:31], v[68:71], v[68:71], v[28:31]
    v_mfma_f32_16x16x32_bf16 v[44:47], v[8:11], v[68:71], v[44:47]
    v_mfma_f32_16x16x32_bf16 v[28:31], v[72:75], v[72:75], v[28:31]
    v_mfma_f32_16x16x32_bf16 v[44:47], v[8:11], v[72:75], v[44:47]
    v_and_b32 v14, 1, v0
    v_cmp_eq_u32 s[28:29], 1, v14
    v_and_b32 v14, 2, v0
    v_cmp_eq_u32 s[30:31], 2, v14
    v_and_b32 v14, 16, v0
    v_cmp_eq_u32 s[44:45], 16, v14
    v_and_b32 v14, 32, v0
    v_cmp_eq_u32 s[46:47], 32, v14
    v_cndmask_b32 v32, v32, v36, s[44:45]
    v_cndmask_b32 v40, v40, v44, s[44:45]
    v_cndmask_b32 v32, v32, v40, s[46:47]
    v_and_b32 v5, 63, v0
    v_lshlrev_b32 v5, 2, v5
    s_lshl_b32 s39, s25, 8
    buffer_atomic_add_f32 v32, v5, s[32:35], s39 offen
    v_cndmask_b32 v16, v16, v17, s[28:29]
    v_cndmask_b32 v18, v18, v19, s[28:29]
    v_cndmask_b32 v16, v16, v18, s[30:31]
    v_cndmask_b32 v20, v20, v21, s[28:29]
    v_cndmask_b32 v22, v22, v23, s[28:29]
    v_cndmask_b32 v20, v20, v22, s[30:31]
    v_cndmask_b32 v24, v24, v25, s[28:29]
    v_cndmask_b32 v26, v26, v27, s[28:29]
    v_cndmask_b32 v24, v24, v26, s[30:31]
    v_cndmask_b32 v28, v28, v29, s[28:29]
    v_cndmask_b32 v30, v30, v31, s[28:29]
    v_cndmask_b32 v28, v28, v30, s[30:31]
    s_add_u32 s39, s39, 8192
    v_bfe_u32 v14, v0, 2, 2
    v_cmp_eq_u32 vcc, v14, v13
    s_nop 0
    s_and_b64 exec, exec, vcc
    buffer_atomic_add_f32 v16, v12, s[32:35], s39 offen offset:0
    buffer_atomic_add_f32 v20, v12, s[32:35], s39 offen offset:64
    buffer_atomic_add_f32 v24, v12, s[32:35], s39 offen offset:128
    buffer_atomic_add_f32 v28, v12, s[32:35], s39 offen offset:192
    s_endpgm
k2_exit:
    s_nop 7
    s_nop 7
    s_endpgm

.globl k3_gemm2_kernel
.p2align 8
.type k3_gemm2_kernel,@function
k3_gemm2_kernel:
    s_cmp_ge_u32 s2, 256
    s_cbranch_scc1 k3_exit
    v_lshrrev_b32 v1, 6, v0
    s_nop 0
    v_readfirstlane_b32 s41, v1
    s_nop 0
    s_cmp_ge_u32 s41, 4
    s_cbranch_scc1 k3_scaler
    s_load_dwordx2 s[4:5], s[0:1], 144
    s_load_dwordx2 s[6:7], s[0:1], 88
    s_load_dwordx2 s[36:37], s[0:1], 96
    s_and_b32 s3, s2, 7
    s_lshr_b32 s38, s2, 3
    s_and_b32 s39, s3, 1
    s_lshl_b32 s39, s39, 2
    s_and_b32 s40, s38, 3
    s_add_u32 s39, s39, s40
    s_lshr_b32 s25, s3, 1
    s_lshl_b32 s25, s25, 3
    s_lshr_b32 s38, s38, 2
    s_add_u32 s25, s25, s38
    s_mul_i32 s24, s39, 7
    s_min_u32 s24, s24, 48
    s_and_b32 s26, s41, 3
    s_mul_i32 s27, s26, 36096
    s_mov_b32 s60, 0xffff0000
    v_and_b32 v1, 63, v0
    v_lshlrev_b32 v2, 4, v1
    s_waitcnt lgkmcnt(0)
    s_barrier
    s_add_u32 s8, s4, 15060992
    s_addc_u32 s9, s5, 0
    s_and_b32 s9, s9, 0xffff
    s_mov_b32 s10, 3538944
    s_mov_b32 s11, 0x20000
    s_lshl_b32 s38, s24, 16
    s_lshl_b32 s40, s26, 14
    s_add_u32 s44, s38, s40
    s_add_u32 s45, s44, 65536
    s_add_u32 s46, s44, 131072
    s_add_u32 s47, s44, 196608
    s_add_u32 s48, s44, 262144
    s_add_u32 s49, s44, 327680
    s_add_u32 s50, s44, 393216
    buffer_load_dwordx4 v[8:11], v2, s[8:11], s44 offen offset:0
    buffer_load_dwordx4 v[12:15], v2, s[8:11], s45 offen offset:0
    buffer_load_dwordx4 v[16:19], v2, s[8:11], s46 offen offset:0
    buffer_load_dwordx4 v[20:23], v2, s[8:11], s47 offen offset:0
    buffer_load_dwordx4 v[24:27], v2, s[8:11], s48 offen offset:0
    buffer_load_dwordx4 v[28:31], v2, s[8:11], s49 offen offset:0
    buffer_load_dwordx4 v[32:35], v2, s[8:11], s50 offen offset:0
    buffer_load_dwordx4 v[36:39], v2, s[8:11], s44 offen offset:1024
    buffer_load_dwordx4 v[40:43], v2, s[8:11], s45 offen offset:1024
    buffer_load_dwordx4 v[44:47], v2, s[8:11], s46 offen offset:1024
    buffer_load_dwordx4 v[48:51], v2, s[8:11], s47 offen offset:1024
    buffer_load_dwordx4 v[52:55], v2, s[8:11], s48 offen offset:1024
    buffer_load_dwordx4 v[56:59], v2, s[8:11], s49 offen offset:1024
    buffer_load_dwordx4 v[60:63], v2, s[8:11], s50 offen offset:1024
    buffer_load_dwordx4 v[64:67], v2, s[8:11], s44 offen offset:2048
    buffer_load_dwordx4 v[68:71], v2, s[8:11], s45 offen offset:2048
    buffer_load_dwordx4 v[72:75], v2, s[8:11], s46 offen offset:2048
    buffer_load_dwordx4 v[76:79], v2, s[8:11], s47 offen offset:2048
    buffer_load_dwordx4 v[80:83], v2, s[8:11], s48 offen offset:2048
    buffer_load_dwordx4 v[84:87], v2, s[8:11], s49 offen offset:2048
    buffer_load_dwordx4 v[88:91], v2, s[8:11], s50 offen offset:2048
    v_and_b32 v124, 15, v1
    v_lshrrev_b32 v125, 4, v1
    v_lshrrev_b32 v126, 5, v1
    v_and_b32 v123, 1, v125
    v_lshl_add_u32 v123, v123, 1, v126
    v_lshlrev_b32 v127, 1, v126
    v_add_u32 v127, 0, v127
    v_xor_b32 v127, v124, v127
    v_lshlrev_b32 v3, 4, v127
    v_lshl_add_u32 v3, v123, 8, v3
    s_add_u32 s38, s27, 0
    v_add_u32 v3, s38, v3
    v_lshlrev_b32 v127, 1, v126
    v_add_u32 v127, 4, v127
    v_xor_b32 v127, v124, v127
    v_lshlrev_b32 v4, 4, v127
    v_lshl_add_u32 v4, v123, 8, v4
    s_add_u32 s38, s27, 1024
    v_add_u32 v4, s38, v4
    s_add_u32 s38, s27, 34816
    v_lshl_add_u32 v5, v125, 4, s38
    s_add_u32 s38, s27, 35840
    v_mov_b32 v6, s38
    s_add_u32 s20, s4, 11522048
    s_addc_u32 s21, s5, 0
    s_and_b32 s21, s21, 0xffff
    s_mov_b32 s22, 3538944
    s_mov_b32 s23, 0x20000
    s_add_u32 s28, s4, 18616320
    s_addc_u32 s29, s5, 0
    s_and_b32 s29, s29, 0xffff
    s_mov_b32 s30, 3538944
    s_mov_b32 s31, 0x20000
    s_mov_b32 s32, s36
    s_and_b32 s33, s37, 0xffff
    s_mov_b32 s34, 4100
    s_mov_b32 s35, 0x20000
    s_and_b32 s38, s24, 1
    s_sub_u32 s69, 0, s38
    s_add_u32 s39, s24, s69
    s_lshr_b32 s40, s39, 1
    s_lshl_b32 s40, s40, 7
    s_lshl_b32 s39, s25, 2
    s_add_u32 s40, s40, s39
    s_add_u32 s40, s40, s26
    s_lshl_b32 s64, s40, 10
    s_add_u32 s65, s64, 131072
    s_lshl_b32 s66, s38, 1
    s_mov_b32 s67, 0
    ds_read_b32 v7, v6
    s_waitcnt lgkmcnt(0)
    v_readfirstlane_b32 s70, v7
    s_nop 0
    s_cmp_ge_u32 s70, 1
    s_cbranch_scc1 k3_gemm2_kernel_wrok2
k3_gemm2_kernel_wr1:
    s_sleep 1
    ds_read_b32 v7, v6
    s_waitcnt lgkmcnt(0)
    v_readfirstlane_b32 s70, v7
    s_nop 0
    s_cmp_lt_u32 s70, 1
    s_cbranch_scc1 k3_gemm2_kernel_wr1
k3_gemm2_kernel_wrok2:
    ds_read_b128 v[92:95], v3 offset:0
    ds_read_b128 v[96:99], v3 offset:2048
    ds_read_b128 v[100:103], v3 offset:4096
    ds_read_b128 v[104:107], v3 offset:6144
    ds_read_b128 v[124:127], v5
    s_waitcnt vmcnt(20) lgkmcnt(4)
    v_mfma_f32_16x16x32_bf16 a[0:3], v[8:11], v[92:95], 0
    s_waitcnt lgkmcnt(3)
    v_mfma_f32_16x16x32_bf16 a[4:7], v[8:11], v[96:99], 0
    s_waitcnt lgkmcnt(2)
    v_mfma_f32_16x16x32_bf16 a[8:11], v[8:11], v[100:103], 0
    s_waitcnt lgkmcnt(1)
    v_mfma_f32_16x16x32_bf16 a[12:15], v[8:11], v[104:107], 0
    buffer_load_dwordx4 v[8:11], v2, s[8:11], s44 offen offset:3072
    s_waitcnt vmcnt(20)
    v_mfma_f32_16x16x32_bf16 a[16:19], v[12:15], v[92:95], 0
    v_mfma_f32_16x16x32_bf16 a[20:23], v[12:15], v[96:99], 0
    v_mfma_f32_16x16x32_bf16 a[24:27], v[12:15], v[100:103], 0
    v_mfma_f32_16x16x32_bf16 a[28:31], v[12:15], v[104:107], 0
    buffer_load_dwordx4 v[12:15], v2, s[8:11], s45 offen offset:3072
    s_waitcnt vmcnt(20)
    v_mfma_f32_16x16x32_bf16 a[32:35], v[16:19], v[92:95], 0
    v_mfma_f32_16x16x32_bf16 a[36:39], v[16:19], v[96:99], 0
    v_mfma_f32_16x16x32_bf16 a[40:43], v[16:19], v[100:103], 0
    v_mfma_f32_16x16x32_bf16 a[44:47], v[16:19], v[104:107], 0
    buffer_load_dwordx4 v[16:19], v2, s[8:11], s46 offen offset:3072
    ds_read_b128 v[108:111], v4 offset:0
    ds_read_b128 v[112:115], v4 offset:2048
    ds_read_b128 v[116:119], v4 offset:4096
    ds_read_b128 v[120:123], v4 offset:6144
    s_waitcnt vmcnt(20)
    v_mfma_f32_16x16x32_bf16 a[48:51], v[20:23], v[92:95], 0
    v_mfma_f32_16x16x32_bf16 a[52:55], v[20:23], v[96:99], 0
    v_mfma_f32_16x16x32_bf16 a[56:59], v[20:23], v[100:103], 0
    v_mfma_f32_16x16x32_bf16 a[60:63], v[20:23], v[104:107], 0
    buffer_load_dwordx4 v[20:23], v2, s[8:11], s47 offen offset:3072
    s_waitcnt vmcnt(20)
    v_mfma_f32_16x16x32_bf16 a[64:67], v[24:27], v[92:95], 0
    v_mfma_f32_16x16x32_bf16 a[68:71], v[24:27], v[96:99], 0
    v_mfma_f32_16x16x32_bf16 a[72:75], v[24:27], v[100:103], 0
    v_mfma_f32_16x16x32_bf16 a[76:79], v[24:27], v[104:107], 0
    buffer_load_dwordx4 v[24:27], v2, s[8:11], s48 offen offset:3072
    s_waitcnt vmcnt(20)
    v_mfma_f32_16x16x32_bf16 a[80:83], v[28:31], v[92:95], 0
    v_mfma_f32_16x16x32_bf16 a[84:87], v[28:31], v[96:99], 0
    v_mfma_f32_16x16x32_bf16 a[88:91], v[28:31], v[100:103], 0
    v_mfma_f32_16x16x32_bf16 a[92:95], v[28:31], v[104:107], 0
    buffer_load_dwordx4 v[28:31], v2, s[8:11], s49 offen offset:3072
    s_waitcnt vmcnt(20)
    v_mfma_f32_16x16x32_bf16 a[96:99], v[32:35], v[92:95], 0
    v_mfma_f32_16x16x32_bf16 a[100:103], v[32:35], v[96:99], 0
    v_mfma_f32_16x16x32_bf16 a[104:107], v[32:35], v[100:103], 0
    v_mfma_f32_16x16x32_bf16 a[108:111], v[32:35], v[104:107], 0
    buffer_load_dwordx4 v[32:35], v2, s[8:11], s50 offen offset:3072
    s_waitcnt lgkmcnt(4)
    v_mfma_f32_16x16x32_bf16 a[112:115], v[124:127], v[92:95], 0
    v_mfma_f32_16x16x32_bf16 a[116:119], v[124:127], v[96:99], 0
    v_mfma_f32_16x16x32_bf16 a[120:123], v[124:127], v[100:103], 0
    v_mfma_f32_16x16x32_bf16 a[124:127], v[124:127], v[104:107], 0
    ds_read_b128 v[124:127], v5 offset:64
    s_add_u32 s44, s44, 4096
    s_add_u32 s45, s45, 4096
    s_add_u32 s46, s46, 4096
    s_add_u32 s47, s47, 4096
    s_add_u32 s48, s48, 4096
    s_add_u32 s49, s49, 4096
    s_add_u32 s50, s50, 4096
    s_waitcnt vmcnt(20) lgkmcnt(4)
    v_mfma_f32_16x16x32_bf16 a[0:3], v[36:39], v[108:111], a[0:3]
    s_waitcnt lgkmcnt(3)
    v_mfma_f32_16x16x32_bf16 a[4:7], v[36:39], v[112:115], a[4:7]
    s_waitcnt lgkmcnt(2)
    v_mfma_f32_16x16x32_bf16 a[8:11], v[36:39], v[116:119], a[8:11]
    s_waitcnt lgkmcnt(1)
    v_mfma_f32_16x16x32_bf16 a[12:15], v[36:39], v[120:123], a[12:15]
    buffer_load_dwordx4 v[36:39], v2, s[8:11], s44 offen offset:0
    v_mov_b32 v7, 1
    ds_write_b32 v6, v7 offset:4
    ds_read_b32 v7, v6
    s_waitcnt vmcnt(20)
    v_mfma_f32_16x16x32_bf16 a[16:19], v[40:43], v[108:111], a[16:19]
    v_mfma_f32_16x16x32_bf16 a[20:23], v[40:43], v[112:115], a[20:23]
    v_mfma_f32_16x16x32_bf16 a[24:27], v[40:43], v[116:119], a[24:27]
    v_mfma_f32_16x16x32_bf16 a[28:31], v[40:43], v[120:123], a[28:31]
    buffer_load_dwordx4 v[40:43], v2, s[8:11], s45 offen offset:0
    s_waitcnt vmcnt(20)
    v_mfma_f32_16x16x32_bf16 a[32:35], v[44:47], v[108:111], a[32:35]
    v_mfma_f32_16x16x32_bf16 a[36:39], v[44:47], v[112:115], a[36:39]
    v_mfma_f32_16x16x32_bf16 a[40:43], v[44:47], v[116:119], a[40:43]
    v_mfma_f32_16x16x32_bf16 a[44:47], v[44:47], v[120:123], a[44:47]
    buffer_load_dwordx4 v[44:47], v2, s[8:11], s46 offen offset:0
    s_waitcnt lgkmcnt(0)
    v_readfirstlane_b32 s70, v7
    s_nop 0
    s_cmp_ge_u32 s70, 2
    s_cbranch_scc1 k3_gemm2_kernel_wrok4
k3_gemm2_kernel_wr3:
    s_sleep 1
    ds_read_b32 v7, v6
    s_waitcnt lgkmcnt(0)
    v_readfirstlane_b32 s70, v7
    s_nop 0
    s_cmp_lt_u32 s70, 2
    s_cbranch_scc1 k3_gemm2_kernel_wr3
k3_gemm2_kernel_wrok4:
    ds_read_b128 v[92:95], v3 offset:8192
    ds_read_b128 v[96:99], v3 offset:10240
    ds_read_b128 v[100:103], v3 offset:12288
    ds_read_b128 v[104:107], v3 offset:14336
    s_waitcnt vmcnt(20)
    v_mfma_f32_16x16x32_bf16 a[48:51], v[48:51], v[108:111], a[48:51]
    v_mfma_f32_16x16x32_bf16 a[52:55], v[48:51], v[112:115], a[52:55]
    v_mfma_f32_16x16x32_bf16 a[56:59], v[48:51], v[116:119], a[56:59]
    v_mfma_f32_16x16x32_bf16 a[60:63], v[48:51], v[120:123], a[60:63]
    buffer_load_dwordx4 v[48:51], v2, s[8:11], s47 offen offset:0
    s_waitcnt vmcnt(20)
    v_mfma_f32_16x16x32_bf16 a[64:67], v[52:55], v[108:111], a[64:67]
    v_mfma_f32_16x16x32_bf16 a[68:71], v[52:55], v[112:115], a[68:71]
    v_mfma_f32_16x16x32_bf16 a[72:75], v[52:55], v[116:119], a[72:75]
    v_mfma_f32_16x16x32_bf16 a[76:79], v[52:55], v[120:123], a[76:79]
    buffer_load_dwordx4 v[52:55], v2, s[8:11], s48 offen offset:0
    s_waitcnt vmcnt(20)
    v_mfma_f32_16x16x32_bf16 a[80:83], v[56:59], v[108:111], a[80:83]
    v_mfma_f32_16x16x32_bf16 a[84:87], v[56:59], v[112:115], a[84:87]
    v_mfma_f32_16x16x32_bf16 a[88:91], v[56:59], v[116:119], a[88:91]
    v_mfma_f32_16x16x32_bf16 a[92:95], v[56:59], v[120:123], a[92:95]
    buffer_load_dwordx4 v[56:59], v2, s[8:11], s49 offen offset:0
    s_waitcnt vmcnt(20)
    v_mfma_f32_16x16x32_bf16 a[96:99], v[60:63], v[108:111], a[96:99]
    v_mfma_f32_16x16x32_bf16 a[100:103], v[60:63], v[112:115], a[100:103]
    v_mfma_f32_16x16x32_bf16 a[104:107], v[60:63], v[116:119], a[104:107]
    v_mfma_f32_16x16x32_bf16 a[108:111], v[60:63], v[120:123], a[108:111]
    buffer_load_dwordx4 v[60:63], v2, s[8:11], s50 offen offset:0
    v_mfma_f32_16x16x32_bf16 a[112:115], v[124:127], v[108:111], a[112:115]
    v_mfma_f32_16x16x32_bf16 a[116:119], v[124:127], v[112:115], a[116:119]
    v_mfma_f32_16x16x32_bf16 a[120:123], v[124:127], v[116:119], a[120:123]
    v_mfma_f32_16x16x32_bf16 a[124:127], v[124:127], v[120:123], a[124:127]
    ds_read_b128 v[124:127], v5 offset:128
    s_waitcnt vmcnt(20) lgkmcnt(4)
    v_mfma_f32_16x16x32_bf16 a[0:3], v[64:67], v[92:95], a[0:3]
    s_waitcnt lgkmcnt(3)
    v_mfma_f32_16x16x32_bf16 a[4:7], v[64:67], v[96:99], a[4:7]
    s_waitcnt lgkmcnt(2)
    v_mfma_f32_16x16x32_bf16 a[8:11], v[64:67], v[100:103], a[8:11]
    s_waitcnt lgkmcnt(1)
    v_mfma_f32_16x16x32_bf16 a[12:15], v[64:67], v[104:107], a[12:15]
    buffer_load_dwordx4 v[64:67], v2, s[8:11], s44 offen offset:1024
    s_waitcnt vmcnt(20)
    v_mfma_f32_16x16x32_bf16 a[16:19], v[68:71], v[92:95], a[16:19]
    v_mfma_f32_16x16x32_bf16 a[20:23], v[68:71], v[96:99], a[20:23]
    v_mfma_f32_16x16x32_bf16 a[24:27], v[68:71], v[100:103], a[24:27]
    v_mfma_f32_16x16x32_bf16 a[28:31], v[68:71], v[104:107], a[28:31]
    buffer_load_dwordx4 v[68:71], v2, s[8:11], s45 offen offset:1024
    s_waitcnt vmcnt(20)
    v_mfma_f32_16x16x32_bf16 a[32:35], v[72:75], v[92:95], a[32:35]
    v_mfma_f32_16x16x32_bf16 a[36:39], v[72:75], v[96:99], a[36:39]
    v_mfma_f32_16x16x32_bf16 a[40:43], v[72:75], v[100:103], a[40:43]
    v_mfma_f32_16x16x32_bf16 a[44:47], v[72:75], v[104:107], a[44:47]
    buffer_load_dwordx4 v[72:75], v2, s[8:11], s46 offen offset:1024
    ds_read_b128 v[108:111], v4 offset:8192
    ds_read_b128 v[112:115], v4 offset:10240
    ds_read_b128 v[116:119], v4 offset:12288
    ds_read_b128 v[120:123], v4 offset:14336
    s_waitcnt vmcnt(20)
    v_mfma_f32_16x16x32_bf16 a[48:51], v[76:79], v[92:95], a[48:51]
    v_mfma_f32_16x16x32_bf16 a[52:55], v[76:79], v[96:99], a[52:55]
    v_mfma_f32_16x16x32_bf16 a[56:59], v[76:79], v[100:103], a[56:59]
    v_mfma_f32_16x16x32_bf16 a[60:63], v[76:79], v[104:107], a[60:63]
    buffer_load_dwordx4 v[76:79], v2, s[8:11], s47 offen offset:1024
    s_waitcnt vmcnt(20)
    v_mfma_f32_16x16x32_bf16 a[64:67], v[80:83], v[92:95], a[64:67]
    v_mfma_f32_16x16x32_bf16 a[68:71], v[80:83], v[96:99], a[68:71]
    v_mfma_f32_16x16x32_bf16 a[72:75], v[80:83], v[100:103], a[72:75]
    v_mfma_f32_16x16x32_bf16 a[76:79], v[80:83], v[104:107], a[76:79]
    buffer_load_dwordx4 v[80:83], v2, s[8:11], s48 offen offset:1024
    s_waitcnt vmcnt(20)
    v_mfma_f32_16x16x32_bf16 a[80:83], v[84:87], v[92:95], a[80:83]
    v_mfma_f32_16x16x32_bf16 a[84:87], v[84:87], v[96:99], a[84:87]
    v_mfma_f32_16x16x32_bf16 a[88:91], v[84:87], v[100:103], a[88:91]
    v_mfma_f32_16x16x32_bf16 a[92:95], v[84:87], v[104:107], a[92:95]
    buffer_load_dwordx4 v[84:87], v2, s[8:11], s49 offen offset:1024
    s_waitcnt vmcnt(20)
    v_mfma_f32_16x16x32_bf16 a[96:99], v[88:91], v[92:95], a[96:99]
    v_mfma_f32_16x16x32_bf16 a[100:103], v[88:91], v[96:99], a[100:103]
    v_mfma_f32_16x16x32_bf16 a[104:107], v[88:91], v[100:103], a[104:107]
    v_mfma_f32_16x16x32_bf16 a[108:111], v[88:91], v[104:107], a[108:111]
    buffer_load_dwordx4 v[88:91], v2, s[8:11], s50 offen offset:1024
    s_waitcnt lgkmcnt(4)
    v_mfma_f32_16x16x32_bf16 a[112:115], v[124:127], v[92:95], a[112:115]
    v_mfma_f32_16x16x32_bf16 a[116:119], v[124:127], v[96:99], a[116:119]
    v_mfma_f32_16x16x32_bf16 a[120:123], v[124:127], v[100:103], a[120:123]
    v_mfma_f32_16x16x32_bf16 a[124:127], v[124:127], v[104:107], a[124:127]
    ds_read_b128 v[124:127], v5 offset:192
    s_waitcnt vmcnt(20) lgkmcnt(4)
    v_mfma_f32_16x16x32_bf16 a[0:3], v[8:11], v[108:111], a[0:3]
    s_waitcnt lgkmcnt(3)
    v_mfma_f32_16x16x32_bf16 a[4:7], v[8:11], v[112:115], a[4:7]
    s_waitcnt lgkmcnt(2)
    v_mfma_f32_16x16x32_bf16 a[8:11], v[8:11], v[116:119], a[8:11]
    s_waitcnt lgkmcnt(1)
    v_mfma_f32_16x16x32_bf16 a[12:15], v[8:11], v[120:123], a[12:15]
    buffer_load_dwordx4 v[8:11], v2, s[8:11], s44 offen offset:2048
    v_mov_b32 v7, 2
    ds_write_b32 v6, v7 offset:4
    ds_read_b32 v7, v6
    s_waitcnt vmcnt(20)
    v_mfma_f32_16x16x32_bf16 a[16:19], v[12:15], v[108:111], a[16:19]
    v_mfma_f32_16x16x32_bf16 a[20:23], v[12:15], v[112:115], a[20:23]
    v_mfma_f32_16x16x32_bf16 a[24:27], v[12:15], v[116:119], a[24:27]
    v_mfma_f32_16x16x32_bf16 a[28:31], v[12:15], v[120:123], a[28:31]
    buffer_load_dwordx4 v[12:15], v2, s[8:11], s45 offen offset:2048
    s_waitcnt vmcnt(20)
    v_mfma_f32_16x16x32_bf16 a[32:35], v[16:19], v[108:111], a[32:35]
    v_mfma_f32_16x16x32_bf16 a[36:39], v[16:19], v[112:115], a[36:39]
    v_mfma_f32_16x16x32_bf16 a[40:43], v[16:19], v[116:119], a[40:43]
    v_mfma_f32_16x16x32_bf16 a[44:47], v[16:19], v[120:123], a[44:47]
    buffer_load_dwordx4 v[16:19], v2, s[8:11], s46 offen offset:2048
    s_waitcnt lgkmcnt(0)
    v_readfirstlane_b32 s70, v7
    s_nop 0
    s_cmp_ge_u32 s70, 3
    s_cbranch_scc1 k3_gemm2_kernel_wrok6
k3_gemm2_kernel_wr5:
    s_sleep 1
    ds_read_b32 v7, v6
    s_waitcnt lgkmcnt(0)
    v_readfirstlane_b32 s70, v7
    s_nop 0
    s_cmp_lt_u32 s70, 3
    s_cbranch_scc1 k3_gemm2_kernel_wr5
k3_gemm2_kernel_wrok6:
    ds_read_b128 v[92:95], v3 offset:16384
    ds_read_b128 v[96:99], v3 offset:18432
    ds_read_b128 v[100:103], v3 offset:20480
    ds_read_b128 v[104:107], v3 offset:22528
    s_waitcnt vmcnt(20)
    v_mfma_f32_16x16x32_bf16 a[48:51], v[20:23], v[108:111], a[48:51]
    v_mfma_f32_16x16x32_bf16 a[52:55], v[20:23], v[112:115], a[52:55]
    v_mfma_f32_16x16x32_bf16 a[56:59], v[20:23], v[116:119], a[56:59]
    v_mfma_f32_16x16x32_bf16 a[60:63], v[20:23], v[120:123], a[60:63]
    buffer_load_dwordx4 v[20:23], v2, s[8:11], s47 offen offset:2048
    s_waitcnt vmcnt(20)
    v_mfma_f32_16x16x32_bf16 a[64:67], v[24:27], v[108:111], a[64:67]
    v_mfma_f32_16x16x32_bf16 a[68:71], v[24:27], v[112:115], a[68:71]
    v_mfma_f32_16x16x32_bf16 a[72:75], v[24:27], v[116:119], a[72:75]
    v_mfma_f32_16x16x32_bf16 a[76:79], v[24:27], v[120:123], a[76:79]
    buffer_load_dwordx4 v[24:27], v2, s[8:11], s48 offen offset:2048
    s_waitcnt vmcnt(20)
    v_mfma_f32_16x16x32_bf16 a[80:83], v[28:31], v[108:111], a[80:83]
    v_mfma_f32_16x16x32_bf16 a[84:87], v[28:31], v[112:115], a[84:87]
    v_mfma_f32_16x16x32_bf16 a[88:91], v[28:31], v[116:119], a[88:91]
    v_mfma_f32_16x16x32_bf16 a[92:95], v[28:31], v[120:123], a[92:95]
    buffer_load_dwordx4 v[28:31], v2, s[8:11], s49 offen offset:2048
    s_waitcnt vmcnt(20)
    v_mfma_f32_16x16x32_bf16 a[96:99], v[32:35], v[108:111], a[96:99]
    v_mfma_f32_16x16x32_bf16 a[100:103], v[32:35], v[112:115], a[100:103]
    v_mfma_f32_16x16x32_bf16 a[104:107], v[32:35], v[116:119], a[104:107]
    v_mfma_f32_16x16x32_bf16 a[108:111], v[32:35], v[120:123], a[108:111]
    buffer_load_dwordx4 v[32:35], v2, s[8:11], s50 offen offset:2048
    v_mfma_f32_16x16x32_bf16 a[112:115], v[124:127], v[108:111], a[112:115]
    v_mfma_f32_16x16x32_bf16 a[116:119], v[124:127], v[112:115], a[116:119]
    v_mfma_f32_16x16x32_bf16 a[120:123], v[124:127], v[116:119], a[120:123]
    v_mfma_f32_16x16x32_bf16 a[124:127], v[124:127], v[120:123], a[124:127]
    ds_read_b128 v[124:127], v5 offset:256
    s_waitcnt vmcnt(20) lgkmcnt(4)
    v_mfma_f32_16x16x32_bf16 a[0:3], v[36:39], v[92:95], a[0:3]
    s_waitcnt lgkmcnt(3)
    v_mfma_f32_16x16x32_bf16 a[4:7], v[36:39], v[96:99], a[4:7]
    s_waitcnt lgkmcnt(2)
    v_mfma_f32_16x16x32_bf16 a[8:11], v[36:39], v[100:103], a[8:11]
    s_waitcnt lgkmcnt(1)
    v_mfma_f32_16x16x32_bf16 a[12:15], v[36:39], v[104:107], a[12:15]
    buffer_load_dwordx4 v[36:39], v2, s[8:11], s44 offen offset:3072
    s_waitcnt vmcnt(20)
    v_mfma_f32_16x16x32_bf16 a[16:19], v[40:43], v[92:95], a[16:19]
    v_mfma_f32_16x16x32_bf16 a[20:23], v[40:43], v[96:99], a[20:23]
    v_mfma_f32_16x16x32_bf16 a[24:27], v[40:43], v[100:103], a[24:27]
    v_mfma_f32_16x16x32_bf16 a[28:31], v[40:43], v[104:107], a[28:31]
    buffer_load_dwordx4 v[40:43], v2, s[8:11], s45 offen offset:3072
    s_waitcnt vmcnt(20)
    v_mfma_f32_16x16x32_bf16 a[32:35], v[44:47], v[92:95], a[32:35]
    v_mfma_f32_16x16x32_bf16 a[36:39], v[44:47], v[96:99], a[36:39]
    v_mfma_f32_16x16x32_bf16 a[40:43], v[44:47], v[100:103], a[40:43]
    v_mfma_f32_16x16x32_bf16 a[44:47], v[44:47], v[104:107], a[44:47]
    buffer_load_dwordx4 v[44:47], v2, s[8:11], s46 offen offset:3072
    ds_read_b128 v[108:111], v4 offset:16384
    ds_read_b128 v[112:115], v4 offset:18432
    ds_read_b128 v[116:119], v4 offset:20480
    ds_read_b128 v[120:123], v4 offset:22528
    s_waitcnt vmcnt(20)
    v_mfma_f32_16x16x32_bf16 a[48:51], v[48:51], v[92:95], a[48:51]
    v_mfma_f32_16x16x32_bf16 a[52:55], v[48:51], v[96:99], a[52:55]
    v_mfma_f32_16x16x32_bf16 a[56:59], v[48:51], v[100:103], a[56:59]
    v_mfma_f32_16x16x32_bf16 a[60:63], v[48:51], v[104:107], a[60:63]
    buffer_load_dwordx4 v[48:51], v2, s[8:11], s47 offen offset:3072
    s_waitcnt vmcnt(20)
    v_mfma_f32_16x16x32_bf16 a[64:67], v[52:55], v[92:95], a[64:67]
    v_mfma_f32_16x16x32_bf16 a[68:71], v[52:55], v[96:99], a[68:71]
    v_mfma_f32_16x16x32_bf16 a[72:75], v[52:55], v[100:103], a[72:75]
    v_mfma_f32_16x16x32_bf16 a[76:79], v[52:55], v[104:107], a[76:79]
    buffer_load_dwordx4 v[52:55], v2, s[8:11], s48 offen offset:3072
    s_waitcnt vmcnt(20)
    v_mfma_f32_16x16x32_bf16 a[80:83], v[56:59], v[92:95], a[80:83]
    v_mfma_f32_16x16x32_bf16 a[84:87], v[56:59], v[96:99], a[84:87]
    v_mfma_f32_16x16x32_bf16 a[88:91], v[56:59], v[100:103], a[88:91]
    v_mfma_f32_16x16x32_bf16 a[92:95], v[56:59], v[104:107], a[92:95]
    buffer_load_dwordx4 v[56:59], v2, s[8:11], s49 offen offset:3072
    s_waitcnt vmcnt(20)
    v_mfma_f32_16x16x32_bf16 a[96:99], v[60:63], v[92:95], a[96:99]
    v_mfma_f32_16x16x32_bf16 a[100:103], v[60:63], v[96:99], a[100:103]
    v_mfma_f32_16x16x32_bf16 a[104:107], v[60:63], v[100:103], a[104:107]
    v_mfma_f32_16x16x32_bf16 a[108:111], v[60:63], v[104:107], a[108:111]
    buffer_load_dwordx4 v[60:63], v2, s[8:11], s50 offen offset:3072
    s_waitcnt lgkmcnt(4)
    v_mfma_f32_16x16x32_bf16 a[112:115], v[124:127], v[92:95], a[112:115]
    v_mfma_f32_16x16x32_bf16 a[116:119], v[124:127], v[96:99], a[116:119]
    v_mfma_f32_16x16x32_bf16 a[120:123], v[124:127], v[100:103], a[120:123]
    v_mfma_f32_16x16x32_bf16 a[124:127], v[124:127], v[104:107], a[124:127]
    ds_read_b128 v[124:127], v5 offset:320
    s_add_u32 s44, s44, 4096
    s_add_u32 s45, s45, 4096
    s_add_u32 s46, s46, 4096
    s_add_u32 s47, s47, 4096
    s_add_u32 s48, s48, 4096
    s_add_u32 s49, s49, 4096
    s_add_u32 s50, s50, 4096
    s_waitcnt vmcnt(20) lgkmcnt(4)
    v_mfma_f32_16x16x32_bf16 a[0:3], v[64:67], v[108:111], a[0:3]
    s_waitcnt lgkmcnt(3)
    v_mfma_f32_16x16x32_bf16 a[4:7], v[64:67], v[112:115], a[4:7]
    s_waitcnt lgkmcnt(2)
    v_mfma_f32_16x16x32_bf16 a[8:11], v[64:67], v[116:119], a[8:11]
    s_waitcnt lgkmcnt(1)
    v_mfma_f32_16x16x32_bf16 a[12:15], v[64:67], v[120:123], a[12:15]
    buffer_load_dwordx4 v[64:67], v2, s[8:11], s44 offen offset:0
    v_mov_b32 v7, 3
    ds_write_b32 v6, v7 offset:4
    ds_read_b32 v7, v6
    s_waitcnt vmcnt(20)
    v_mfma_f32_16x16x32_bf16 a[16:19], v[68:71], v[108:111], a[16:19]
    v_mfma_f32_16x16x32_bf16 a[20:23], v[68:71], v[112:115], a[20:23]
    v_mfma_f32_16x16x32_bf16 a[24:27], v[68:71], v[116:119], a[24:27]
    v_mfma_f32_16x16x32_bf16 a[28:31], v[68:71], v[120:123], a[28:31]
    buffer_load_dwordx4 v[68:71], v2, s[8:11], s45 offen offset:0
    s_waitcnt vmcnt(20)
    v_mfma_f32_16x16x32_bf16 a[32:35], v[72:75], v[108:111], a[32:35]
    v_mfma_f32_16x16x32_bf16 a[36:39], v[72:75], v[112:115], a[36:39]
    v_mfma_f32_16x16x32_bf16 a[40:43], v[72:75], v[116:119], a[40:43]
    v_mfma_f32_16x16x32_bf16 a[44:47], v[72:75], v[120:123], a[44:47]
    buffer_load_dwordx4 v[72:75], v2, s[8:11], s46 offen offset:0
    s_waitcnt lgkmcnt(0)
    v_readfirstlane_b32 s70, v7
    s_nop 0
    s_cmp_ge_u32 s70, 4
    s_cbranch_scc1 k3_gemm2_kernel_wrok8
k3_gemm2_kernel_wr7:
    s_sleep 1
    ds_read_b32 v7, v6
    s_waitcnt lgkmcnt(0)
    v_readfirstlane_b32 s70, v7
    s_nop 0
    s_cmp_lt_u32 s70, 4
    s_cbranch_scc1 k3_gemm2_kernel_wr7
k3_gemm2_kernel_wrok8:
    ds_read_b128 v[92:95], v3 offset:24576
    ds_read_b128 v[96:99], v3 offset:26624
    ds_read_b128 v[100:103], v3 offset:28672
    ds_read_b128 v[104:107], v3 offset:30720
    s_waitcnt vmcnt(20)
    v_mfma_f32_16x16x32_bf16 a[48:51], v[76:79], v[108:111], a[48:51]
    v_mfma_f32_16x16x32_bf16 a[52:55], v[76:79], v[112:115], a[52:55]
    v_mfma_f32_16x16x32_bf16 a[56:59], v[76:79], v[116:119], a[56:59]
    v_mfma_f32_16x16x32_bf16 a[60:63], v[76:79], v[120:123], a[60:63]
    buffer_load_dwordx4 v[76:79], v2, s[8:11], s47 offen offset:0
    s_waitcnt vmcnt(20)
    v_mfma_f32_16x16x32_bf16 a[64:67], v[80:83], v[108:111], a[64:67]
    v_mfma_f32_16x16x32_bf16 a[68:71], v[80:83], v[112:115], a[68:71]
    v_mfma_f32_16x16x32_bf16 a[72:75], v[80:83], v[116:119], a[72:75]
    v_mfma_f32_16x16x32_bf16 a[76:79], v[80:83], v[120:123], a[76:79]
    buffer_load_dwordx4 v[80:83], v2, s[8:11], s48 offen offset:0
    s_waitcnt vmcnt(20)
    v_mfma_f32_16x16x32_bf16 a[80:83], v[84:87], v[108:111], a[80:83]
    v_mfma_f32_16x16x32_bf16 a[84:87], v[84:87], v[112:115], a[84:87]
    v_mfma_f32_16x16x32_bf16 a[88:91], v[84:87], v[116:119], a[88:91]
    v_mfma_f32_16x16x32_bf16 a[92:95], v[84:87], v[120:123], a[92:95]
    buffer_load_dwordx4 v[84:87], v2, s[8:11], s49 offen offset:0
    s_waitcnt vmcnt(20)
    v_mfma_f32_16x16x32_bf16 a[96:99], v[88:91], v[108:111], a[96:99]
    v_mfma_f32_16x16x32_bf16 a[100:103], v[88:91], v[112:115], a[100:103]
    v_mfma_f32_16x16x32_bf16 a[104:107], v[88:91], v[116:119], a[104:107]
    v_mfma_f32_16x16x32_bf16 a[108:111], v[88:91], v[120:123], a[108:111]
    buffer_load_dwordx4 v[88:91], v2, s[8:11], s50 offen offset:0
    v_mfma_f32_16x16x32_bf16 a[112:115], v[124:127], v[108:111], a[112:115]
    v_mfma_f32_16x16x32_bf16 a[116:119], v[124:127], v[112:115], a[116:119]
    v_mfma_f32_16x16x32_bf16 a[120:123], v[124:127], v[116:119], a[120:123]
    v_mfma_f32_16x16x32_bf16 a[124:127], v[124:127], v[120:123], a[124:127]
    ds_read_b128 v[124:127], v5 offset:384
    s_waitcnt vmcnt(20) lgkmcnt(4)
    v_mfma_f32_16x16x32_bf16 a[0:3], v[8:11], v[92:95], a[0:3]
    s_waitcnt lgkmcnt(3)
    v_mfma_f32_16x16x32_bf16 a[4:7], v[8:11], v[96:99], a[4:7]
    s_waitcnt lgkmcnt(2)
    v_mfma_f32_16x16x32_bf16 a[8:11], v[8:11], v[100:103], a[8:11]
    s_waitcnt lgkmcnt(1)
    v_mfma_f32_16x16x32_bf16 a[12:15], v[8:11], v[104:107], a[12:15]
    buffer_load_dwordx4 v[8:11], v2, s[8:11], s44 offen offset:1024
    s_waitcnt vmcnt(20)
    v_mfma_f32_16x16x32_bf16 a[16:19], v[12:15], v[92:95], a[16:19]
    v_mfma_f32_16x16x32_bf16 a[20:23], v[12:15], v[96:99], a[20:23]
    v_mfma_f32_16x16x32_bf16 a[24:27], v[12:15], v[100:103], a[24:27]
    v_mfma_f32_16x16x32_bf16 a[28:31], v[12:15], v[104:107], a[28:31]
    buffer_load_dwordx4 v[12:15], v2, s[8:11], s45 offen offset:1024
    s_waitcnt vmcnt(20)
    v_mfma_f32_16x16x32_bf16 a[32:35], v[16:19], v[92:95], a[32:35]
    v_mfma_f32_16x16x32_bf16 a[36:39], v[16:19], v[96:99], a[36:39]
    v_mfma_f32_16x16x32_bf16 a[40:43], v[16:19], v[100:103], a[40:43]
    v_mfma_f32_16x16x32_bf16 a[44:47], v[16:19], v[104:107], a[44:47]
    buffer_load_dwordx4 v[16:19], v2, s[8:11], s46 offen offset:1024
    ds_read_b128 v[108:111], v4 offset:24576
    ds_read_b128 v[112:115], v4 offset:26624
    ds_read_b128 v[116:119], v4 offset:28672
    ds_read_b128 v[120:123], v4 offset:30720
    s_waitcnt vmcnt(20)
    v_mfma_f32_16x16x32_bf16 a[48:51], v[20:23], v[92:95], a[48:51]
    v_mfma_f32_16x16x32_bf16 a[52:55], v[20:23], v[96:99], a[52:55]
    v_mfma_f32_16x16x32_bf16 a[56:59], v[20:23], v[100:103], a[56:59]
    v_mfma_f32_16x16x32_bf16 a[60:63], v[20:23], v[104:107], a[60:63]
    buffer_load_dwordx4 v[20:23], v2, s[8:11], s47 offen offset:1024
    s_waitcnt vmcnt(20)
    v_mfma_f32_16x16x32_bf16 a[64:67], v[24:27], v[92:95], a[64:67]
    v_mfma_f32_16x16x32_bf16 a[68:71], v[24:27], v[96:99], a[68:71]
    v_mfma_f32_16x16x32_bf16 a[72:75], v[24:27], v[100:103], a[72:75]
    v_mfma_f32_16x16x32_bf16 a[76:79], v[24:27], v[104:107], a[76:79]
    buffer_load_dwordx4 v[24:27], v2, s[8:11], s48 offen offset:1024
    s_waitcnt vmcnt(20)
    v_mfma_f32_16x16x32_bf16 a[80:83], v[28:31], v[92:95], a[80:83]
    v_mfma_f32_16x16x32_bf16 a[84:87], v[28:31], v[96:99], a[84:87]
    v_mfma_f32_16x16x32_bf16 a[88:91], v[28:31], v[100:103], a[88:91]
    v_mfma_f32_16x16x32_bf16 a[92:95], v[28:31], v[104:107], a[92:95]
    buffer_load_dwordx4 v[28:31], v2, s[8:11], s49 offen offset:1024
    s_waitcnt vmcnt(20)
    v_mfma_f32_16x16x32_bf16 a[96:99], v[32:35], v[92:95], a[96:99]
    v_mfma_f32_16x16x32_bf16 a[100:103], v[32:35], v[96:99], a[100:103]
    v_mfma_f32_16x16x32_bf16 a[104:107], v[32:35], v[100:103], a[104:107]
    v_mfma_f32_16x16x32_bf16 a[108:111], v[32:35], v[104:107], a[108:111]
    buffer_load_dwordx4 v[32:35], v2, s[8:11], s50 offen offset:1024
    s_waitcnt lgkmcnt(4)
    v_mfma_f32_16x16x32_bf16 a[112:115], v[124:127], v[92:95], a[112:115]
    v_mfma_f32_16x16x32_bf16 a[116:119], v[124:127], v[96:99], a[116:119]
    v_mfma_f32_16x16x32_bf16 a[120:123], v[124:127], v[100:103], a[120:123]
    v_mfma_f32_16x16x32_bf16 a[124:127], v[124:127], v[104:107], a[124:127]
    ds_read_b128 v[124:127], v5 offset:448
    s_waitcnt vmcnt(20) lgkmcnt(4)
    v_mfma_f32_16x16x32_bf16 a[0:3], v[36:39], v[108:111], a[0:3]
    s_waitcnt lgkmcnt(3)
    v_mfma_f32_16x16x32_bf16 a[4:7], v[36:39], v[112:115], a[4:7]
    s_waitcnt lgkmcnt(2)
    v_mfma_f32_16x16x32_bf16 a[8:11], v[36:39], v[116:119], a[8:11]
    s_waitcnt lgkmcnt(1)
    v_mfma_f32_16x16x32_bf16 a[12:15], v[36:39], v[120:123], a[12:15]
    buffer_load_dwordx4 v[36:39], v2, s[8:11], s44 offen offset:2048
    v_mov_b32 v7, 4
    ds_write_b32 v6, v7 offset:4
    ds_read_b32 v7, v6
    s_waitcnt vmcnt(20)
    v_mfma_f32_16x16x32_bf16 a[16:19], v[40:43], v[108:111], a[16:19]
    v_mfma_f32_16x16x32_bf16 a[20:23], v[40:43], v[112:115], a[20:23]
    v_mfma_f32_16x16x32_bf16 a[24:27], v[40:43], v[116:119], a[24:27]
    v_mfma_f32_16x16x32_bf16 a[28:31], v[40:43], v[120:123], a[28:31]
    buffer_load_dwordx4 v[40:43], v2, s[8:11], s45 offen offset:2048
    s_waitcnt vmcnt(20)
    v_mfma_f32_16x16x32_bf16 a[32:35], v[44:47], v[108:111], a[32:35]
    v_mfma_f32_16x16x32_bf16 a[36:39], v[44:47], v[112:115], a[36:39]
    v_mfma_f32_16x16x32_bf16 a[40:43], v[44:47], v[116:119], a[40:43]
    v_mfma_f32_16x16x32_bf16 a[44:47], v[44:47], v[120:123], a[44:47]
    buffer_load_dwordx4 v[44:47], v2, s[8:11], s46 offen offset:2048
    s_waitcnt lgkmcnt(0)
    v_readfirstlane_b32 s70, v7
    s_nop 0
    s_cmp_ge_u32 s70, 5
    s_cbranch_scc1 k3_gemm2_kernel_wrok10
k3_gemm2_kernel_wr9:
    s_sleep 1
    ds_read_b32 v7, v6
    s_waitcnt lgkmcnt(0)
    v_readfirstlane_b32 s70, v7
    s_nop 0
    s_cmp_lt_u32 s70, 5
    s_cbranch_scc1 k3_gemm2_kernel_wr9
k3_gemm2_kernel_wrok10:
    ds_read_b128 v[92:95], v3 offset:0
    ds_read_b128 v[96:99], v3 offset:2048
    ds_read_b128 v[100:103], v3 offset:4096
    ds_read_b128 v[104:107], v3 offset:6144
    s_waitcnt vmcnt(20)
    v_mfma_f32_16x16x32_bf16 a[48:51], v[48:51], v[108:111], a[48:51]
    v_mfma_f32_16x16x32_bf16 a[52:55], v[48:51], v[112:115], a[52:55]
    v_mfma_f32_16x16x32_bf16 a[56:59], v[48:51], v[116:119], a[56:59]
    v_mfma_f32_16x16x32_bf16 a[60:63], v[48:51], v[120:123], a[60:63]
    buffer_load_dwordx4 v[48:51], v2, s[8:11], s47 offen offset:2048
    s_waitcnt vmcnt(20)
    v_mfma_f32_16x16x32_bf16 a[64:67], v[52:55], v[108:111], a[64:67]
    v_mfma_f32_16x16x32_bf16 a[68:71], v[52:55], v[112:115], a[68:71]
    v_mfma_f32_16x16x32_bf16 a[72:75], v[52:55], v[116:119], a[72:75]
    v_mfma_f32_16x16x32_bf16 a[76:79], v[52:55], v[120:123], a[76:79]
    buffer_load_dwordx4 v[52:55], v2, s[8:11], s48 offen offset:2048
    s_waitcnt vmcnt(20)
    v_mfma_f32_16x16x32_bf16 a[80:83], v[56:59], v[108:111], a[80:83]
    v_mfma_f32_16x16x32_bf16 a[84:87], v[56:59], v[112:115], a[84:87]
    v_mfma_f32_16x16x32_bf16 a[88:91], v[56:59], v[116:119], a[88:91]
    v_mfma_f32_16x16x32_bf16 a[92:95], v[56:59], v[120:123], a[92:95]
    buffer_load_dwordx4 v[56:59], v2, s[8:11], s49 offen offset:2048
    s_waitcnt vmcnt(20)
    v_mfma_f32_16x16x32_bf16 a[96:99], v[60:63], v[108:111], a[96:99]
    v_mfma_f32_16x16x32_bf16 a[100:103], v[60:63], v[112:115], a[100:103]
    v_mfma_f32_16x16x32_bf16 a[104:107], v[60:63], v[116:119], a[104:107]
    v_mfma_f32_16x16x32_bf16 a[108:111], v[60:63], v[120:123], a[108:111]
    buffer_load_dwordx4 v[60:63], v2, s[8:11], s50 offen offset:2048
    v_mfma_f32_16x16x32_bf16 a[112:115], v[124:127], v[108:111], a[112:115]
    v_mfma_f32_16x16x32_bf16 a[116:119], v[124:127], v[112:115], a[116:119]
    v_mfma_f32_16x16x32_bf16 a[120:123], v[124:127], v[116:119], a[120:123]
    v_mfma_f32_16x16x32_bf16 a[124:127], v[124:127], v[120:123], a[124:127]
    ds_read_b128 v[124:127], v5 offset:512
    s_waitcnt vmcnt(20) lgkmcnt(4)
    v_mfma_f32_16x16x32_bf16 a[0:3], v[64:67], v[92:95], a[0:3]
    s_waitcnt lgkmcnt(3)
    v_mfma_f32_16x16x32_bf16 a[4:7], v[64:67], v[96:99], a[4:7]
    s_waitcnt lgkmcnt(2)
    v_mfma_f32_16x16x32_bf16 a[8:11], v[64:67], v[100:103], a[8:11]
    s_waitcnt lgkmcnt(1)
    v_mfma_f32_16x16x32_bf16 a[12:15], v[64:67], v[104:107], a[12:15]
    buffer_load_dwordx4 v[64:67], v2, s[8:11], s44 offen offset:3072
    s_waitcnt vmcnt(20)
    v_mfma_f32_16x16x32_bf16 a[16:19], v[68:71], v[92:95], a[16:19]
    v_mfma_f32_16x16x32_bf16 a[20:23], v[68:71], v[96:99], a[20:23]
    v_mfma_f32_16x16x32_bf16 a[24:27], v[68:71], v[100:103], a[24:27]
    v_mfma_f32_16x16x32_bf16 a[28:31], v[68:71], v[104:107], a[28:31]
    buffer_load_dwordx4 v[68:71], v2, s[8:11], s45 offen offset:3072
    s_waitcnt vmcnt(20)
    v_mfma_f32_16x16x32_bf16 a[32:35], v[72:75], v[92:95], a[32:35]
    v_mfma_f32_16x16x32_bf16 a[36:39], v[72:75], v[96:99], a[36:39]
    v_mfma_f32_16x16x32_bf16 a[40:43], v[72:75], v[100:103], a[40:43]
    v_mfma_f32_16x16x32_bf16 a[44:47], v[72:75], v[104:107], a[44:47]
    buffer_load_dwordx4 v[72:75], v2, s[8:11], s46 offen offset:3072
    ds_read_b128 v[108:111], v4 offset:0
    ds_read_b128 v[112:115], v4 offset:2048
    ds_read_b128 v[116:119], v4 offset:4096
    ds_read_b128 v[120:123], v4 offset:6144
    s_waitcnt vmcnt(20)
    v_mfma_f32_16x16x32_bf16 a[48:51], v[76:79], v[92:95], a[48:51]
    v_mfma_f32_16x16x32_bf16 a[52:55], v[76:79], v[96:99], a[52:55]
    v_mfma_f32_16x16x32_bf16 a[56:59], v[76:79], v[100:103], a[56:59]
    v_mfma_f32_16x16x32_bf16 a[60:63], v[76:79], v[104:107], a[60:63]
    buffer_load_dwordx4 v[76:79], v2, s[8:11], s47 offen offset:3072
    s_waitcnt vmcnt(20)
    v_mfma_f32_16x16x32_bf16 a[64:67], v[80:83], v[92:95], a[64:67]
    v_mfma_f32_16x16x32_bf16 a[68:71], v[80:83], v[96:99], a[68:71]
    v_mfma_f32_16x16x32_bf16 a[72:75], v[80:83], v[100:103], a[72:75]
    v_mfma_f32_16x16x32_bf16 a[76:79], v[80:83], v[104:107], a[76:79]
    buffer_load_dwordx4 v[80:83], v2, s[8:11], s48 offen offset:3072
    s_waitcnt vmcnt(20)
    v_mfma_f32_16x16x32_bf16 a[80:83], v[84:87], v[92:95], a[80:83]
    v_mfma_f32_16x16x32_bf16 a[84:87], v[84:87], v[96:99], a[84:87]
    v_mfma_f32_16x16x32_bf16 a[88:91], v[84:87], v[100:103], a[88:91]
    v_mfma_f32_16x16x32_bf16 a[92:95], v[84:87], v[104:107], a[92:95]
    buffer_load_dwordx4 v[84:87], v2, s[8:11], s49 offen offset:3072
    s_waitcnt vmcnt(20)
    v_mfma_f32_16x16x32_bf16 a[96:99], v[88:91], v[92:95], a[96:99]
    v_mfma_f32_16x16x32_bf16 a[100:103], v[88:91], v[96:99], a[100:103]
    v_mfma_f32_16x16x32_bf16 a[104:107], v[88:91], v[100:103], a[104:107]
    v_mfma_f32_16x16x32_bf16 a[108:111], v[88:91], v[104:107], a[108:111]
    buffer_load_dwordx4 v[88:91], v2, s[8:11], s50 offen offset:3072
    s_waitcnt lgkmcnt(4)
    v_mfma_f32_16x16x32_bf16 a[112:115], v[124:127], v[92:95], a[112:115]
    v_mfma_f32_16x16x32_bf16 a[116:119], v[124:127], v[96:99], a[116:119]
    v_mfma_f32_16x16x32_bf16 a[120:123], v[124:127], v[100:103], a[120:123]
    v_mfma_f32_16x16x32_bf16 a[124:127], v[124:127], v[104:107], a[124:127]
    ds_read_b128 v[124:127], v5 offset:576
    s_add_u32 s44, s44, 4096
    s_add_u32 s45, s45, 4096
    s_add_u32 s46, s46, 4096
    s_add_u32 s47, s47, 4096
    s_add_u32 s48, s48, 4096
    s_add_u32 s49, s49, 4096
    s_add_u32 s50, s50, 4096
    s_waitcnt vmcnt(20) lgkmcnt(4)
    v_mfma_f32_16x16x32_bf16 a[0:3], v[8:11], v[108:111], a[0:3]
    s_waitcnt lgkmcnt(3)
    v_mfma_f32_16x16x32_bf16 a[4:7], v[8:11], v[112:115], a[4:7]
    s_waitcnt lgkmcnt(2)
    v_mfma_f32_16x16x32_bf16 a[8:11], v[8:11], v[116:119], a[8:11]
    s_waitcnt lgkmcnt(1)
    v_mfma_f32_16x16x32_bf16 a[12:15], v[8:11], v[120:123], a[12:15]
    buffer_load_dwordx4 v[8:11], v2, s[8:11], s44 offen offset:0
    v_mov_b32 v7, 5
    ds_write_b32 v6, v7 offset:4
    ds_read_b32 v7, v6
    s_waitcnt vmcnt(20)
    v_mfma_f32_16x16x32_bf16 a[16:19], v[12:15], v[108:111], a[16:19]
    v_mfma_f32_16x16x32_bf16 a[20:23], v[12:15], v[112:115], a[20:23]
    v_mfma_f32_16x16x32_bf16 a[24:27], v[12:15], v[116:119], a[24:27]
    v_mfma_f32_16x16x32_bf16 a[28:31], v[12:15], v[120:123], a[28:31]
    buffer_load_dwordx4 v[12:15], v2, s[8:11], s45 offen offset:0
    s_waitcnt vmcnt(20)
    v_mfma_f32_16x16x32_bf16 a[32:35], v[16:19], v[108:111], a[32:35]
    v_mfma_f32_16x16x32_bf16 a[36:39], v[16:19], v[112:115], a[36:39]
    v_mfma_f32_16x16x32_bf16 a[40:43], v[16:19], v[116:119], a[40:43]
    v_mfma_f32_16x16x32_bf16 a[44:47], v[16:19], v[120:123], a[44:47]
    buffer_load_dwordx4 v[16:19], v2, s[8:11], s46 offen offset:0
    s_waitcnt lgkmcnt(0)
    v_readfirstlane_b32 s70, v7
    s_nop 0
    s_cmp_ge_u32 s70, 6
    s_cbranch_scc1 k3_gemm2_kernel_wrok12
k3_gemm2_kernel_wr11:
    s_sleep 1
    ds_read_b32 v7, v6
    s_waitcnt lgkmcnt(0)
    v_readfirstlane_b32 s70, v7
    s_nop 0
    s_cmp_lt_u32 s70, 6
    s_cbranch_scc1 k3_gemm2_kernel_wr11
k3_gemm2_kernel_wrok12:
    ds_read_b128 v[92:95], v3 offset:8192
    ds_read_b128 v[96:99], v3 offset:10240
    ds_read_b128 v[100:103], v3 offset:12288
    ds_read_b128 v[104:107], v3 offset:14336
    s_waitcnt vmcnt(20)
    v_mfma_f32_16x16x32_bf16 a[48:51], v[20:23], v[108:111], a[48:51]
    v_mfma_f32_16x16x32_bf16 a[52:55], v[20:23], v[112:115], a[52:55]
    v_mfma_f32_16x16x32_bf16 a[56:59], v[20:23], v[116:119], a[56:59]
    v_mfma_f32_16x16x32_bf16 a[60:63], v[20:23], v[120:123], a[60:63]
    buffer_load_dwordx4 v[20:23], v2, s[8:11], s47 offen offset:0
    s_waitcnt vmcnt(20)
    v_mfma_f32_16x16x32_bf16 a[64:67], v[24:27], v[108:111], a[64:67]
    v_mfma_f32_16x16x32_bf16 a[68:71], v[24:27], v[112:115], a[68:71]
    v_mfma_f32_16x16x32_bf16 a[72:75], v[24:27], v[116:119], a[72:75]
    v_mfma_f32_16x16x32_bf16 a[76:79], v[24:27], v[120:123], a[76:79]
    buffer_load_dwordx4 v[24:27], v2, s[8:11], s48 offen offset:0
    s_waitcnt vmcnt(20)
    v_mfma_f32_16x16x32_bf16 a[80:83], v[28:31], v[108:111], a[80:83]
    v_mfma_f32_16x16x32_bf16 a[84:87], v[28:31], v[112:115], a[84:87]
    v_mfma_f32_16x16x32_bf16 a[88:91], v[28:31], v[116:119], a[88:91]
    v_mfma_f32_16x16x32_bf16 a[92:95], v[28:31], v[120:123], a[92:95]
    buffer_load_dwordx4 v[28:31], v2, s[8:11], s49 offen offset:0
    s_waitcnt vmcnt(20)
    v_mfma_f32_16x16x32_bf16 a[96:99], v[32:35], v[108:111], a[96:99]
    v_mfma_f32_16x16x32_bf16 a[100:103], v[32:35], v[112:115], a[100:103]
    v_mfma_f32_16x16x32_bf16 a[104:107], v[32:35], v[116:119], a[104:107]
    v_mfma_f32_16x16x32_bf16 a[108:111], v[32:35], v[120:123], a[108:111]
    buffer_load_dwordx4 v[32:35], v2, s[8:11], s50 offen offset:0
    v_mfma_f32_16x16x32_bf16 a[112:115], v[124:127], v[108:111], a[112:115]
    v_mfma_f32_16x16x32_bf16 a[116:119], v[124:127], v[112:115], a[116:119]
    v_mfma_f32_16x16x32_bf16 a[120:123], v[124:127], v[116:119], a[120:123]
    v_mfma_f32_16x16x32_bf16 a[124:127], v[124:127], v[120:123], a[124:127]
    ds_read_b128 v[124:127], v5 offset:640
    s_waitcnt vmcnt(20) lgkmcnt(4)
    v_mfma_f32_16x16x32_bf16 a[0:3], v[36:39], v[92:95], a[0:3]
    s_waitcnt lgkmcnt(3)
    v_mfma_f32_16x16x32_bf16 a[4:7], v[36:39], v[96:99], a[4:7]
    s_waitcnt lgkmcnt(2)
    v_mfma_f32_16x16x32_bf16 a[8:11], v[36:39], v[100:103], a[8:11]
    s_waitcnt lgkmcnt(1)
    v_mfma_f32_16x16x32_bf16 a[12:15], v[36:39], v[104:107], a[12:15]
    buffer_load_dwordx4 v[36:39], v2, s[8:11], s44 offen offset:1024
    s_waitcnt vmcnt(20)
    v_mfma_f32_16x16x32_bf16 a[16:19], v[40:43], v[92:95], a[16:19]
    v_mfma_f32_16x16x32_bf16 a[20:23], v[40:43], v[96:99], a[20:23]
    v_mfma_f32_16x16x32_bf16 a[24:27], v[40:43], v[100:103], a[24:27]
    v_mfma_f32_16x16x32_bf16 a[28:31], v[40:43], v[104:107], a[28:31]
    buffer_load_dwordx4 v[40:43], v2, s[8:11], s45 offen offset:1024
    s_waitcnt vmcnt(20)
    v_mfma_f32_16x16x32_bf16 a[32:35], v[44:47], v[92:95], a[32:35]
    v_mfma_f32_16x16x32_bf16 a[36:39], v[44:47], v[96:99], a[36:39]
    v_mfma_f32_16x16x32_bf16 a[40:43], v[44:47], v[100:103], a[40:43]
    v_mfma_f32_16x16x32_bf16 a[44:47], v[44:47], v[104:107], a[44:47]
    buffer_load_dwordx4 v[44:47], v2, s[8:11], s46 offen offset:1024
    ds_read_b128 v[108:111], v4 offset:8192
    ds_read_b128 v[112:115], v4 offset:10240
    ds_read_b128 v[116:119], v4 offset:12288
    ds_read_b128 v[120:123], v4 offset:14336
    s_waitcnt vmcnt(20)
    v_mfma_f32_16x16x32_bf16 a[48:51], v[48:51], v[92:95], a[48:51]
    v_mfma_f32_16x16x32_bf16 a[52:55], v[48:51], v[96:99], a[52:55]
    v_mfma_f32_16x16x32_bf16 a[56:59], v[48:51], v[100:103], a[56:59]
    v_mfma_f32_16x16x32_bf16 a[60:63], v[48:51], v[104:107], a[60:63]
    buffer_load_dwordx4 v[48:51], v2, s[8:11], s47 offen offset:1024
    s_waitcnt vmcnt(20)
    v_mfma_f32_16x16x32_bf16 a[64:67], v[52:55], v[92:95], a[64:67]
    v_mfma_f32_16x16x32_bf16 a[68:71], v[52:55], v[96:99], a[68:71]
    v_mfma_f32_16x16x32_bf16 a[72:75], v[52:55], v[100:103], a[72:75]
    v_mfma_f32_16x16x32_bf16 a[76:79], v[52:55], v[104:107], a[76:79]
    buffer_load_dwordx4 v[52:55], v2, s[8:11], s48 offen offset:1024
    s_waitcnt vmcnt(20)
    v_mfma_f32_16x16x32_bf16 a[80:83], v[56:59], v[92:95], a[80:83]
    v_mfma_f32_16x16x32_bf16 a[84:87], v[56:59], v[96:99], a[84:87]
    v_mfma_f32_16x16x32_bf16 a[88:91], v[56:59], v[100:103], a[88:91]
    v_mfma_f32_16x16x32_bf16 a[92:95], v[56:59], v[104:107], a[92:95]
    buffer_load_dwordx4 v[56:59], v2, s[8:11], s49 offen offset:1024
    s_waitcnt vmcnt(20)
    v_mfma_f32_16x16x32_bf16 a[96:99], v[60:63], v[92:95], a[96:99]
    v_mfma_f32_16x16x32_bf16 a[100:103], v[60:63], v[96:99], a[100:103]
    v_mfma_f32_16x16x32_bf16 a[104:107], v[60:63], v[100:103], a[104:107]
    v_mfma_f32_16x16x32_bf16 a[108:111], v[60:63], v[104:107], a[108:111]
    buffer_load_dwordx4 v[60:63], v2, s[8:11], s50 offen offset:1024
    s_waitcnt lgkmcnt(4)
    v_mfma_f32_16x16x32_bf16 a[112:115], v[124:127], v[92:95], a[112:115]
    v_mfma_f32_16x16x32_bf16 a[116:119], v[124:127], v[96:99], a[116:119]
    v_mfma_f32_16x16x32_bf16 a[120:123], v[124:127], v[100:103], a[120:123]
    v_mfma_f32_16x16x32_bf16 a[124:127], v[124:127], v[104:107], a[124:127]
    ds_read_b128 v[124:127], v5 offset:704
    s_waitcnt vmcnt(20) lgkmcnt(4)
    v_mfma_f32_16x16x32_bf16 a[0:3], v[64:67], v[108:111], a[0:3]
    s_waitcnt lgkmcnt(3)
    v_mfma_f32_16x16x32_bf16 a[4:7], v[64:67], v[112:115], a[4:7]
    s_waitcnt lgkmcnt(2)
    v_mfma_f32_16x16x32_bf16 a[8:11], v[64:67], v[116:119], a[8:11]
    s_waitcnt lgkmcnt(1)
    v_mfma_f32_16x16x32_bf16 a[12:15], v[64:67], v[120:123], a[12:15]
    buffer_load_dwordx4 v[64:67], v2, s[8:11], s44 offen offset:2048
    v_mov_b32 v7, 6
    ds_write_b32 v6, v7 offset:4
    ds_read_b32 v7, v6
    s_waitcnt vmcnt(20)
    v_mfma_f32_16x16x32_bf16 a[16:19], v[68:71], v[108:111], a[16:19]
    v_mfma_f32_16x16x32_bf16 a[20:23], v[68:71], v[112:115], a[20:23]
    v_mfma_f32_16x16x32_bf16 a[24:27], v[68:71], v[116:119], a[24:27]
    v_mfma_f32_16x16x32_bf16 a[28:31], v[68:71], v[120:123], a[28:31]
    buffer_load_dwordx4 v[68:71], v2, s[8:11], s45 offen offset:2048
    s_waitcnt vmcnt(20)
    v_mfma_f32_16x16x32_bf16 a[32:35], v[72:75], v[108:111], a[32:35]
    v_mfma_f32_16x16x32_bf16 a[36:39], v[72:75], v[112:115], a[36:39]
    v_mfma_f32_16x16x32_bf16 a[40:43], v[72:75], v[116:119], a[40:43]
    v_mfma_f32_16x16x32_bf16 a[44:47], v[72:75], v[120:123], a[44:47]
    buffer_load_dwordx4 v[72:75], v2, s[8:11], s46 offen offset:2048
    s_waitcnt lgkmcnt(0)
    v_readfirstlane_b32 s70, v7
    s_nop 0
    s_cmp_ge_u32 s70, 7
    s_cbranch_scc1 k3_gemm2_kernel_wrok14
k3_gemm2_kernel_wr13:
    s_sleep 1
    ds_read_b32 v7, v6
    s_waitcnt lgkmcnt(0)
    v_readfirstlane_b32 s70, v7
    s_nop 0
    s_cmp_lt_u32 s70, 7
    s_cbranch_scc1 k3_gemm2_kernel_wr13
k3_gemm2_kernel_wrok14:
    ds_read_b128 v[92:95], v3 offset:16384
    ds_read_b128 v[96:99], v3 offset:18432
    ds_read_b128 v[100:103], v3 offset:20480
    ds_read_b128 v[104:107], v3 offset:22528
    s_waitcnt vmcnt(20)
    v_mfma_f32_16x16x32_bf16 a[48:51], v[76:79], v[108:111], a[48:51]
    v_mfma_f32_16x16x32_bf16 a[52:55], v[76:79], v[112:115], a[52:55]
    v_mfma_f32_16x16x32_bf16 a[56:59], v[76:79], v[116:119], a[56:59]
    v_mfma_f32_16x16x32_bf16 a[60:63], v[76:79], v[120:123], a[60:63]
    buffer_load_dwordx4 v[76:79], v2, s[8:11], s47 offen offset:2048
    s_waitcnt vmcnt(20)
    v_mfma_f32_16x16x32_bf16 a[64:67], v[80:83], v[108:111], a[64:67]
    v_mfma_f32_16x16x32_bf16 a[68:71], v[80:83], v[112:115], a[68:71]
    v_mfma_f32_16x16x32_bf16 a[72:75], v[80:83], v[116:119], a[72:75]
    v_mfma_f32_16x16x32_bf16 a[76:79], v[80:83], v[120:123], a[76:79]
    buffer_load_dwordx4 v[80:83], v2, s[8:11], s48 offen offset:2048
    s_waitcnt vmcnt(20)
    v_mfma_f32_16x16x32_bf16 a[80:83], v[84:87], v[108:111], a[80:83]
    v_mfma_f32_16x16x32_bf16 a[84:87], v[84:87], v[112:115], a[84:87]
    v_mfma_f32_16x16x32_bf16 a[88:91], v[84:87], v[116:119], a[88:91]
    v_mfma_f32_16x16x32_bf16 a[92:95], v[84:87], v[120:123], a[92:95]
    buffer_load_dwordx4 v[84:87], v2, s[8:11], s49 offen offset:2048
    s_waitcnt vmcnt(20)
    v_mfma_f32_16x16x32_bf16 a[96:99], v[88:91], v[108:111], a[96:99]
    v_mfma_f32_16x16x32_bf16 a[100:103], v[88:91], v[112:115], a[100:103]
    v_mfma_f32_16x16x32_bf16 a[104:107], v[88:91], v[116:119], a[104:107]
    v_mfma_f32_16x16x32_bf16 a[108:111], v[88:91], v[120:123], a[108:111]
    buffer_load_dwordx4 v[88:91], v2, s[8:11], s50 offen offset:2048
    v_mfma_f32_16x16x32_bf16 a[112:115], v[124:127], v[108:111], a[112:115]
    v_mfma_f32_16x16x32_bf16 a[116:119], v[124:127], v[112:115], a[116:119]
    v_mfma_f32_16x16x32_bf16 a[120:123], v[124:127], v[116:119], a[120:123]
    v_mfma_f32_16x16x32_bf16 a[124:127], v[124:127], v[120:123], a[124:127]
    ds_read_b128 v[124:127], v5 offset:768
    s_waitcnt vmcnt(20) lgkmcnt(4)
    v_mfma_f32_16x16x32_bf16 a[0:3], v[8:11], v[92:95], a[0:3]
    s_waitcnt lgkmcnt(3)
    v_mfma_f32_16x16x32_bf16 a[4:7], v[8:11], v[96:99], a[4:7]
    s_waitcnt lgkmcnt(2)
    v_mfma_f32_16x16x32_bf16 a[8:11], v[8:11], v[100:103], a[8:11]
    s_waitcnt lgkmcnt(1)
    v_mfma_f32_16x16x32_bf16 a[12:15], v[8:11], v[104:107], a[12:15]
    buffer_load_dwordx4 v[8:11], v2, s[8:11], s44 offen offset:3072
    s_waitcnt vmcnt(20)
    v_mfma_f32_16x16x32_bf16 a[16:19], v[12:15], v[92:95], a[16:19]
    v_mfma_f32_16x16x32_bf16 a[20:23], v[12:15], v[96:99], a[20:23]
    v_mfma_f32_16x16x32_bf16 a[24:27], v[12:15], v[100:103], a[24:27]
    v_mfma_f32_16x16x32_bf16 a[28:31], v[12:15], v[104:107], a[28:31]
    buffer_load_dwordx4 v[12:15], v2, s[8:11], s45 offen offset:3072
    s_waitcnt vmcnt(20)
    v_mfma_f32_16x16x32_bf16 a[32:35], v[16:19], v[92:95], a[32:35]
    v_mfma_f32_16x16x32_bf16 a[36:39], v[16:19], v[96:99], a[36:39]
    v_mfma_f32_16x16x32_bf16 a[40:43], v[16:19], v[100:103], a[40:43]
    v_mfma_f32_16x16x32_bf16 a[44:47], v[16:19], v[104:107], a[44:47]
    buffer_load_dwordx4 v[16:19], v2, s[8:11], s46 offen offset:3072
    ds_read_b128 v[108:111], v4 offset:16384
    ds_read_b128 v[112:115], v4 offset:18432
    ds_read_b128 v[116:119], v4 offset:20480
    ds_read_b128 v[120:123], v4 offset:22528
    s_waitcnt vmcnt(20)
    v_mfma_f32_16x16x32_bf16 a[48:51], v[20:23], v[92:95], a[48:51]
    v_mfma_f32_16x16x32_bf16 a[52:55], v[20:23], v[96:99], a[52:55]
    v_mfma_f32_16x16x32_bf16 a[56:59], v[20:23], v[100:103], a[56:59]
    v_mfma_f32_16x16x32_bf16 a[60:63], v[20:23], v[104:107], a[60:63]
    buffer_load_dwordx4 v[20:23], v2, s[8:11], s47 offen offset:3072
    s_waitcnt vmcnt(20)
    v_mfma_f32_16x16x32_bf16 a[64:67], v[24:27], v[92:95], a[64:67]
    v_mfma_f32_16x16x32_bf16 a[68:71], v[24:27], v[96:99], a[68:71]
    v_mfma_f32_16x16x32_bf16 a[72:75], v[24:27], v[100:103], a[72:75]
    v_mfma_f32_16x16x32_bf16 a[76:79], v[24:27], v[104:107], a[76:79]
    buffer_load_dwordx4 v[24:27], v2, s[8:11], s48 offen offset:3072
    s_waitcnt vmcnt(20)
    v_mfma_f32_16x16x32_bf16 a[80:83], v[28:31], v[92:95], a[80:83]
    v_mfma_f32_16x16x32_bf16 a[84:87], v[28:31], v[96:99], a[84:87]
    v_mfma_f32_16x16x32_bf16 a[88:91], v[28:31], v[100:103], a[88:91]
    v_mfma_f32_16x16x32_bf16 a[92:95], v[28:31], v[104:107], a[92:95]
    buffer_load_dwordx4 v[28:31], v2, s[8:11], s49 offen offset:3072
    s_waitcnt vmcnt(20)
    v_mfma_f32_16x16x32_bf16 a[96:99], v[32:35], v[92:95], a[96:99]
    v_mfma_f32_16x16x32_bf16 a[100:103], v[32:35], v[96:99], a[100:103]
    v_mfma_f32_16x16x32_bf16 a[104:107], v[32:35], v[100:103], a[104:107]
    v_mfma_f32_16x16x32_bf16 a[108:111], v[32:35], v[104:107], a[108:111]
    buffer_load_dwordx4 v[32:35], v2, s[8:11], s50 offen offset:3072
    s_waitcnt lgkmcnt(4)
    v_mfma_f32_16x16x32_bf16 a[112:115], v[124:127], v[92:95], a[112:115]
    v_mfma_f32_16x16x32_bf16 a[116:119], v[124:127], v[96:99], a[116:119]
    v_mfma_f32_16x16x32_bf16 a[120:123], v[124:127], v[100:103], a[120:123]
    v_mfma_f32_16x16x32_bf16 a[124:127], v[124:127], v[104:107], a[124:127]
    ds_read_b128 v[124:127], v5 offset:832
    s_waitcnt vmcnt(20) lgkmcnt(4)
    v_mfma_f32_16x16x32_bf16 a[0:3], v[36:39], v[108:111], a[0:3]
    s_waitcnt lgkmcnt(3)
    v_mfma_f32_16x16x32_bf16 a[4:7], v[36:39], v[112:115], a[4:7]
    s_waitcnt lgkmcnt(2)
    v_mfma_f32_16x16x32_bf16 a[8:11], v[36:39], v[116:119], a[8:11]
    s_waitcnt lgkmcnt(1)
    v_mfma_f32_16x16x32_bf16 a[12:15], v[36:39], v[120:123], a[12:15]
    v_mov_b32 v7, 7
    ds_write_b32 v6, v7 offset:4
    ds_read_b32 v7, v6
    s_waitcnt vmcnt(19)
    v_mfma_f32_16x16x32_bf16 a[16:19], v[40:43], v[108:111], a[16:19]
    v_mfma_f32_16x16x32_bf16 a[20:23], v[40:43], v[112:115], a[20:23]
    v_mfma_f32_16x16x32_bf16 a[24:27], v[40:43], v[116:119], a[24:27]
    v_mfma_f32_16x16x32_bf16 a[28:31], v[40:43], v[120:123], a[28:31]
    s_waitcnt vmcnt(18)
    v_mfma_f32_16x16x32_bf16 a[32:35], v[44:47], v[108:111], a[32:35]
    v_mfma_f32_16x16x32_bf16 a[36:39], v[44:47], v[112:115], a[36:39]
    v_mfma_f32_16x16x32_bf16 a[40:43], v[44:47], v[116:119], a[40:43]
    v_mfma_f32_16x16x32_bf16 a[44:47], v[44:47], v[120:123], a[44:47]
    s_waitcnt lgkmcnt(0)
    v_readfirstlane_b32 s70, v7
    s_nop 0
    s_cmp_ge_u32 s70, 8
    s_cbranch_scc1 k3_gemm2_kernel_wrok16
k3_gemm2_kernel_wr15:
    s_sleep 1
    ds_read_b32 v7, v6
    s_waitcnt lgkmcnt(0)
    v_readfirstlane_b32 s70, v7
    s_nop 0
    s_cmp_lt_u32 s70, 8
    s_cbranch_scc1 k3_gemm2_kernel_wr15
k3_gemm2_kernel_wrok16:
    ds_read_b128 v[92:95], v3 offset:24576
    ds_read_b128 v[96:99], v3 offset:26624
    ds_read_b128 v[100:103], v3 offset:28672
    ds_read_b128 v[104:107], v3 offset:30720
    s_waitcnt vmcnt(17)
    v_mfma_f32_16x16x32_bf16 a[48:51], v[48:51], v[108:111], a[48:51]
    v_mfma_f32_16x16x32_bf16 a[52:55], v[48:51], v[112:115], a[52:55]
    v_mfma_f32_16x16x32_bf16 a[56:59], v[48:51], v[116:119], a[56:59]
    v_mfma_f32_16x16x32_bf16 a[60:63], v[48:51], v[120:123], a[60:63]
    s_waitcnt vmcnt(16)
    v_mfma_f32_16x16x32_bf16 a[64:67], v[52:55], v[108:111], a[64:67]
    v_mfma_f32_16x16x32_bf16 a[68:71], v[52:55], v[112:115], a[68:71]
    v_mfma_f32_16x16x32_bf16 a[72:75], v[52:55], v[116:119], a[72:75]
    v_mfma_f32_16x16x32_bf16 a[76:79], v[52:55], v[120:123], a[76:79]
    s_waitcnt vmcnt(15)
    v_mfma_f32_16x16x32_bf16 a[80:83], v[56:59], v[108:111], a[80:83]
    v_mfma_f32_16x16x32_bf16 a[84:87], v[56:59], v[112:115], a[84:87]
    v_mfma_f32_16x16x32_bf16 a[88:91], v[56:59], v[116:119], a[88:91]
    v_mfma_f32_16x16x32_bf16 a[92:95], v[56:59], v[120:123], a[92:95]
    s_waitcnt vmcnt(14)
    v_mfma_f32_16x16x32_bf16 a[96:99], v[60:63], v[108:111], a[96:99]
    v_mfma_f32_16x16x32_bf16 a[100:103], v[60:63], v[112:115], a[100:103]
    v_mfma_f32_16x16x32_bf16 a[104:107], v[60:63], v[116:119], a[104:107]
    v_mfma_f32_16x16x32_bf16 a[108:111], v[60:63], v[120:123], a[108:111]
    v_mfma_f32_16x16x32_bf16 a[112:115], v[124:127], v[108:111], a[112:115]
    v_mfma_f32_16x16x32_bf16 a[116:119], v[124:127], v[112:115], a[116:119]
    v_mfma_f32_16x16x32_bf16 a[120:123], v[124:127], v[116:119], a[120:123]
    v_mfma_f32_16x16x32_bf16 a[124:127], v[124:127], v[120:123], a[124:127]
    ds_read_b128 v[124:127], v5 offset:896
    buffer_load_dwordx4 v[36:39], v2, s[20:23], s64 offen
    buffer_load_dwordx4 v[40:43], v2, s[20:23], s65 offen
    v_and_b32 v45, 15, v1
    v_lshlrev_b32 v45, 1, v45
    s_lshl_b32 s38, s25, 7
    s_lshl_b32 s40, s26, 5
    s_add_u32 s68, s38, s40
    buffer_load_ushort v44, v45, s[32:35], s68 offen
    s_waitcnt vmcnt(16) lgkmcnt(4)
    v_mfma_f32_16x16x32_bf16 a[0:3], v[64:67], v[92:95], a[0:3]
    s_waitcnt lgkmcnt(3)
    v_mfma_f32_16x16x32_bf16 a[4:7], v[64:67], v[96:99], a[4:7]
    s_waitcnt lgkmcnt(2)
    v_mfma_f32_16x16x32_bf16 a[8:11], v[64:67], v[100:103], a[8:11]
    s_waitcnt lgkmcnt(1)
    v_mfma_f32_16x16x32_bf16 a[12:15], v[64:67], v[104:107], a[12:15]
    s_waitcnt vmcnt(15)
    v_mfma_f32_16x16x32_bf16 a[16:19], v[68:71], v[92:95], a[16:19]
    v_mfma_f32_16x16x32_bf16 a[20:23], v[68:71], v[96:99], a[20:23]
    v_mfma_f32_16x16x32_bf16 a[24:27], v[68:71], v[100:103], a[24:27]
    v_mfma_f32_16x16x32_bf16 a[28:31], v[68:71], v[104:107], a[28:31]
    s_waitcnt vmcnt(14)
    v_mfma_f32_16x16x32_bf16 a[32:35], v[72:75], v[92:95], a[32:35]
    v_mfma_f32_16x16x32_bf16 a[36:39], v[72:75], v[96:99], a[36:39]
    v_mfma_f32_16x16x32_bf16 a[40:43], v[72:75], v[100:103], a[40:43]
    v_mfma_f32_16x16x32_bf16 a[44:47], v[72:75], v[104:107], a[44:47]
    ds_read_b128 v[108:111], v4 offset:24576
    ds_read_b128 v[112:115], v4 offset:26624
    ds_read_b128 v[116:119], v4 offset:28672
    ds_read_b128 v[120:123], v4 offset:30720
    s_waitcnt vmcnt(13)
    v_mfma_f32_16x16x32_bf16 a[48:51], v[76:79], v[92:95], a[48:51]
    v_mfma_f32_16x16x32_bf16 a[52:55], v[76:79], v[96:99], a[52:55]
    v_mfma_f32_16x16x32_bf16 a[56:59], v[76:79], v[100:103], a[56:59]
    v_mfma_f32_16x16x32_bf16 a[60:63], v[76:79], v[104:107], a[60:63]
    s_waitcnt vmcnt(12)
    v_mfma_f32_16x16x32_bf16 a[64:67], v[80:83], v[92:95], a[64:67]
    v_mfma_f32_16x16x32_bf16 a[68:71], v[80:83], v[96:99], a[68:71]
    v_mfma_f32_16x16x32_bf16 a[72:75], v[80:83], v[100:103], a[72:75]
    v_mfma_f32_16x16x32_bf16 a[76:79], v[80:83], v[104:107], a[76:79]
    s_waitcnt vmcnt(11)
    v_mfma_f32_16x16x32_bf16 a[80:83], v[84:87], v[92:95], a[80:83]
    v_mfma_f32_16x16x32_bf16 a[84:87], v[84:87], v[96:99], a[84:87]
    v_mfma_f32_16x16x32_bf16 a[88:91], v[84:87], v[100:103], a[88:91]
    v_mfma_f32_16x16x32_bf16 a[92:95], v[84:87], v[104:107], a[92:95]
    s_waitcnt vmcnt(10)
    v_mfma_f32_16x16x32_bf16 a[96:99], v[88:91], v[92:95], a[96:99]
    v_mfma_f32_16x16x32_bf16 a[100:103], v[88:91], v[96:99], a[100:103]
    v_mfma_f32_16x16x32_bf16 a[104:107], v[88:91], v[100:103], a[104:107]
    v_mfma_f32_16x16x32_bf16 a[108:111], v[88:91], v[104:107], a[108:111]
    s_waitcnt lgkmcnt(4)
    v_mfma_f32_16x16x32_bf16 a[112:115], v[124:127], v[92:95], a[112:115]
    v_mfma_f32_16x16x32_bf16 a[116:119], v[124:127], v[96:99], a[116:119]
    v_mfma_f32_16x16x32_bf16 a[120:123], v[124:127], v[100:103], a[120:123]
    v_mfma_f32_16x16x32_bf16 a[124:127], v[124:127], v[104:107], a[124:127]
    ds_read_b128 v[124:127], v5 offset:960
    v_add_u32 v7, s27, v2
    s_waitcnt vmcnt(9) lgkmcnt(3)
    v_mfma_f32_16x16x32_bf16 a[4:7], v[8:11], v[112:115], a[4:7]
    s_waitcnt vmcnt(8)
    v_mfma_f32_16x16x32_bf16 a[20:23], v[12:15], v[112:115], a[20:23]
    s_waitcnt vmcnt(7)
    v_mfma_f32_16x16x32_bf16 a[36:39], v[16:19], v[112:115], a[36:39]
    s_waitcnt vmcnt(6)
    v_mfma_f32_16x16x32_bf16 a[52:55], v[20:23], v[112:115], a[52:55]
    s_waitcnt vmcnt(5)
    v_mfma_f32_16x16x32_bf16 a[68:71], v[24:27], v[112:115], a[68:71]
    s_waitcnt vmcnt(4)
    v_mfma_f32_16x16x32_bf16 a[84:87], v[28:31], v[112:115], a[84:87]
    s_waitcnt vmcnt(3)
    v_mfma_f32_16x16x32_bf16 a[100:103], v[32:35], v[112:115], a[100:103]
    s_waitcnt lgkmcnt(0)
    v_mfma_f32_16x16x32_bf16 a[116:119], v[124:127], v[112:115], a[116:119]
    v_mfma_f32_16x16x32_bf16 a[8:11], v[8:11], v[116:119], a[8:11]
    v_mfma_f32_16x16x32_bf16 a[24:27], v[12:15], v[116:119], a[24:27]
    ds_write_b128 v7, a[4:7] offset:9216
    v_mfma_f32_16x16x32_bf16 a[40:43], v[16:19], v[116:119], a[40:43]
    ds_write_b128 v7, a[20:23] offset:10240
    v_mfma_f32_16x16x32_bf16 a[56:59], v[20:23], v[116:119], a[56:59]
    ds_write_b128 v7, a[36:39] offset:11264
    v_mfma_f32_16x16x32_bf16 a[72:75], v[24:27], v[116:119], a[72:75]
    ds_write_b128 v7, a[52:55] offset:12288
    v_mfma_f32_16x16x32_bf16 a[88:91], v[28:31], v[116:119], a[88:91]
    ds_write_b128 v7, a[68:71] offset:13312
    v_mfma_f32_16x16x32_bf16 a[104:107], v[32:35], v[116:119], a[104:107]
    ds_write_b128 v7, a[84:87] offset:14336
    v_mfma_f32_16x16x32_bf16 a[120:123], v[124:127], v[116:119], a[120:123]
    ds_write_b128 v7, a[100:103] offset:15360
    ds_write_b128 v7, a[116:119] offset:16384
    v_mfma_f32_16x16x32_bf16 a[12:15], v[8:11], v[120:123], a[12:15]
    v_mfma_f32_16x16x32_bf16 a[28:31], v[12:15], v[120:123], a[28:31]
    ds_write_b128 v7, a[8:11] offset:17408
    v_mfma_f32_16x16x32_bf16 a[44:47], v[16:19], v[120:123], a[44:47]
    ds_write_b128 v7, a[24:27] offset:18432
    v_mfma_f32_16x16x32_bf16 a[60:63], v[20:23], v[120:123], a[60:63]
    ds_write_b128 v7, a[40:43] offset:19456
    v_mfma_f32_16x16x32_bf16 a[76:79], v[24:27], v[120:123], a[76:79]
    ds_write_b128 v7, a[56:59] offset:20480
    v_mfma_f32_16x16x32_bf16 a[92:95], v[28:31], v[120:123], a[92:95]
    ds_write_b128 v7, a[72:75] offset:21504
    v_mfma_f32_16x16x32_bf16 a[108:111], v[32:35], v[120:123], a[108:111]
    ds_write_b128 v7, a[88:91] offset:22528
    v_mfma_f32_16x16x32_bf16 a[124:127], v[124:127], v[120:123], a[124:127]
    ds_write_b128 v7, a[104:107] offset:23552
    ds_write_b128 v7, a[120:123] offset:24576
    v_mfma_f32_16x16x32_bf16 a[0:3], v[8:11], v[108:111], a[0:3]
    v_mfma_f32_16x16x32_bf16 a[16:19], v[12:15], v[108:111], a[16:19]
    ds_write_b128 v7, a[12:15] offset:25600
    v_mfma_f32_16x16x32_bf16 a[32:35], v[16:19], v[108:111], a[32:35]
    ds_write_b128 v7, a[28:31] offset:26624
    v_mfma_f32_16x16x32_bf16 a[48:51], v[20:23], v[108:111], a[48:51]
    ds_write_b128 v7, a[44:47] offset:27648
    v_mfma_f32_16x16x32_bf16 a[64:67], v[24:27], v[108:111], a[64:67]
    ds_write_b128 v7, a[60:63] offset:28672
    v_mfma_f32_16x16x32_bf16 a[80:83], v[28:31], v[108:111], a[80:83]
    ds_write_b128 v7, a[76:79] offset:29696
    v_mfma_f32_16x16x32_bf16 a[96:99], v[32:35], v[108:111], a[96:99]
    ds_write_b128 v7, a[92:95] offset:30720
    v_mfma_f32_16x16x32_bf16 a[112:115], v[124:127], v[108:111], a[112:115]
    ds_write_b128 v7, a[108:111] offset:31744
    ds_write_b128 v7, a[124:127] offset:32768
    ds_write_b128 v7, a[0:3] offset:1024
    ds_write_b128 v7, a[16:19] offset:2048
    ds_write_b128 v7, a[32:35] offset:3072
    ds_write_b128 v7, a[48:51] offset:4096
    ds_write_b128 v7, a[64:67] offset:5120
    ds_write_b128 v7, a[80:83] offset:6144
    ds_write_b128 v7, a[96:99] offset:7168
    ds_write_b128 v7, a[112:115] offset:8192
    s_waitcnt lgkmcnt(0)
    s_barrier
    s_lshl_b32 s39, s69, 10
    s_sub_u32 s38, s26, 0
    s_and_b32 s38, s38, 3
    s_mul_i32 s38, s38, 36096
    v_add_u32 v20, s38, v2
    s_add_u32 s38, s38, s39
    v_add_u32 v21, s38, v2
    ds_read_b32 v112, v20 offset:8192
    ds_read_b128 v[48:51], v21 offset:1024
    ds_read_b128 v[52:55], v21 offset:2048
    ds_read_b128 v[56:59], v21 offset:3072
    ds_read_b128 v[60:63], v21 offset:4096
    s_sub_u32 s38, s26, 1
    s_and_b32 s38, s38, 3
    s_mul_i32 s38, s38, 36096
    v_add_u32 v22, s38, v2
    s_add_u32 s38, s38, s39
    v_add_u32 v23, s38, v2
    ds_read_b32 v113, v22 offset:16384
    ds_read_b128 v[64:67], v23 offset:9216
    ds_read_b128 v[68:71], v23 offset:10240
    ds_read_b128 v[72:75], v23 offset:11264
    ds_read_b128 v[76:79], v23 offset:12288
    s_sub_u32 s38, s26, 2
    s_and_b32 s38, s38, 3
    s_mul_i32 s38, s38, 36096
    v_add_u32 v20, s38, v2
    s_add_u32 s38, s38, s39
    v_add_u32 v21, s38, v2
    ds_read_b32 v114, v20 offset:24576
    ds_read_b128 v[80:83], v21 offset:17408
    ds_read_b128 v[84:87], v21 offset:18432
    ds_read_b128 v[88:91], v21 offset:19456
    ds_read_b128 v[92:95], v21 offset:20480
    s_sub_u32 s38, s26, 3
    s_and_b32 s38, s38, 3
    s_mul_i32 s38, s38, 36096
    v_add_u32 v22, s38, v2
    s_add_u32 s38, s38, s39
    v_add_u32 v23, s38, v2
    ds_read_b32 v115, v22 offset:32768
    ds_read_b128 v[96:99], v23 offset:25600
    ds_read_b128 v[100:103], v23 offset:26624
    ds_read_b128 v[104:107], v23 offset:27648
    ds_read_b128 v[108:111], v23 offset:28672
    s_waitcnt lgkmcnt(14)
    v_add_f32 v112, v112, v113
    s_waitcnt lgkmcnt(4)
    v_add_f32 v114, v114, v115
    v_add_f32 v112, v112, v114
    s_waitcnt vmcnt(0)
    v_lshlrev_b32 v44, 16, v44
    v_sub_f32 v112, v44, v112
    v_pk_add_f32 v[48:49], v[48:49], v[64:65]
    s_waitcnt lgkmcnt(3)
    v_pk_add_f32 v[80:81], v[80:81], v[96:97]
    v_pk_add_f32 v[50:51], v[50:51], v[66:67]
    v_pk_add_f32 v[82:83], v[82:83], v[98:99]
    v_lshlrev_b32 v120, 16, v36
    v_and_b32 v121, s60, v36
    v_lshlrev_b32 v122, 16, v37
    v_and_b32 v123, s60, v37
    v_pk_add_f32 v[48:49], v[48:49], v[112:113] op_sel_hi:[1,0]
    v_pk_add_f32 v[50:51], v[50:51], v[112:113] op_sel_hi:[1,0]
    v_pk_add_f32 v[48:49], v[48:49], v[80:81]
    v_pk_add_f32 v[50:51], v[50:51], v[82:83]
    v_pk_mul_f32 v[120:121], v[120:121], v[48:49]
    v_pk_mul_f32 v[122:123], v[122:123], v[50:51]
    v_cvt_pk_bf16_f32 v24, v120, v121
    v_cvt_pk_bf16_f32 v25, v122, v123
    v_pk_add_f32 v[52:53], v[52:53], v[68:69]
    s_waitcnt lgkmcnt(2)
    v_pk_add_f32 v[84:85], v[84:85], v[100:101]
    v_pk_add_f32 v[54:55], v[54:55], v[70:71]
    v_pk_add_f32 v[86:87], v[86:87], v[102:103]
    v_lshlrev_b32 v120, 16, v38
    v_and_b32 v121, s60, v38
    v_lshlrev_b32 v122, 16, v39
    v_and_b32 v123, s60, v39
    v_pk_add_f32 v[52:53], v[52:53], v[112:113] op_sel_hi:[1,0]
    v_pk_add_f32 v[54:55], v[54:55], v[112:113] op_sel_hi:[1,0]
    v_pk_add_f32 v[52:53], v[52:53], v[84:85]
    v_pk_add_f32 v[54:55], v[54:55], v[86:87]
    v_pk_mul_f32 v[120:121], v[120:121], v[52:53]
    v_pk_mul_f32 v[122:123], v[122:123], v[54:55]
    v_cvt_pk_bf16_f32 v26, v120, v121
    v_cvt_pk_bf16_f32 v27, v122, v123
    s_cmp_lg_u32 s66, 0
    s_cbranch_scc1 k3_gemm2_kernel_sth17
    buffer_store_dwordx4 v[24:27], v2, s[28:31], s64 offen
    s_branch k3_gemm2_kernel_ste18
k3_gemm2_kernel_sth17:
    buffer_store_dwordx2 v[26:27], v2, s[28:31], s64 offen offset:8
k3_gemm2_kernel_ste18:
    v_pk_add_f32 v[56:57], v[56:57], v[72:73]
    s_waitcnt lgkmcnt(1)
    v_pk_add_f32 v[88:89], v[88:89], v[104:105]
    v_pk_add_f32 v[58:59], v[58:59], v[74:75]
    v_pk_add_f32 v[90:91], v[90:91], v[106:107]
    v_lshlrev_b32 v120, 16, v40
    v_and_b32 v121, s60, v40
    v_lshlrev_b32 v122, 16, v41
    v_and_b32 v123, s60, v41
    v_pk_add_f32 v[56:57], v[56:57], v[112:113] op_sel_hi:[1,0]
    v_pk_add_f32 v[58:59], v[58:59], v[112:113] op_sel_hi:[1,0]
    v_pk_add_f32 v[56:57], v[56:57], v[88:89]
    v_pk_add_f32 v[58:59], v[58:59], v[90:91]
    v_pk_mul_f32 v[120:121], v[120:121], v[56:57]
    v_pk_mul_f32 v[122:123], v[122:123], v[58:59]
    v_cvt_pk_bf16_f32 v28, v120, v121
    v_cvt_pk_bf16_f32 v29, v122, v123
    v_pk_add_f32 v[60:61], v[60:61], v[76:77]
    s_waitcnt lgkmcnt(0)
    v_pk_add_f32 v[92:93], v[92:93], v[108:109]
    v_pk_add_f32 v[62:63], v[62:63], v[78:79]
    v_pk_add_f32 v[94:95], v[94:95], v[110:111]
    v_lshlrev_b32 v120, 16, v42
    v_and_b32 v121, s60, v42
    v_lshlrev_b32 v122, 16, v43
    v_and_b32 v123, s60, v43
    v_pk_add_f32 v[60:61], v[60:61], v[112:113] op_sel_hi:[1,0]
    v_pk_add_f32 v[62:63], v[62:63], v[112:113] op_sel_hi:[1,0]
    v_pk_add_f32 v[60:61], v[60:61], v[92:93]
    v_pk_add_f32 v[62:63], v[62:63], v[94:95]
    v_pk_mul_f32 v[120:121], v[120:121], v[60:61]
    v_pk_mul_f32 v[122:123], v[122:123], v[62:63]
    v_cvt_pk_bf16_f32 v30, v120, v121
    v_cvt_pk_bf16_f32 v31, v122, v123
    buffer_store_dwordx4 v[28:31], v2, s[28:31], s65 offen
    s_endpgm
k3_scaler:
    s_nop 7
    s_nop 7
    s_setprio 2
    s_load_dwordx2 s[4:5], s[0:1], 144
    s_load_dwordx2 s[6:7], s[0:1], 88
    s_load_dwordx2 s[36:37], s[0:1], 96
    s_and_b32 s3, s2, 7
    s_lshr_b32 s38, s2, 3
    s_and_b32 s39, s3, 1
    s_lshl_b32 s39, s39, 2
    s_and_b32 s40, s38, 3
    s_add_u32 s39, s39, s40
    s_lshr_b32 s25, s3, 1
    s_lshl_b32 s25, s25, 3
    s_lshr_b32 s38, s38, 2
    s_add_u32 s25, s25, s38
    s_mul_i32 s24, s39, 7
    s_min_u32 s24, s24, 48
    s_and_b32 s26, s41, 3
    s_mul_i32 s27, s26, 36096
    s_mov_b32 s60, 0xffff0000
    v_and_b32 v1, 63, v0
    v_lshlrev_b32 v2, 4, v1
    s_add_u32 s38, s27, 35840
    v_mov_b32 v6, s38
    v_mov_b32 v8, 0
    v_mov_b32 v9, 0
    ds_write_b64 v6, v[8:9]
    s_lshl_b32 s38, s26, 11
    v_lshl_add_u32 v10, v1, 5, s38
    s_waitcnt lgkmcnt(0)
    s_barrier
    s_add_u32 s16, s4, 18599936
    s_addc_u32 s17, s5, 0
    s_and_b32 s17, s17, 0xffff
    s_mov_b32 s18, 16384
    s_mov_b32 s19, 0x20000
    buffer_load_dwordx4 v[96:99], v10, s[16:19], 0 offen
    buffer_load_dwordx4 v[100:103], v10, s[16:19], 0 offen offset:16
    s_mov_b32 s38, 8192
    buffer_load_dwordx4 v[104:107], v10, s[16:19], s38 offen
    buffer_load_dwordx4 v[108:111], v10, s[16:19], s38 offen offset:16
    s_mov_b32 s12, s6
    s_and_b32 s13, s7, 0xffff
    s_mov_b32 s14, 8388608
    s_mov_b32 s15, 0x20000
    v_lshrrev_b32 v3, 3, v1
    v_lshlrev_b32 v3, 12, v3
    v_and_b32 v11, 7, v1
    v_lshl_add_u32 v3, v11, 4, v3
    s_lshl_b32 s38, s25, 18
    s_lshl_b32 s40, s26, 10
    s_add_u32 s38, s38, s40
    s_add_u32 s40, s26, 0
    s_and_b32 s40, s40, 3
    s_lshl_b32 s40, s40, 16
    s_add_u32 s44, s38, s40
    s_add_u32 s45, s44, 32768
    s_add_u32 s40, s26, 1
    s_and_b32 s40, s40, 3
    s_lshl_b32 s40, s40, 16
    s_add_u32 s46, s38, s40
    s_add_u32 s47, s46, 32768
    s_add_u32 s40, s26, 2
    s_and_b32 s40, s40, 3
    s_lshl_b32 s40, s40, 16
    s_add_u32 s48, s38, s40
    s_add_u32 s49, s48, 32768
    s_add_u32 s40, s26, 3
    s_and_b32 s40, s40, 3
    s_lshl_b32 s40, s40, 16
    s_add_u32 s50, s38, s40
    s_add_u32 s51, s50, 32768
    buffer_load_dwordx4 v[32:35], v3, s[12:15], s44 offen offset:0
    buffer_load_dwordx4 v[36:39], v3, s[12:15], s45 offen offset:0
    buffer_load_dwordx4 v[40:43], v3, s[12:15], s46 offen offset:0
    buffer_load_dwordx4 v[44:47], v3, s[12:15], s47 offen offset:0
    buffer_load_dwordx4 v[48:51], v3, s[12:15], s48 offen offset:0
    buffer_load_dwordx4 v[52:55], v3, s[12:15], s49 offen offset:0
    buffer_load_dwordx4 v[56:59], v3, s[12:15], s50 offen offset:0
    buffer_load_dwordx4 v[60:63], v3, s[12:15], s51 offen offset:0
    v_bfe_u32 v12, v1, 2, 1
    v_and_b32 v13, 1, v1
    v_lshl_add_u32 v14, v12, 1, v13
    v_lshlrev_b32 v14, 1, v14
    v_lshrrev_b32 v15, 3, v1
    v_xor_b32 v15, v15, v14
    v_lshlrev_b32 v4, 4, v15
    v_lshl_add_u32 v4, v12, 10, v4
    v_lshl_add_u32 v4, v13, 8, v4
    v_bfe_u32 v12, v1, 1, 1
    v_lshl_add_u32 v4, v12, 3, v4
    v_add_u32 v4, s27, v4
    v_add_u32 v0, 128, v4
    s_add_u32 s38, s27, 32768
    v_lshl_add_u32 v5, v11, 5, s38
    v_lshl_add_u32 v16, v1, 5, s38
    v_lshrrev_b32 v17, 2, v1
    v_lshlrev_b32 v17, 6, v17
    v_lshl_add_u32 v17, v13, 5, v17
    v_lshl_add_u32 v17, v12, 3, v17
    s_add_u32 s38, s27, 34816
    v_add_u32 v17, s38, v17
    buffer_load_dwordx4 v[64:67], v3, s[12:15], s44 offen offset:128
    buffer_load_dwordx4 v[68:71], v3, s[12:15], s45 offen offset:128
    buffer_load_dwordx4 v[72:75], v3, s[12:15], s46 offen offset:128
    buffer_load_dwordx4 v[76:79], v3, s[12:15], s47 offen offset:128
    buffer_load_dwordx4 v[80:83], v3, s[12:15], s48 offen offset:128
    buffer_load_dwordx4 v[84:87], v3, s[12:15], s49 offen offset:128
    buffer_load_dwordx4 v[88:91], v3, s[12:15], s50 offen offset:128
    buffer_load_dwordx4 v[92:95], v3, s[12:15], s51 offen offset:128
    s_waitcnt vmcnt(19)
    v_mul_f32 v96, 0x3a97b426, v96
    s_waitcnt vmcnt(17)
    v_mul_f32 v104, 0x3a97b426, v104
    v_fma_f32 v104, -v96, v96, v104
    v_max_f32 v104, 0, v104
    v_mul_f32 v97, 0x3a97b426, v97
    v_mul_f32 v105, 0x3a97b426, v105
    v_fma_f32 v105, -v97, v97, v105
    v_max_f32 v105, 0, v105
    v_mul_f32 v98, 0x3a97b426, v98
    v_mul_f32 v106, 0x3a97b426, v106
    v_fma_f32 v106, -v98, v98, v106
    v_max_f32 v106, 0, v106
    v_mul_f32 v99, 0x3a97b426, v99
    v_mul_f32 v107, 0x3a97b426, v107
    v_fma_f32 v107, -v99, v99, v107
    v_max_f32 v107, 0, v107
    v_mul_f32 v100, 0x3a97b426, v100
    s_waitcnt vmcnt(16)
    v_mul_f32 v108, 0x3a97b426, v108
    v_fma_f32 v108, -v100, v100, v108
    v_max_f32 v108, 0, v108
    v_mul_f32 v101, 0x3a97b426, v101
    v_mul_f32 v109, 0x3a97b426, v109
    v_fma_f32 v109, -v101, v101, v109
    v_max_f32 v109, 0, v109
    v_mul_f32 v102, 0x3a97b426, v102
    v_mul_f32 v110, 0x3a97b426, v110
    v_fma_f32 v110, -v102, v102, v110
    v_max_f32 v110, 0, v110
    v_mul_f32 v103, 0x3a97b426, v103
    v_mul_f32 v111, 0x3a97b426, v111
    v_fma_f32 v111, -v103, v103, v111
    v_max_f32 v111, 0, v111
    v_cvt_pk_bf16_f32 v24, v104, v105
    v_cvt_pk_bf16_f32 v25, v106, v107
    v_cvt_pk_bf16_f32 v26, v108, v109
    v_cvt_pk_bf16_f32 v27, v110, v111
    v_lshlrev_b32 v104, 16, v24
    v_and_b32 v105, s60, v24
    v_lshlrev_b32 v106, 16, v25
    v_and_b32 v107, s60, v25
    v_lshlrev_b32 v108, 16, v26
    v_and_b32 v109, s60, v26
    v_lshlrev_b32 v110, 16, v27
    v_and_b32 v111, s60, v27
    v_add_f32 v104, 0x3727c5ac, v104
    v_add_f32 v105, 0x3727c5ac, v105
    v_add_f32 v106, 0x3727c5ac, v106
    v_add_f32 v107, 0x3727c5ac, v107
    v_add_f32 v108, 0x3727c5ac, v108
    v_add_f32 v109, 0x3727c5ac, v109
    v_add_f32 v110, 0x3727c5ac, v110
    v_add_f32 v111, 0x3727c5ac, v111
    v_cvt_pk_bf16_f32 v24, v104, v105
    v_cvt_pk_bf16_f32 v25, v106, v107
    v_cvt_pk_bf16_f32 v26, v108, v109
    v_cvt_pk_bf16_f32 v27, v110, v111
    v_lshlrev_b32 v104, 16, v24
    v_and_b32 v105, s60, v24
    v_lshlrev_b32 v106, 16, v25
    v_and_b32 v107, s60, v25
    v_lshlrev_b32 v108, 16, v26
    v_and_b32 v109, s60, v26
    v_lshlrev_b32 v110, 16, v27
    v_and_b32 v111, s60, v27
    v_sqrt_f32 v104, v104
    v_sqrt_f32 v105, v105
    v_sqrt_f32 v106, v106
    v_sqrt_f32 v107, v107
    v_sqrt_f32 v108, v108
    v_sqrt_f32 v109, v109
    v_sqrt_f32 v110, v110
    v_sqrt_f32 v111, v111
    v_cvt_pk_bf16_f32 v24, v104, v105
    v_cvt_pk_bf16_f32 v25, v106, v107
    v_cvt_pk_bf16_f32 v26, v108, v109
    v_cvt_pk_bf16_f32 v27, v110, v111
    v_lshlrev_b32 v104, 16, v24
    v_and_b32 v105, s60, v24
    v_lshlrev_b32 v106, 16, v25
    v_and_b32 v107, s60, v25
    v_lshlrev_b32 v108, 16, v26
    v_and_b32 v109, s60, v26
    v_lshlrev_b32 v110, 16, v27
    v_and_b32 v111, s60, v27
    v_rcp_f32 v104, v104
    v_rcp_f32 v105, v105
    v_rcp_f32 v106, v106
    v_rcp_f32 v107, v107
    v_rcp_f32 v108, v108
    v_rcp_f32 v109, v109
    v_rcp_f32 v110, v110
    v_rcp_f32 v111, v111
    v_cvt_pk_bf16_f32 v24, v96, v97
    v_cvt_pk_bf16_f32 v25, v98, v99
    v_cvt_pk_bf16_f32 v26, v100, v101
    v_cvt_pk_bf16_f32 v27, v102, v103
    ds_write_b128 v16, v[104:107]
    ds_write_b128 v16, v[108:111] offset:16
    ds_write_b64 v17, v[24:25]
    ds_write_b64 v17, v[26:27] offset:16
    ds_read_b128 v[8:11], v5 offset:0
    ds_read_b128 v[12:15], v5 offset:16
    ds_read_b128 v[16:19], v5 offset:256
    ds_read_b128 v[20:23], v5 offset:272
    s_waitcnt vmcnt(15)
    v_lshlrev_b32 v24, 16, v32
    v_and_b32 v25, s60, v32
    v_lshlrev_b32 v26, 16, v33
    v_and_b32 v27, s60, v33
    v_lshlrev_b32 v28, 16, v34
    v_and_b32 v29, s60, v34
    v_lshlrev_b32 v30, 16, v35
    v_and_b32 v31, s60, v35
    s_waitcnt lgkmcnt(3)
    v_mul_f32 v24, v24, v8
    v_mul_f32 v25, v25, v9
    v_mul_f32 v26, v26, v10
    v_mul_f32 v27, v27, v11
    s_waitcnt lgkmcnt(2)
    v_mul_f32 v28, v28, v12
    v_mul_f32 v29, v29, v13
    v_mul_f32 v30, v30, v14
    v_mul_f32 v31, v31, v15
    v_cvt_pk_bf16_f32 v32, v24, v25
    v_cvt_pk_bf16_f32 v33, v26, v27
    v_cvt_pk_bf16_f32 v34, v28, v29
    v_cvt_pk_bf16_f32 v35, v30, v31
    ds_write2st64_b64 v4, v[32:33], v[34:35] offset0:0 offset1:1
    s_waitcnt vmcnt(14)
    v_lshlrev_b32 v24, 16, v36
    v_and_b32 v25, s60, v36
    v_lshlrev_b32 v26, 16, v37
    v_and_b32 v27, s60, v37
    v_lshlrev_b32 v28, 16, v38
    v_and_b32 v29, s60, v38
    v_lshlrev_b32 v30, 16, v39
    v_and_b32 v31, s60, v39
    v_mul_f32 v24, v24, v8
    v_mul_f32 v25, v25, v9
    v_mul_f32 v26, v26, v10
    v_mul_f32 v27, v27, v11
    v_mul_f32 v28, v28, v12
    v_mul_f32 v29, v29, v13
    v_mul_f32 v30, v30, v14
    v_mul_f32 v31, v31, v15
    v_cvt_pk_bf16_f32 v36, v24, v25
    v_cvt_pk_bf16_f32 v37, v26, v27
    v_cvt_pk_bf16_f32 v38, v28, v29
    v_cvt_pk_bf16_f32 v39, v30, v31
    ds_write2st64_b64 v0, v[36:37], v[38:39] offset0:0 offset1:1
    s_waitcnt vmcnt(13)
    v_lshlrev_b32 v24, 16, v40
    v_and_b32 v25, s60, v40
    v_lshlrev_b32 v26, 16, v41
    v_and_b32 v27, s60, v41
    v_lshlrev_b32 v28, 16, v42
    v_and_b32 v29, s60, v42
    v_lshlrev_b32 v30, 16, v43
    v_and_b32 v31, s60, v43
    v_mul_f32 v24, v24, v8
    v_mul_f32 v25, v25, v9
    v_mul_f32 v26, v26, v10
    v_mul_f32 v27, v27, v11
    v_mul_f32 v28, v28, v12
    v_mul_f32 v29, v29, v13
    v_mul_f32 v30, v30, v14
    v_mul_f32 v31, v31, v15
    v_cvt_pk_bf16_f32 v40, v24, v25
    v_cvt_pk_bf16_f32 v41, v26, v27
    v_cvt_pk_bf16_f32 v42, v28, v29
    v_cvt_pk_bf16_f32 v43, v30, v31
    ds_write2st64_b64 v4, v[40:41], v[42:43] offset0:4 offset1:5
    s_waitcnt vmcnt(12)
    v_lshlrev_b32 v24, 16, v44
    v_and_b32 v25, s60, v44
    v_lshlrev_b32 v26, 16, v45
    v_and_b32 v27, s60, v45
    v_lshlrev_b32 v28, 16, v46
    v_and_b32 v29, s60, v46
    v_lshlrev_b32 v30, 16, v47
    v_and_b32 v31, s60, v47
    v_mul_f32 v24, v24, v8
    v_mul_f32 v25, v25, v9
    v_mul_f32 v26, v26, v10
    v_mul_f32 v27, v27, v11
    v_mul_f32 v28, v28, v12
    v_mul_f32 v29, v29, v13
    v_mul_f32 v30, v30, v14
    v_mul_f32 v31, v31, v15
    v_cvt_pk_bf16_f32 v44, v24, v25
    v_cvt_pk_bf16_f32 v45, v26, v27
    v_cvt_pk_bf16_f32 v46, v28, v29
    v_cvt_pk_bf16_f32 v47, v30, v31
    ds_write2st64_b64 v0, v[44:45], v[46:47] offset0:4 offset1:5
    s_waitcnt vmcnt(11)
    v_lshlrev_b32 v24, 16, v48
    v_and_b32 v25, s60, v48
    v_lshlrev_b32 v26, 16, v49
    v_and_b32 v27, s60, v49
    v_lshlrev_b32 v28, 16, v50
    v_and_b32 v29, s60, v50
    v_lshlrev_b32 v30, 16, v51
    v_and_b32 v31, s60, v51
    v_mul_f32 v24, v24, v8
    v_mul_f32 v25, v25, v9
    v_mul_f32 v26, v26, v10
    v_mul_f32 v27, v27, v11
    v_mul_f32 v28, v28, v12
    v_mul_f32 v29, v29, v13
    v_mul_f32 v30, v30, v14
    v_mul_f32 v31, v31, v15
    v_cvt_pk_bf16_f32 v48, v24, v25
    v_cvt_pk_bf16_f32 v49, v26, v27
    v_cvt_pk_bf16_f32 v50, v28, v29
    v_cvt_pk_bf16_f32 v51, v30, v31
    ds_write2st64_b64 v4, v[48:49], v[50:51] offset0:8 offset1:9
    s_waitcnt vmcnt(10)
    v_lshlrev_b32 v24, 16, v52
    v_and_b32 v25, s60, v52
    v_lshlrev_b32 v26, 16, v53
    v_and_b32 v27, s60, v53
    v_lshlrev_b32 v28, 16, v54
    v_and_b32 v29, s60, v54
    v_lshlrev_b32 v30, 16, v55
    v_and_b32 v31, s60, v55
    v_mul_f32 v24, v24, v8
    v_mul_f32 v25, v25, v9
    v_mul_f32 v26, v26, v10
    v_mul_f32 v27, v27, v11
    v_mul_f32 v28, v28, v12
    v_mul_f32 v29, v29, v13
    v_mul_f32 v30, v30, v14
    v_mul_f32 v31, v31, v15
    v_cvt_pk_bf16_f32 v52, v24, v25
    v_cvt_pk_bf16_f32 v53, v26, v27
    v_cvt_pk_bf16_f32 v54, v28, v29
    v_cvt_pk_bf16_f32 v55, v30, v31
    ds_write2st64_b64 v0, v[52:53], v[54:55] offset0:8 offset1:9
    s_waitcnt vmcnt(9)
    v_lshlrev_b32 v24, 16, v56
    v_and_b32 v25, s60, v56
    v_lshlrev_b32 v26, 16, v57
    v_and_b32 v27, s60, v57
    v_lshlrev_b32 v28, 16, v58
    v_and_b32 v29, s60, v58
    v_lshlrev_b32 v30, 16, v59
    v_and_b32 v31, s60, v59
    v_mul_f32 v24, v24, v8
    v_mul_f32 v25, v25, v9
    v_mul_f32 v26, v26, v10
    v_mul_f32 v27, v27, v11
    v_mul_f32 v28, v28, v12
    v_mul_f32 v29, v29, v13
    v_mul_f32 v30, v30, v14
    v_mul_f32 v31, v31, v15
    v_cvt_pk_bf16_f32 v56, v24, v25
    v_cvt_pk_bf16_f32 v57, v26, v27
    v_cvt_pk_bf16_f32 v58, v28, v29
    v_cvt_pk_bf16_f32 v59, v30, v31
    ds_write2st64_b64 v4, v[56:57], v[58:59] offset0:12 offset1:13
    s_waitcnt vmcnt(8)
    v_lshlrev_b32 v24, 16, v60
    v_and_b32 v25, s60, v60
    v_lshlrev_b32 v26, 16, v61
    v_and_b32 v27, s60, v61
    v_lshlrev_b32 v28, 16, v62
    v_and_b32 v29, s60, v62
    v_lshlrev_b32 v30, 16, v63
    v_and_b32 v31, s60, v63
    v_mul_f32 v24, v24, v8
    v_mul_f32 v25, v25, v9
    v_mul_f32 v26, v26, v10
    v_mul_f32 v27, v27, v11
    v_mul_f32 v28, v28, v12
    v_mul_f32 v29, v29, v13
    v_mul_f32 v30, v30, v14
    v_mul_f32 v31, v31, v15
    v_cvt_pk_bf16_f32 v60, v24, v25
    v_cvt_pk_bf16_f32 v61, v26, v27
    v_cvt_pk_bf16_f32 v62, v28, v29
    v_cvt_pk_bf16_f32 v63, v30, v31
    ds_write2st64_b64 v0, v[60:61], v[62:63] offset0:12 offset1:13
    v_mov_b32 v7, 1
    ds_write_b32 v6, v7
    buffer_load_dwordx4 v[96:99], v3, s[12:15], s44 offen offset:256
    buffer_load_dwordx4 v[100:103], v3, s[12:15], s45 offen offset:256
    buffer_load_dwordx4 v[104:107], v3, s[12:15], s46 offen offset:256
    buffer_load_dwordx4 v[108:111], v3, s[12:15], s47 offen offset:256
    buffer_load_dwordx4 v[112:115], v3, s[12:15], s48 offen offset:256
    buffer_load_dwordx4 v[116:119], v3, s[12:15], s49 offen offset:256
    buffer_load_dwordx4 v[120:123], v3, s[12:15], s50 offen offset:256
    buffer_load_dwordx4 v[124:127], v3, s[12:15], s51 offen offset:256
    buffer_load_dwordx4 v[32:35], v3, s[12:15], s44 offen offset:384
    buffer_load_dwordx4 v[36:39], v3, s[12:15], s45 offen offset:384
    buffer_load_dwordx4 v[40:43], v3, s[12:15], s46 offen offset:384
    buffer_load_dwordx4 v[44:47], v3, s[12:15], s47 offen offset:384
    buffer_load_dwordx4 v[48:51], v3, s[12:15], s48 offen offset:384
    buffer_load_dwordx4 v[52:55], v3, s[12:15], s49 offen offset:384
    buffer_load_dwordx4 v[56:59], v3, s[12:15], s50 offen offset:384
    buffer_load_dwordx4 v[60:63], v3, s[12:15], s51 offen offset:384
    ds_read_b128 v[8:11], v5 offset:512
    ds_read_b128 v[12:15], v5 offset:528
    s_waitcnt vmcnt(23)
    v_lshlrev_b32 v24, 16, v64
    v_and_b32 v25, s60, v64
    v_lshlrev_b32 v26, 16, v65
    v_and_b32 v27, s60, v65
    v_lshlrev_b32 v28, 16, v66
    v_and_b32 v29, s60, v66
    v_lshlrev_b32 v30, 16, v67
    v_and_b32 v31, s60, v67
    s_waitcnt lgkmcnt(12)
    v_mul_f32 v24, v24, v16
    v_mul_f32 v25, v25, v17
    v_mul_f32 v26, v26, v18
    v_mul_f32 v27, v27, v19
    s_waitcnt lgkmcnt(11)
    v_mul_f32 v28, v28, v20
    v_mul_f32 v29, v29, v21
    v_mul_f32 v30, v30, v22
    v_mul_f32 v31, v31, v23
    v_cvt_pk_bf16_f32 v64, v24, v25
    v_cvt_pk_bf16_f32 v65, v26, v27
    v_cvt_pk_bf16_f32 v66, v28, v29
    v_cvt_pk_bf16_f32 v67, v30, v31
    ds_write2st64_b64 v4, v[64:65], v[66:67] offset0:16 offset1:17
    buffer_load_dwordx4 v[64:67], v3, s[12:15], s44 offen offset:512
    s_waitcnt vmcnt(23)
    v_lshlrev_b32 v24, 16, v68
    v_and_b32 v25, s60, v68
    v_lshlrev_b32 v26, 16, v69
    v_and_b32 v27, s60, v69
    v_lshlrev_b32 v28, 16, v70
    v_and_b32 v29, s60, v70
    v_lshlrev_b32 v30, 16, v71
    v_and_b32 v31, s60, v71
    v_mul_f32 v24, v24, v16
    v_mul_f32 v25, v25, v17
    v_mul_f32 v26, v26, v18
    v_mul_f32 v27, v27, v19
    v_mul_f32 v28, v28, v20
    v_mul_f32 v29, v29, v21
    v_mul_f32 v30, v30, v22
    v_mul_f32 v31, v31, v23
    v_cvt_pk_bf16_f32 v68, v24, v25
    v_cvt_pk_bf16_f32 v69, v26, v27
    v_cvt_pk_bf16_f32 v70, v28, v29
    v_cvt_pk_bf16_f32 v71, v30, v31
    ds_write2st64_b64 v0, v[68:69], v[70:71] offset0:16 offset1:17
    buffer_load_dwordx4 v[68:71], v3, s[12:15], s45 offen offset:512
    s_waitcnt vmcnt(23)
    v_lshlrev_b32 v24, 16, v72
    v_and_b32 v25, s60, v72
    v_lshlrev_b32 v26, 16, v73
    v_and_b32 v27, s60, v73
    v_lshlrev_b32 v28, 16, v74
    v_and_b32 v29, s60, v74
    v_lshlrev_b32 v30, 16, v75
    v_and_b32 v31, s60, v75
    v_mul_f32 v24, v24, v16
    v_mul_f32 v25, v25, v17
    v_mul_f32 v26, v26, v18
    v_mul_f32 v27, v27, v19
    v_mul_f32 v28, v28, v20
    v_mul_f32 v29, v29, v21
    v_mul_f32 v30, v30, v22
    v_mul_f32 v31, v31, v23
    v_cvt_pk_bf16_f32 v72, v24, v25
    v_cvt_pk_bf16_f32 v73, v26, v27
    v_cvt_pk_bf16_f32 v74, v28, v29
    v_cvt_pk_bf16_f32 v75, v30, v31
    ds_write2st64_b64 v4, v[72:73], v[74:75] offset0:20 offset1:21
    buffer_load_dwordx4 v[72:75], v3, s[12:15], s46 offen offset:512
    s_waitcnt vmcnt(23)
    v_lshlrev_b32 v24, 16, v76
    v_and_b32 v25, s60, v76
    v_lshlrev_b32 v26, 16, v77
    v_and_b32 v27, s60, v77
    v_lshlrev_b32 v28, 16, v78
    v_and_b32 v29, s60, v78
    v_lshlrev_b32 v30, 16, v79
    v_and_b32 v31, s60, v79
    v_mul_f32 v24, v24, v16
    v_mul_f32 v25, v25, v17
    v_mul_f32 v26, v26, v18
    v_mul_f32 v27, v27, v19
    v_mul_f32 v28, v28, v20
    v_mul_f32 v29, v29, v21
    v_mul_f32 v30, v30, v22
    v_mul_f32 v31, v31, v23
    v_cvt_pk_bf16_f32 v76, v24, v25
    v_cvt_pk_bf16_f32 v77, v26, v27
    v_cvt_pk_bf16_f32 v78, v28, v29
    v_cvt_pk_bf16_f32 v79, v30, v31
    ds_write2st64_b64 v0, v[76:77], v[78:79] offset0:20 offset1:21
    buffer_load_dwordx4 v[76:79], v3, s[12:15], s47 offen offset:512
    s_waitcnt vmcnt(23)
    v_lshlrev_b32 v24, 16, v80
    v_and_b32 v25, s60, v80
    v_lshlrev_b32 v26, 16, v81
    v_and_b32 v27, s60, v81
    v_lshlrev_b32 v28, 16, v82
    v_and_b32 v29, s60, v82
    v_lshlrev_b32 v30, 16, v83
    v_and_b32 v31, s60, v83
    v_mul_f32 v24, v24, v16
    v_mul_f32 v25, v25, v17
    v_mul_f32 v26, v26, v18
    v_mul_f32 v27, v27, v19
    v_mul_f32 v28, v28, v20
    v_mul_f32 v29, v29, v21
    v_mul_f32 v30, v30, v22
    v_mul_f32 v31, v31, v23
    v_cvt_pk_bf16_f32 v80, v24, v25
    v_cvt_pk_bf16_f32 v81, v26, v27
    v_cvt_pk_bf16_f32 v82, v28, v29
    v_cvt_pk_bf16_f32 v83, v30, v31
    ds_write2st64_b64 v4, v[80:81], v[82:83] offset0:24 offset1:25
    buffer_load_dwordx4 v[80:83], v3, s[12:15], s48 offen offset:512
    s_waitcnt vmcnt(23)
    v_lshlrev_b32 v24, 16, v84
    v_and_b32 v25, s60, v84
    v_lshlrev_b32 v26, 16, v85
    v_and_b32 v27, s60, v85
    v_lshlrev_b32 v28, 16, v86
    v_and_b32 v29, s60, v86
    v_lshlrev_b32 v30, 16, v87
    v_and_b32 v31, s60, v87
    v_mul_f32 v24, v24, v16
    v_mul_f32 v25, v25, v17
    v_mul_f32 v26, v26, v18
    v_mul_f32 v27, v27, v19
    v_mul_f32 v28, v28, v20
    v_mul_f32 v29, v29, v21
    v_mul_f32 v30, v30, v22
    v_mul_f32 v31, v31, v23
    v_cvt_pk_bf16_f32 v84, v24, v25
    v_cvt_pk_bf16_f32 v85, v26, v27
    v_cvt_pk_bf16_f32 v86, v28, v29
    v_cvt_pk_bf16_f32 v87, v30, v31
    ds_write2st64_b64 v0, v[84:85], v[86:87] offset0:24 offset1:25
    buffer_load_dwordx4 v[84:87], v3, s[12:15], s49 offen offset:512
    s_waitcnt vmcnt(23)
    v_lshlrev_b32 v24, 16, v88
    v_and_b32 v25, s60, v88
    v_lshlrev_b32 v26, 16, v89
    v_and_b32 v27, s60, v89
    v_lshlrev_b32 v28, 16, v90
    v_and_b32 v29, s60, v90
    v_lshlrev_b32 v30, 16, v91
    v_and_b32 v31, s60, v91
    v_mul_f32 v24, v24, v16
    v_mul_f32 v25, v25, v17
    v_mul_f32 v26, v26, v18
    v_mul_f32 v27, v27, v19
    v_mul_f32 v28, v28, v20
    v_mul_f32 v29, v29, v21
    v_mul_f32 v30, v30, v22
    v_mul_f32 v31, v31, v23
    v_cvt_pk_bf16_f32 v88, v24, v25
    v_cvt_pk_bf16_f32 v89, v26, v27
    v_cvt_pk_bf16_f32 v90, v28, v29
    v_cvt_pk_bf16_f32 v91, v30, v31
    ds_write2st64_b64 v4, v[88:89], v[90:91] offset0:28 offset1:29
    buffer_load_dwordx4 v[88:91], v3, s[12:15], s50 offen offset:512
    s_waitcnt vmcnt(23)
    v_lshlrev_b32 v24, 16, v92
    v_and_b32 v25, s60, v92
    v_lshlrev_b32 v26, 16, v93
    v_and_b32 v27, s60, v93
    v_lshlrev_b32 v28, 16, v94
    v_and_b32 v29, s60, v94
    v_lshlrev_b32 v30, 16, v95
    v_and_b32 v31, s60, v95
    v_mul_f32 v24, v24, v16
    v_mul_f32 v25, v25, v17
    v_mul_f32 v26, v26, v18
    v_mul_f32 v27, v27, v19
    v_mul_f32 v28, v28, v20
    v_mul_f32 v29, v29, v21
    v_mul_f32 v30, v30, v22
    v_mul_f32 v31, v31, v23
    v_cvt_pk_bf16_f32 v92, v24, v25
    v_cvt_pk_bf16_f32 v93, v26, v27
    v_cvt_pk_bf16_f32 v94, v28, v29
    v_cvt_pk_bf16_f32 v95, v30, v31
    ds_write2st64_b64 v0, v[92:93], v[94:95] offset0:28 offset1:29
    buffer_load_dwordx4 v[92:95], v3, s[12:15], s51 offen offset:512
    v_mov_b32 v7, 2
    ds_write_b32 v6, v7
    ds_read_b128 v[16:19], v5 offset:768
    ds_read_b128 v[20:23], v5 offset:784
    s_waitcnt vmcnt(23)
    v_lshlrev_b32 v24, 16, v96
    v_and_b32 v25, s60, v96
    v_lshlrev_b32 v26, 16, v97
    v_and_b32 v27, s60, v97
    v_lshlrev_b32 v28, 16, v98
    v_and_b32 v29, s60, v98
    v_lshlrev_b32 v30, 16, v99
    v_and_b32 v31, s60, v99
    s_waitcnt lgkmcnt(12)
    v_mul_f32 v24, v24, v8
    v_mul_f32 v25, v25, v9
    v_mul_f32 v26, v26, v10
    v_mul_f32 v27, v27, v11
    s_waitcnt lgkmcnt(11)
    v_mul_f32 v28, v28, v12
    v_mul_f32 v29, v29, v13
    v_mul_f32 v30, v30, v14
    v_mul_f32 v31, v31, v15
    v_cvt_pk_bf16_f32 v96, v24, v25
    v_cvt_pk_bf16_f32 v97, v26, v27
    v_cvt_pk_bf16_f32 v98, v28, v29
    v_cvt_pk_bf16_f32 v99, v30, v31
    ds_write2st64_b64 v4, v[96:97], v[98:99] offset0:32 offset1:33
    buffer_load_dwordx4 v[96:99], v3, s[12:15], s44 offen offset:640
    s_waitcnt vmcnt(23)
    v_lshlrev_b32 v24, 16, v100
    v_and_b32 v25, s60, v100
    v_lshlrev_b32 v26, 16, v101
    v_and_b32 v27, s60, v101
    v_lshlrev_b32 v28, 16, v102
    v_and_b32 v29, s60, v102
    v_lshlrev_b32 v30, 16, v103
    v_and_b32 v31, s60, v103
    v_mul_f32 v24, v24, v8
    v_mul_f32 v25, v25, v9
    v_mul_f32 v26, v26, v10
    v_mul_f32 v27, v27, v11
    v_mul_f32 v28, v28, v12
    v_mul_f32 v29, v29, v13
    v_mul_f32 v30, v30, v14
    v_mul_f32 v31, v31, v15
    v_cvt_pk_bf16_f32 v100, v24, v25
    v_cvt_pk_bf16_f32 v101, v26, v27
    v_cvt_pk_bf16_f32 v102, v28, v29
    v_cvt_pk_bf16_f32 v103, v30, v31
    ds_write2st64_b64 v0, v[100:101], v[102:103] offset0:32 offset1:33
    buffer_load_dwordx4 v[100:103], v3, s[12:15], s45 offen offset:640
    s_waitcnt vmcnt(23)
    v_lshlrev_b32 v24, 16, v104
    v_and_b32 v25, s60, v104
    v_lshlrev_b32 v26, 16, v105
    v_and_b32 v27, s60, v105
    v_lshlrev_b32 v28, 16, v106
    v_and_b32 v29, s60, v106
    v_lshlrev_b32 v30, 16, v107
    v_and_b32 v31, s60, v107
    v_mul_f32 v24, v24, v8
    v_mul_f32 v25, v25, v9
    v_mul_f32 v26, v26, v10
    v_mul_f32 v27, v27, v11
    v_mul_f32 v28, v28, v12
    v_mul_f32 v29, v29, v13
    v_mul_f32 v30, v30, v14
    v_mul_f32 v31, v31, v15
    v_cvt_pk_bf16_f32 v104, v24, v25
    v_cvt_pk_bf16_f32 v105, v26, v27
    v_cvt_pk_bf16_f32 v106, v28, v29
    v_cvt_pk_bf16_f32 v107, v30, v31
    ds_write2st64_b64 v4, v[104:105], v[106:107] offset0:36 offset1:37
    buffer_load_dwordx4 v[104:107], v3, s[12:15], s46 offen offset:640
    s_waitcnt vmcnt(23)
    v_lshlrev_b32 v24, 16, v108
    v_and_b32 v25, s60, v108
    v_lshlrev_b32 v26, 16, v109
    v_and_b32 v27, s60, v109
    v_lshlrev_b32 v28, 16, v110
    v_and_b32 v29, s60, v110
    v_lshlrev_b32 v30, 16, v111
    v_and_b32 v31, s60, v111
    v_mul_f32 v24, v24, v8
    v_mul_f32 v25, v25, v9
    v_mul_f32 v26, v26, v10
    v_mul_f32 v27, v27, v11
    v_mul_f32 v28, v28, v12
    v_mul_f32 v29, v29, v13
    v_mul_f32 v30, v30, v14
    v_mul_f32 v31, v31, v15
    v_cvt_pk_bf16_f32 v108, v24, v25
    v_cvt_pk_bf16_f32 v109, v26, v27
    v_cvt_pk_bf16_f32 v110, v28, v29
    v_cvt_pk_bf16_f32 v111, v30, v31
    ds_write2st64_b64 v0, v[108:109], v[110:111] offset0:36 offset1:37
    buffer_load_dwordx4 v[108:111], v3, s[12:15], s47 offen offset:640
    s_waitcnt vmcnt(23)
    v_lshlrev_b32 v24, 16, v112
    v_and_b32 v25, s60, v112
    v_lshlrev_b32 v26, 16, v113
    v_and_b32 v27, s60, v113
    v_lshlrev_b32 v28, 16, v114
    v_and_b32 v29, s60, v114
    v_lshlrev_b32 v30, 16, v115
    v_and_b32 v31, s60, v115
    v_mul_f32 v24, v24, v8
    v_mul_f32 v25, v25, v9
    v_mul_f32 v26, v26, v10
    v_mul_f32 v27, v27, v11
    v_mul_f32 v28, v28, v12
    v_mul_f32 v29, v29, v13
    v_mul_f32 v30, v30, v14
    v_mul_f32 v31, v31, v15
    v_cvt_pk_bf16_f32 v112, v24, v25
    v_cvt_pk_bf16_f32 v113, v26, v27
    v_cvt_pk_bf16_f32 v114, v28, v29
    v_cvt_pk_bf16_f32 v115, v30, v31
    ds_write2st64_b64 v4, v[112:113], v[114:115] offset0:40 offset1:41
    buffer_load_dwordx4 v[112:115], v3, s[12:15], s48 offen offset:640
    s_waitcnt vmcnt(23)
    v_lshlrev_b32 v24, 16, v116
    v_and_b32 v25, s60, v116
    v_lshlrev_b32 v26, 16, v117
    v_and_b32 v27, s60, v117
    v_lshlrev_b32 v28, 16, v118
    v_and_b32 v29, s60, v118
    v_lshlrev_b32 v30, 16, v119
    v_and_b32 v31, s60, v119
    v_mul_f32 v24, v24, v8
    v_mul_f32 v25, v25, v9
    v_mul_f32 v26, v26, v10
    v_mul_f32 v27, v27, v11
    v_mul_f32 v28, v28, v12
    v_mul_f32 v29, v29, v13
    v_mul_f32 v30, v30, v14
    v_mul_f32 v31, v31, v15
    v_cvt_pk_bf16_f32 v116, v24, v25
    v_cvt_pk_bf16_f32 v117, v26, v27
    v_cvt_pk_bf16_f32 v118, v28, v29
    v_cvt_pk_bf16_f32 v119, v30, v31
    ds_write2st64_b64 v0, v[116:117], v[118:119] offset0:40 offset1:41
    buffer_load_dwordx4 v[116:119], v3, s[12:15], s49 offen offset:640
    s_waitcnt vmcnt(23)
    v_lshlrev_b32 v24, 16, v120
    v_and_b32 v25, s60, v120
    v_lshlrev_b32 v26, 16, v121
    v_and_b32 v27, s60, v121
    v_lshlrev_b32 v28, 16, v122
    v_and_b32 v29, s60, v122
    v_lshlrev_b32 v30, 16, v123
    v_and_b32 v31, s60, v123
    v_mul_f32 v24, v24, v8
    v_mul_f32 v25, v25, v9
    v_mul_f32 v26, v26, v10
    v_mul_f32 v27, v27, v11
    v_mul_f32 v28, v28, v12
    v_mul_f32 v29, v29, v13
    v_mul_f32 v30, v30, v14
    v_mul_f32 v31, v31, v15
    v_cvt_pk_bf16_f32 v120, v24, v25
    v_cvt_pk_bf16_f32 v121, v26, v27
    v_cvt_pk_bf16_f32 v122, v28, v29
    v_cvt_pk_bf16_f32 v123, v30, v31
    ds_write2st64_b64 v4, v[120:121], v[122:123] offset0:44 offset1:45
    buffer_load_dwordx4 v[120:123], v3, s[12:15], s50 offen offset:640
    s_waitcnt vmcnt(23)
    v_lshlrev_b32 v24, 16, v124
    v_and_b32 v25, s60, v124
    v_lshlrev_b32 v26, 16, v125
    v_and_b32 v27, s60, v125
    v_lshlrev_b32 v28, 16, v126
    v_and_b32 v29, s60, v126
    v_lshlrev_b32 v30, 16, v127
    v_and_b32 v31, s60, v127
    v_mul_f32 v24, v24, v8
    v_mul_f32 v25, v25, v9
    v_mul_f32 v26, v26, v10
    v_mul_f32 v27, v27, v11
    v_mul_f32 v28, v28, v12
    v_mul_f32 v29, v29, v13
    v_mul_f32 v30, v30, v14
    v_mul_f32 v31, v31, v15
    v_cvt_pk_bf16_f32 v124, v24, v25
    v_cvt_pk_bf16_f32 v125, v26, v27
    v_cvt_pk_bf16_f32 v126, v28, v29
    v_cvt_pk_bf16_f32 v127, v30, v31
    ds_write2st64_b64 v0, v[124:125], v[126:127] offset0:44 offset1:45
    buffer_load_dwordx4 v[124:127], v3, s[12:15], s51 offen offset:640
    v_mov_b32 v7, 3
    ds_write_b32 v6, v7
    ds_read_b128 v[8:11], v5 offset:1024
    ds_read_b128 v[12:15], v5 offset:1040
    s_waitcnt vmcnt(23)
    v_lshlrev_b32 v24, 16, v32
    v_and_b32 v25, s60, v32
    v_lshlrev_b32 v26, 16, v33
    v_and_b32 v27, s60, v33
    v_lshlrev_b32 v28, 16, v34
    v_and_b32 v29, s60, v34
    v_lshlrev_b32 v30, 16, v35
    v_and_b32 v31, s60, v35
    s_waitcnt lgkmcnt(12)
    v_mul_f32 v24, v24, v16
    v_mul_f32 v25, v25, v17
    v_mul_f32 v26, v26, v18
    v_mul_f32 v27, v27, v19
    s_waitcnt lgkmcnt(11)
    v_mul_f32 v28, v28, v20
    v_mul_f32 v29, v29, v21
    v_mul_f32 v30, v30, v22
    v_mul_f32 v31, v31, v23
    v_cvt_pk_bf16_f32 v32, v24, v25
    v_cvt_pk_bf16_f32 v33, v26, v27
    v_cvt_pk_bf16_f32 v34, v28, v29
    v_cvt_pk_bf16_f32 v35, v30, v31
    ds_write2st64_b64 v4, v[32:33], v[34:35] offset0:48 offset1:49
    buffer_load_dwordx4 v[32:35], v3, s[12:15], s44 offen offset:768
    s_waitcnt vmcnt(23)
    v_lshlrev_b32 v24, 16, v36
    v_and_b32 v25, s60, v36
    v_lshlrev_b32 v26, 16, v37
    v_and_b32 v27, s60, v37
    v_lshlrev_b32 v28, 16, v38
    v_and_b32 v29, s60, v38
    v_lshlrev_b32 v30, 16, v39
    v_and_b32 v31, s60, v39
    v_mul_f32 v24, v24, v16
    v_mul_f32 v25, v25, v17
    v_mul_f32 v26, v26, v18
    v_mul_f32 v27, v27, v19
    v_mul_f32 v28, v28, v20
    v_mul_f32 v29, v29, v21
    v_mul_f32 v30, v30, v22
    v_mul_f32 v31, v31, v23
    v_cvt_pk_bf16_f32 v36, v24, v25
    v_cvt_pk_bf16_f32 v37, v26, v27
    v_cvt_pk_bf16_f32 v38, v28, v29
    v_cvt_pk_bf16_f32 v39, v30, v31
    ds_write2st64_b64 v0, v[36:37], v[38:39] offset0:48 offset1:49
    buffer_load_dwordx4 v[36:39], v3, s[12:15], s45 offen offset:768
    s_waitcnt vmcnt(23)
    v_lshlrev_b32 v24, 16, v40
    v_and_b32 v25, s60, v40
    v_lshlrev_b32 v26, 16, v41
    v_and_b32 v27, s60, v41
    v_lshlrev_b32 v28, 16, v42
    v_and_b32 v29, s60, v42
    v_lshlrev_b32 v30, 16, v43
    v_and_b32 v31, s60, v43
    v_mul_f32 v24, v24, v16
    v_mul_f32 v25, v25, v17
    v_mul_f32 v26, v26, v18
    v_mul_f32 v27, v27, v19
    v_mul_f32 v28, v28, v20
    v_mul_f32 v29, v29, v21
    v_mul_f32 v30, v30, v22
    v_mul_f32 v31, v31, v23
    v_cvt_pk_bf16_f32 v40, v24, v25
    v_cvt_pk_bf16_f32 v41, v26, v27
    v_cvt_pk_bf16_f32 v42, v28, v29
    v_cvt_pk_bf16_f32 v43, v30, v31
    ds_write2st64_b64 v4, v[40:41], v[42:43] offset0:52 offset1:53
    buffer_load_dwordx4 v[40:43], v3, s[12:15], s46 offen offset:768
    s_waitcnt vmcnt(23)
    v_lshlrev_b32 v24, 16, v44
    v_and_b32 v25, s60, v44
    v_lshlrev_b32 v26, 16, v45
    v_and_b32 v27, s60, v45
    v_lshlrev_b32 v28, 16, v46
    v_and_b32 v29, s60, v46
    v_lshlrev_b32 v30, 16, v47
    v_and_b32 v31, s60, v47
    v_mul_f32 v24, v24, v16
    v_mul_f32 v25, v25, v17
    v_mul_f32 v26, v26, v18
    v_mul_f32 v27, v27, v19
    v_mul_f32 v28, v28, v20
    v_mul_f32 v29, v29, v21
    v_mul_f32 v30, v30, v22
    v_mul_f32 v31, v31, v23
    v_cvt_pk_bf16_f32 v44, v24, v25
    v_cvt_pk_bf16_f32 v45, v26, v27
    v_cvt_pk_bf16_f32 v46, v28, v29
    v_cvt_pk_bf16_f32 v47, v30, v31
    ds_write2st64_b64 v0, v[44:45], v[46:47] offset0:52 offset1:53
    buffer_load_dwordx4 v[44:47], v3, s[12:15], s47 offen offset:768
    s_waitcnt vmcnt(23)
    v_lshlrev_b32 v24, 16, v48
    v_and_b32 v25, s60, v48
    v_lshlrev_b32 v26, 16, v49
    v_and_b32 v27, s60, v49
    v_lshlrev_b32 v28, 16, v50
    v_and_b32 v29, s60, v50
    v_lshlrev_b32 v30, 16, v51
    v_and_b32 v31, s60, v51
    v_mul_f32 v24, v24, v16
    v_mul_f32 v25, v25, v17
    v_mul_f32 v26, v26, v18
    v_mul_f32 v27, v27, v19
    v_mul_f32 v28, v28, v20
    v_mul_f32 v29, v29, v21
    v_mul_f32 v30, v30, v22
    v_mul_f32 v31, v31, v23
    v_cvt_pk_bf16_f32 v48, v24, v25
    v_cvt_pk_bf16_f32 v49, v26, v27
    v_cvt_pk_bf16_f32 v50, v28, v29
    v_cvt_pk_bf16_f32 v51, v30, v31
    ds_write2st64_b64 v4, v[48:49], v[50:51] offset0:56 offset1:57
    buffer_load_dwordx4 v[48:51], v3, s[12:15], s48 offen offset:768
    s_waitcnt vmcnt(23)
    v_lshlrev_b32 v24, 16, v52
    v_and_b32 v25, s60, v52
    v_lshlrev_b32 v26, 16, v53
    v_and_b32 v27, s60, v53
    v_lshlrev_b32 v28, 16, v54
    v_and_b32 v29, s60, v54
    v_lshlrev_b32 v30, 16, v55
    v_and_b32 v31, s60, v55
    v_mul_f32 v24, v24, v16
    v_mul_f32 v25, v25, v17
    v_mul_f32 v26, v26, v18
    v_mul_f32 v27, v27, v19
    v_mul_f32 v28, v28, v20
    v_mul_f32 v29, v29, v21
    v_mul_f32 v30, v30, v22
    v_mul_f32 v31, v31, v23
    v_cvt_pk_bf16_f32 v52, v24, v25
    v_cvt_pk_bf16_f32 v53, v26, v27
    v_cvt_pk_bf16_f32 v54, v28, v29
    v_cvt_pk_bf16_f32 v55, v30, v31
    ds_write2st64_b64 v0, v[52:53], v[54:55] offset0:56 offset1:57
    buffer_load_dwordx4 v[52:55], v3, s[12:15], s49 offen offset:768
    s_waitcnt vmcnt(23)
    v_lshlrev_b32 v24, 16, v56
    v_and_b32 v25, s60, v56
    v_lshlrev_b32 v26, 16, v57
    v_and_b32 v27, s60, v57
    v_lshlrev_b32 v28, 16, v58
    v_and_b32 v29, s60, v58
    v_lshlrev_b32 v30, 16, v59
    v_and_b32 v31, s60, v59
    v_mul_f32 v24, v24, v16
    v_mul_f32 v25, v25, v17
    v_mul_f32 v26, v26, v18
    v_mul_f32 v27, v27, v19
    v_mul_f32 v28, v28, v20
    v_mul_f32 v29, v29, v21
    v_mul_f32 v30, v30, v22
    v_mul_f32 v31, v31, v23
    v_cvt_pk_bf16_f32 v56, v24, v25
    v_cvt_pk_bf16_f32 v57, v26, v27
    v_cvt_pk_bf16_f32 v58, v28, v29
    v_cvt_pk_bf16_f32 v59, v30, v31
    ds_write2st64_b64 v4, v[56:57], v[58:59] offset0:60 offset1:61
    buffer_load_dwordx4 v[56:59], v3, s[12:15], s50 offen offset:768
    s_waitcnt vmcnt(23)
    v_lshlrev_b32 v24, 16, v60
    v_and_b32 v25, s60, v60
    v_lshlrev_b32 v26, 16, v61
    v_and_b32 v27, s60, v61
    v_lshlrev_b32 v28, 16, v62
    v_and_b32 v29, s60, v62
    v_lshlrev_b32 v30, 16, v63
    v_and_b32 v31, s60, v63
    v_mul_f32 v24, v24, v16
    v_mul_f32 v25, v25, v17
    v_mul_f32 v26, v26, v18
    v_mul_f32 v27, v27, v19
    v_mul_f32 v28, v28, v20
    v_mul_f32 v29, v29, v21
    v_mul_f32 v30, v30, v22
    v_mul_f32 v31, v31, v23
    v_cvt_pk_bf16_f32 v60, v24, v25
    v_cvt_pk_bf16_f32 v61, v26, v27
    v_cvt_pk_bf16_f32 v62, v28, v29
    v_cvt_pk_bf16_f32 v63, v30, v31
    ds_write2st64_b64 v0, v[60:61], v[62:63] offset0:60 offset1:61
    buffer_load_dwordx4 v[60:63], v3, s[12:15], s51 offen offset:768
    v_mov_b32 v7, 4
    ds_write_b32 v6, v7
k3_gemm2_kernel_wc21:
    ds_read_b32 v7, v6 offset:4
    s_waitcnt lgkmcnt(0)
    v_readfirstlane_b32 s70, v7
    s_nop 0
    s_cmp_ge_u32 s70, 1
    s_cbranch_scc1 k3_gemm2_kernel_wc21k
    s_sleep 2
    s_branch k3_gemm2_kernel_wc21
k3_gemm2_kernel_wc21k:
    ds_read_b128 v[16:19], v5 offset:1280
    ds_read_b128 v[20:23], v5 offset:1296
    s_waitcnt vmcnt(23)
    v_lshlrev_b32 v24, 16, v64
    v_and_b32 v25, s60, v64
    v_lshlrev_b32 v26, 16, v65
    v_and_b32 v27, s60, v65
    v_lshlrev_b32 v28, 16, v66
    v_and_b32 v29, s60, v66
    v_lshlrev_b32 v30, 16, v67
    v_and_b32 v31, s60, v67
    v_mul_f32 v24, v24, v8
    v_mul_f32 v25, v25, v9
    v_mul_f32 v26, v26, v10
    v_mul_f32 v27, v27, v11
    v_mul_f32 v28, v28, v12
    v_mul_f32 v29, v29, v13
    v_mul_f32 v30, v30, v14
    v_mul_f32 v31, v31, v15
    v_cvt_pk_bf16_f32 v64, v24, v25
    v_cvt_pk_bf16_f32 v65, v26, v27
    v_cvt_pk_bf16_f32 v66, v28, v29
    v_cvt_pk_bf16_f32 v67, v30, v31
    ds_write2st64_b64 v4, v[64:65], v[66:67] offset0:0 offset1:1
    buffer_load_dwordx4 v[64:67], v3, s[12:15], s44 offen offset:896
    s_waitcnt vmcnt(23)
    v_lshlrev_b32 v24, 16, v68
    v_and_b32 v25, s60, v68
    v_lshlrev_b32 v26, 16, v69
    v_and_b32 v27, s60, v69
    v_lshlrev_b32 v28, 16, v70
    v_and_b32 v29, s60, v70
    v_lshlrev_b32 v30, 16, v71
    v_and_b32 v31, s60, v71
    v_mul_f32 v24, v24, v8
    v_mul_f32 v25, v25, v9
    v_mul_f32 v26, v26, v10
    v_mul_f32 v27, v27, v11
    v_mul_f32 v28, v28, v12
    v_mul_f32 v29, v29, v13
    v_mul_f32 v30, v30, v14
    v_mul_f32 v31, v31, v15
    v_cvt_pk_bf16_f32 v68, v24, v25
    v_cvt_pk_bf16_f32 v69, v26, v27
    v_cvt_pk_bf16_f32 v70, v28, v29
    v_cvt_pk_bf16_f32 v71, v30, v31
    ds_write2st64_b64 v0, v[68:69], v[70:71] offset0:0 offset1:1
    buffer_load_dwordx4 v[68:71], v3, s[12:15], s45 offen offset:896
    s_waitcnt vmcnt(23)
    v_lshlrev_b32 v24, 16, v72
    v_and_b32 v25, s60, v72
    v_lshlrev_b32 v26, 16, v73
    v_and_b32 v27, s60, v73
    v_lshlrev_b32 v28, 16, v74
    v_and_b32 v29, s60, v74
    v_lshlrev_b32 v30, 16, v75
    v_and_b32 v31, s60, v75
    v_mul_f32 v24, v24, v8
    v_mul_f32 v25, v25, v9
    v_mul_f32 v26, v26, v10
    v_mul_f32 v27, v27, v11
    v_mul_f32 v28, v28, v12
    v_mul_f32 v29, v29, v13
    v_mul_f32 v30, v30, v14
    v_mul_f32 v31, v31, v15
    v_cvt_pk_bf16_f32 v72, v24, v25
    v_cvt_pk_bf16_f32 v73, v26, v27
    v_cvt_pk_bf16_f32 v74, v28, v29
    v_cvt_pk_bf16_f32 v75, v30, v31
    ds_write2st64_b64 v4, v[72:73], v[74:75] offset0:4 offset1:5
    buffer_load_dwordx4 v[72:75], v3, s[12:15], s46 offen offset:896
    s_waitcnt vmcnt(23)
    v_lshlrev_b32 v24, 16, v76
    v_and_b32 v25, s60, v76
    v_lshlrev_b32 v26, 16, v77
    v_and_b32 v27, s60, v77
    v_lshlrev_b32 v28, 16, v78
    v_and_b32 v29, s60, v78
    v_lshlrev_b32 v30, 16, v79
    v_and_b32 v31, s60, v79
    v_mul_f32 v24, v24, v8
    v_mul_f32 v25, v25, v9
    v_mul_f32 v26, v26, v10
    v_mul_f32 v27, v27, v11
    v_mul_f32 v28, v28, v12
    v_mul_f32 v29, v29, v13
    v_mul_f32 v30, v30, v14
    v_mul_f32 v31, v31, v15
    v_cvt_pk_bf16_f32 v76, v24, v25
    v_cvt_pk_bf16_f32 v77, v26, v27
    v_cvt_pk_bf16_f32 v78, v28, v29
    v_cvt_pk_bf16_f32 v79, v30, v31
    ds_write2st64_b64 v0, v[76:77], v[78:79] offset0:4 offset1:5
    buffer_load_dwordx4 v[76:79], v3, s[12:15], s47 offen offset:896
    s_waitcnt vmcnt(23)
    v_lshlrev_b32 v24, 16, v80
    v_and_b32 v25, s60, v80
    v_lshlrev_b32 v26, 16, v81
    v_and_b32 v27, s60, v81
    v_lshlrev_b32 v28, 16, v82
    v_and_b32 v29, s60, v82
    v_lshlrev_b32 v30, 16, v83
    v_and_b32 v31, s60, v83
    v_mul_f32 v24, v24, v8
    v_mul_f32 v25, v25, v9
    v_mul_f32 v26, v26, v10
    v_mul_f32 v27, v27, v11
    v_mul_f32 v28, v28, v12
    v_mul_f32 v29, v29, v13
    v_mul_f32 v30, v30, v14
    v_mul_f32 v31, v31, v15
    v_cvt_pk_bf16_f32 v80, v24, v25
    v_cvt_pk_bf16_f32 v81, v26, v27
    v_cvt_pk_bf16_f32 v82, v28, v29
    v_cvt_pk_bf16_f32 v83, v30, v31
    ds_write2st64_b64 v4, v[80:81], v[82:83] offset0:8 offset1:9
    buffer_load_dwordx4 v[80:83], v3, s[12:15], s48 offen offset:896
    s_waitcnt vmcnt(23)
    v_lshlrev_b32 v24, 16, v84
    v_and_b32 v25, s60, v84
    v_lshlrev_b32 v26, 16, v85
    v_and_b32 v27, s60, v85
    v_lshlrev_b32 v28, 16, v86
    v_and_b32 v29, s60, v86
    v_lshlrev_b32 v30, 16, v87
    v_and_b32 v31, s60, v87
    v_mul_f32 v24, v24, v8
    v_mul_f32 v25, v25, v9
    v_mul_f32 v26, v26, v10
    v_mul_f32 v27, v27, v11
    v_mul_f32 v28, v28, v12
    v_mul_f32 v29, v29, v13
    v_mul_f32 v30, v30, v14
    v_mul_f32 v31, v31, v15
    v_cvt_pk_bf16_f32 v84, v24, v25
    v_cvt_pk_bf16_f32 v85, v26, v27
    v_cvt_pk_bf16_f32 v86, v28, v29
    v_cvt_pk_bf16_f32 v87, v30, v31
    ds_write2st64_b64 v0, v[84:85], v[86:87] offset0:8 offset1:9
    buffer_load_dwordx4 v[84:87], v3, s[12:15], s49 offen offset:896
    s_waitcnt vmcnt(23)
    v_lshlrev_b32 v24, 16, v88
    v_and_b32 v25, s60, v88
    v_lshlrev_b32 v26, 16, v89
    v_and_b32 v27, s60, v89
    v_lshlrev_b32 v28, 16, v90
    v_and_b32 v29, s60, v90
    v_lshlrev_b32 v30, 16, v91
    v_and_b32 v31, s60, v91
    v_mul_f32 v24, v24, v8
    v_mul_f32 v25, v25, v9
    v_mul_f32 v26, v26, v10
    v_mul_f32 v27, v27, v11
    v_mul_f32 v28, v28, v12
    v_mul_f32 v29, v29, v13
    v_mul_f32 v30, v30, v14
    v_mul_f32 v31, v31, v15
    v_cvt_pk_bf16_f32 v88, v24, v25
    v_cvt_pk_bf16_f32 v89, v26, v27
    v_cvt_pk_bf16_f32 v90, v28, v29
    v_cvt_pk_bf16_f32 v91, v30, v31
    ds_write2st64_b64 v4, v[88:89], v[90:91] offset0:12 offset1:13
    buffer_load_dwordx4 v[88:91], v3, s[12:15], s50 offen offset:896
    s_waitcnt vmcnt(23)
    v_lshlrev_b32 v24, 16, v92
    v_and_b32 v25, s60, v92
    v_lshlrev_b32 v26, 16, v93
    v_and_b32 v27, s60, v93
    v_lshlrev_b32 v28, 16, v94
    v_and_b32 v29, s60, v94
    v_lshlrev_b32 v30, 16, v95
    v_and_b32 v31, s60, v95
    v_mul_f32 v24, v24, v8
    v_mul_f32 v25, v25, v9
    v_mul_f32 v26, v26, v10
    v_mul_f32 v27, v27, v11
    v_mul_f32 v28, v28, v12
    v_mul_f32 v29, v29, v13
    v_mul_f32 v30, v30, v14
    v_mul_f32 v31, v31, v15
    v_cvt_pk_bf16_f32 v92, v24, v25
    v_cvt_pk_bf16_f32 v93, v26, v27
    v_cvt_pk_bf16_f32 v94, v28, v29
    v_cvt_pk_bf16_f32 v95, v30, v31
    ds_write2st64_b64 v0, v[92:93], v[94:95] offset0:12 offset1:13
    buffer_load_dwordx4 v[92:95], v3, s[12:15], s51 offen offset:896
    v_mov_b32 v7, 5
    ds_write_b32 v6, v7
k3_gemm2_kernel_wc22:
    ds_read_b32 v7, v6 offset:4
    s_waitcnt lgkmcnt(0)
    v_readfirstlane_b32 s70, v7
    s_nop 0
    s_cmp_ge_u32 s70, 2
    s_cbranch_scc1 k3_gemm2_kernel_wc22k
    s_sleep 2
    s_branch k3_gemm2_kernel_wc22
k3_gemm2_kernel_wc22k:
    ds_read_b128 v[8:11], v5 offset:1536
    ds_read_b128 v[12:15], v5 offset:1552
    s_waitcnt vmcnt(23)
    v_lshlrev_b32 v24, 16, v96
    v_and_b32 v25, s60, v96
    v_lshlrev_b32 v26, 16, v97
    v_and_b32 v27, s60, v97
    v_lshlrev_b32 v28, 16, v98
    v_and_b32 v29, s60, v98
    v_lshlrev_b32 v30, 16, v99
    v_and_b32 v31, s60, v99
    v_mul_f32 v24, v24, v16
    v_mul_f32 v25, v25, v17
    v_mul_f32 v26, v26, v18
    v_mul_f32 v27, v27, v19
    v_mul_f32 v28, v28, v20
    v_mul_f32 v29, v29, v21
    v_mul_f32 v30, v30, v22
    v_mul_f32 v31, v31, v23
    v_cvt_pk_bf16_f32 v96, v24, v25
    v_cvt_pk_bf16_f32 v97, v26, v27
    v_cvt_pk_bf16_f32 v98, v28, v29
    v_cvt_pk_bf16_f32 v99, v30, v31
    ds_write2st64_b64 v4, v[96:97], v[98:99] offset0:16 offset1:17
    s_waitcnt vmcnt(22)
    v_lshlrev_b32 v24, 16, v100
    v_and_b32 v25, s60, v100
    v_lshlrev_b32 v26, 16, v101
    v_and_b32 v27, s60, v101
    v_lshlrev_b32 v28, 16, v102
    v_and_b32 v29, s60, v102
    v_lshlrev_b32 v30, 16, v103
    v_and_b32 v31, s60, v103
    v_mul_f32 v24, v24, v16
    v_mul_f32 v25, v25, v17
    v_mul_f32 v26, v26, v18
    v_mul_f32 v27, v27, v19
    v_mul_f32 v28, v28, v20
    v_mul_f32 v29, v29, v21
    v_mul_f32 v30, v30, v22
    v_mul_f32 v31, v31, v23
    v_cvt_pk_bf16_f32 v100, v24, v25
    v_cvt_pk_bf16_f32 v101, v26, v27
    v_cvt_pk_bf16_f32 v102, v28, v29
    v_cvt_pk_bf16_f32 v103, v30, v31
    ds_write2st64_b64 v0, v[100:101], v[102:103] offset0:16 offset1:17
    s_waitcnt vmcnt(21)
    v_lshlrev_b32 v24, 16, v104
    v_and_b32 v25, s60, v104
    v_lshlrev_b32 v26, 16, v105
    v_and_b32 v27, s60, v105
    v_lshlrev_b32 v28, 16, v106
    v_and_b32 v29, s60, v106
    v_lshlrev_b32 v30, 16, v107
    v_and_b32 v31, s60, v107
    v_mul_f32 v24, v24, v16
    v_mul_f32 v25, v25, v17
    v_mul_f32 v26, v26, v18
    v_mul_f32 v27, v27, v19
    v_mul_f32 v28, v28, v20
    v_mul_f32 v29, v29, v21
    v_mul_f32 v30, v30, v22
    v_mul_f32 v31, v31, v23
    v_cvt_pk_bf16_f32 v104, v24, v25
    v_cvt_pk_bf16_f32 v105, v26, v27
    v_cvt_pk_bf16_f32 v106, v28, v29
    v_cvt_pk_bf16_f32 v107, v30, v31
    ds_write2st64_b64 v4, v[104:105], v[106:107] offset0:20 offset1:21
    s_waitcnt vmcnt(20)
    v_lshlrev_b32 v24, 16, v108
    v_and_b32 v25, s60, v108
    v_lshlrev_b32 v26, 16, v109
    v_and_b32 v27, s60, v109
    v_lshlrev_b32 v28, 16, v110
    v_and_b32 v29, s60, v110
    v_lshlrev_b32 v30, 16, v111
    v_and_b32 v31, s60, v111
    v_mul_f32 v24, v24, v16
    v_mul_f32 v25, v25, v17
    v_mul_f32 v26, v26, v18
    v_mul_f32 v27, v27, v19
    v_mul_f32 v28, v28, v20
    v_mul_f32 v29, v29, v21
    v_mul_f32 v30, v30, v22
    v_mul_f32 v31, v31, v23
    v_cvt_pk_bf16_f32 v108, v24, v25
    v_cvt_pk_bf16_f32 v109, v26, v27
    v_cvt_pk_bf16_f32 v110, v28, v29
    v_cvt_pk_bf16_f32 v111, v30, v31
    ds_write2st64_b64 v0, v[108:109], v[110:111] offset0:20 offset1:21
    s_waitcnt vmcnt(19)
    v_lshlrev_b32 v24, 16, v112
    v_and_b32 v25, s60, v112
    v_lshlrev_b32 v26, 16, v113
    v_and_b32 v27, s60, v113
    v_lshlrev_b32 v28, 16, v114
    v_and_b32 v29, s60, v114
    v_lshlrev_b32 v30, 16, v115
    v_and_b32 v31, s60, v115
    v_mul_f32 v24, v24, v16
    v_mul_f32 v25, v25, v17
    v_mul_f32 v26, v26, v18
    v_mul_f32 v27, v27, v19
    v_mul_f32 v28, v28, v20
    v_mul_f32 v29, v29, v21
    v_mul_f32 v30, v30, v22
    v_mul_f32 v31, v31, v23
    v_cvt_pk_bf16_f32 v112, v24, v25
    v_cvt_pk_bf16_f32 v113, v26, v27
    v_cvt_pk_bf16_f32 v114, v28, v29
    v_cvt_pk_bf16_f32 v115, v30, v31
    ds_write2st64_b64 v4, v[112:113], v[114:115] offset0:24 offset1:25
    s_waitcnt vmcnt(18)
    v_lshlrev_b32 v24, 16, v116
    v_and_b32 v25, s60, v116
    v_lshlrev_b32 v26, 16, v117
    v_and_b32 v27, s60, v117
    v_lshlrev_b32 v28, 16, v118
    v_and_b32 v29, s60, v118
    v_lshlrev_b32 v30, 16, v119
    v_and_b32 v31, s60, v119
    v_mul_f32 v24, v24, v16
    v_mul_f32 v25, v25, v17
    v_mul_f32 v26, v26, v18
    v_mul_f32 v27, v27, v19
    v_mul_f32 v28, v28, v20
    v_mul_f32 v29, v29, v21
    v_mul_f32 v30, v30, v22
    v_mul_f32 v31, v31, v23
    v_cvt_pk_bf16_f32 v116, v24, v25
    v_cvt_pk_bf16_f32 v117, v26, v27
    v_cvt_pk_bf16_f32 v118, v28, v29
    v_cvt_pk_bf16_f32 v119, v30, v31
    ds_write2st64_b64 v0, v[116:117], v[118:119] offset0:24 offset1:25
    s_waitcnt vmcnt(17)
    v_lshlrev_b32 v24, 16, v120
    v_and_b32 v25, s60, v120
    v_lshlrev_b32 v26, 16, v121
    v_and_b32 v27, s60, v121
    v_lshlrev_b32 v28, 16, v122
    v_and_b32 v29, s60, v122
    v_lshlrev_b32 v30, 16, v123
    v_and_b32 v31, s60, v123
    v_mul_f32 v24, v24, v16
    v_mul_f32 v25, v25, v17
    v_mul_f32 v26, v26, v18
    v_mul_f32 v27, v27, v19
    v_mul_f32 v28, v28, v20
    v_mul_f32 v29, v29, v21
    v_mul_f32 v30, v30, v22
    v_mul_f32 v31, v31, v23
    v_cvt_pk_bf16_f32 v120, v24, v25
    v_cvt_pk_bf16_f32 v121, v26, v27
    v_cvt_pk_bf16_f32 v122, v28, v29
    v_cvt_pk_bf16_f32 v123, v30, v31
    ds_write2st64_b64 v4, v[120:121], v[122:123] offset0:28 offset1:29
    s_waitcnt vmcnt(16)
    v_lshlrev_b32 v24, 16, v124
    v_and_b32 v25, s60, v124
    v_lshlrev_b32 v26, 16, v125
    v_and_b32 v27, s60, v125
    v_lshlrev_b32 v28, 16, v126
    v_and_b32 v29, s60, v126
    v_lshlrev_b32 v30, 16, v127
    v_and_b32 v31, s60, v127
    v_mul_f32 v24, v24, v16
    v_mul_f32 v25, v25, v17
    v_mul_f32 v26, v26, v18
    v_mul_f32 v27, v27, v19
    v_mul_f32 v28, v28, v20
    v_mul_f32 v29, v29, v21
    v_mul_f32 v30, v30, v22
    v_mul_f32 v31, v31, v23
    v_cvt_pk_bf16_f32 v124, v24, v25
    v_cvt_pk_bf16_f32 v125, v26, v27
    v_cvt_pk_bf16_f32 v126, v28, v29
    v_cvt_pk_bf16_f32 v127, v30, v31
    ds_write2st64_b64 v0, v[124:125], v[126:127] offset0:28 offset1:29
    v_mov_b32 v7, 6
    ds_write_b32 v6, v7
k3_gemm2_kernel_wc23:
    ds_read_b32 v7, v6 offset:4
    s_waitcnt lgkmcnt(0)
    v_readfirstlane_b32 s70, v7
    s_nop 0
    s_cmp_ge_u32 s70, 3
    s_cbranch_scc1 k3_gemm2_kernel_wc23k
    s_sleep 2
    s_branch k3_gemm2_kernel_wc23
k3_gemm2_kernel_wc23k:
    ds_read_b128 v[16:19], v5 offset:1792
    ds_read_b128 v[20:23], v5 offset:1808
    s_waitcnt vmcnt(15)
    v_lshlrev_b32 v24, 16, v32
    v_and_b32 v25, s60, v32
    v_lshlrev_b32 v26, 16, v33
    v_and_b32 v27, s60, v33
    v_lshlrev_b32 v28, 16, v34
    v_and_b32 v29, s60, v34
    v_lshlrev_b32 v30, 16, v35
    v_and_b32 v31, s60, v35
    v_mul_f32 v24, v24, v8
    v_mul_f32 v25, v25, v9
    v_mul_f32 v26, v26, v10
    v_mul_f32 v27, v27, v11
    v_mul_f32 v28, v28, v12
    v_mul_f32 v29, v29, v13
    v_mul_f32 v30, v30, v14
    v_mul_f32 v31, v31, v15
    v_cvt_pk_bf16_f32 v32, v24, v25
    v_cvt_pk_bf16_f32 v33, v26, v27
    v_cvt_pk_bf16_f32 v34, v28, v29
    v_cvt_pk_bf16_f32 v35, v30, v31
    ds_write2st64_b64 v4, v[32:33], v[34:35] offset0:32 offset1:33
    s_waitcnt vmcnt(14)
    v_lshlrev_b32 v24, 16, v36
    v_and_b32 v25, s60, v36
    v_lshlrev_b32 v26, 16, v37
    v_and_b32 v27, s60, v37
    v_lshlrev_b32 v28, 16, v38
    v_and_b32 v29, s60, v38
    v_lshlrev_b32 v30, 16, v39
    v_and_b32 v31, s60, v39
    v_mul_f32 v24, v24, v8
    v_mul_f32 v25, v25, v9
    v_mul_f32 v26, v26, v10
    v_mul_f32 v27, v27, v11
    v_mul_f32 v28, v28, v12
    v_mul_f32 v29, v29, v13
    v_mul_f32 v30, v30, v14
    v_mul_f32 v31, v31, v15
    v_cvt_pk_bf16_f32 v36, v24, v25
    v_cvt_pk_bf16_f32 v37, v26, v27
    v_cvt_pk_bf16_f32 v38, v28, v29
    v_cvt_pk_bf16_f32 v39, v30, v31
    ds_write2st64_b64 v0, v[36:37], v[38:39] offset0:32 offset1:33
    s_waitcnt vmcnt(13)
    v_lshlrev_b32 v24, 16, v40
    v_and_b32 v25, s60, v40
    v_lshlrev_b32 v26, 16, v41
    v_and_b32 v27, s60, v41
    v_lshlrev_b32 v28, 16, v42
    v_and_b32 v29, s60, v42
    v_lshlrev_b32 v30, 16, v43
    v_and_b32 v31, s60, v43
    v_mul_f32 v24, v24, v8
    v_mul_f32 v25, v25, v9
    v_mul_f32 v26, v26, v10
    v_mul_f32 v27, v27, v11
    v_mul_f32 v28, v28, v12
    v_mul_f32 v29, v29, v13
    v_mul_f32 v30, v30, v14
    v_mul_f32 v31, v31, v15
    v_cvt_pk_bf16_f32 v40, v24, v25
    v_cvt_pk_bf16_f32 v41, v26, v27
    v_cvt_pk_bf16_f32 v42, v28, v29
    v_cvt_pk_bf16_f32 v43, v30, v31
    ds_write2st64_b64 v4, v[40:41], v[42:43] offset0:36 offset1:37
    s_waitcnt vmcnt(12)
    v_lshlrev_b32 v24, 16, v44
    v_and_b32 v25, s60, v44
    v_lshlrev_b32 v26, 16, v45
    v_and_b32 v27, s60, v45
    v_lshlrev_b32 v28, 16, v46
    v_and_b32 v29, s60, v46
    v_lshlrev_b32 v30, 16, v47
    v_and_b32 v31, s60, v47
    v_mul_f32 v24, v24, v8
    v_mul_f32 v25, v25, v9
    v_mul_f32 v26, v26, v10
    v_mul_f32 v27, v27, v11
    v_mul_f32 v28, v28, v12
    v_mul_f32 v29, v29, v13
    v_mul_f32 v30, v30, v14
    v_mul_f32 v31, v31, v15
    v_cvt_pk_bf16_f32 v44, v24, v25
    v_cvt_pk_bf16_f32 v45, v26, v27
    v_cvt_pk_bf16_f32 v46, v28, v29
    v_cvt_pk_bf16_f32 v47, v30, v31
    ds_write2st64_b64 v0, v[44:45], v[46:47] offset0:36 offset1:37
    s_waitcnt vmcnt(11)
    v_lshlrev_b32 v24, 16, v48
    v_and_b32 v25, s60, v48
    v_lshlrev_b32 v26, 16, v49
    v_and_b32 v27, s60, v49
    v_lshlrev_b32 v28, 16, v50
    v_and_b32 v29, s60, v50
    v_lshlrev_b32 v30, 16, v51
    v_and_b32 v31, s60, v51
    v_mul_f32 v24, v24, v8
    v_mul_f32 v25, v25, v9
    v_mul_f32 v26, v26, v10
    v_mul_f32 v27, v27, v11
    v_mul_f32 v28, v28, v12
    v_mul_f32 v29, v29, v13
    v_mul_f32 v30, v30, v14
    v_mul_f32 v31, v31, v15
    v_cvt_pk_bf16_f32 v48, v24, v25
    v_cvt_pk_bf16_f32 v49, v26, v27
    v_cvt_pk_bf16_f32 v50, v28, v29
    v_cvt_pk_bf16_f32 v51, v30, v31
    ds_write2st64_b64 v4, v[48:49], v[50:51] offset0:40 offset1:41
    s_waitcnt vmcnt(10)
    v_lshlrev_b32 v24, 16, v52
    v_and_b32 v25, s60, v52
    v_lshlrev_b32 v26, 16, v53
    v_and_b32 v27, s60, v53
    v_lshlrev_b32 v28, 16, v54
    v_and_b32 v29, s60, v54
    v_lshlrev_b32 v30, 16, v55
    v_and_b32 v31, s60, v55
    v_mul_f32 v24, v24, v8
    v_mul_f32 v25, v25, v9
    v_mul_f32 v26, v26, v10
    v_mul_f32 v27, v27, v11
    v_mul_f32 v28, v28, v12
    v_mul_f32 v29, v29, v13
    v_mul_f32 v30, v30, v14
    v_mul_f32 v31, v31, v15
    v_cvt_pk_bf16_f32 v52, v24, v25
    v_cvt_pk_bf16_f32 v53, v26, v27
    v_cvt_pk_bf16_f32 v54, v28, v29
    v_cvt_pk_bf16_f32 v55, v30, v31
    ds_write2st64_b64 v0, v[52:53], v[54:55] offset0:40 offset1:41
    s_waitcnt vmcnt(9)
    v_lshlrev_b32 v24, 16, v56
    v_and_b32 v25, s60, v56
    v_lshlrev_b32 v26, 16, v57
    v_and_b32 v27, s60, v57
    v_lshlrev_b32 v28, 16, v58
    v_and_b32 v29, s60, v58
    v_lshlrev_b32 v30, 16, v59
    v_and_b32 v31, s60, v59
    v_mul_f32 v24, v24, v8
    v_mul_f32 v25, v25, v9
    v_mul_f32 v26, v26, v10
    v_mul_f32 v27, v27, v11
    v_mul_f32 v28, v28, v12
    v_mul_f32 v29, v29, v13
    v_mul_f32 v30, v30, v14
    v_mul_f32 v31, v31, v15
    v_cvt_pk_bf16_f32 v56, v24, v25
    v_cvt_pk_bf16_f32 v57, v26, v27
    v_cvt_pk_bf16_f32 v58, v28, v29
    v_cvt_pk_bf16_f32 v59, v30, v31
    ds_write2st64_b64 v4, v[56:57], v[58:59] offset0:44 offset1:45
    s_waitcnt vmcnt(8)
    v_lshlrev_b32 v24, 16, v60
    v_and_b32 v25, s60, v60
    v_lshlrev_b32 v26, 16, v61
    v_and_b32 v27, s60, v61
    v_lshlrev_b32 v28, 16, v62
    v_and_b32 v29, s60, v62
    v_lshlrev_b32 v30, 16, v63
    v_and_b32 v31, s60, v63
    v_mul_f32 v24, v24, v8
    v_mul_f32 v25, v25, v9
    v_mul_f32 v26, v26, v10
    v_mul_f32 v27, v27, v11
    v_mul_f32 v28, v28, v12
    v_mul_f32 v29, v29, v13
    v_mul_f32 v30, v30, v14
    v_mul_f32 v31, v31, v15
    v_cvt_pk_bf16_f32 v60, v24, v25
    v_cvt_pk_bf16_f32 v61, v26, v27
    v_cvt_pk_bf16_f32 v62, v28, v29
    v_cvt_pk_bf16_f32 v63, v30, v31
    ds_write2st64_b64 v0, v[60:61], v[62:63] offset0:44 offset1:45
    v_mov_b32 v7, 7
    ds_write_b32 v6, v7
k3_gemm2_kernel_wc24:
    ds_read_b32 v7, v6 offset:4
    s_waitcnt lgkmcnt(0)
    v_readfirstlane_b32 s70, v7
    s_nop 0
    s_cmp_ge_u32 s70, 4
    s_cbranch_scc1 k3_gemm2_kernel_wc24k
    s_sleep 2
    s_branch k3_gemm2_kernel_wc24
k3_gemm2_kernel_wc24k:
    s_waitcnt vmcnt(7)
    v_lshlrev_b32 v24, 16, v64
    v_and_b32 v25, s60, v64
    v_lshlrev_b32 v26, 16, v65
    v_and_b32 v27, s60, v65
    v_lshlrev_b32 v28, 16, v66
    v_and_b32 v29, s60, v66
    v_lshlrev_b32 v30, 16, v67
    v_and_b32 v31, s60, v67
    v_mul_f32 v24, v24, v16
    v_mul_f32 v25, v25, v17
    v_mul_f32 v26, v26, v18
    v_mul_f32 v27, v27, v19
    v_mul_f32 v28, v28, v20
    v_mul_f32 v29, v29, v21
    v_mul_f32 v30, v30, v22
    v_mul_f32 v31, v31, v23
    v_cvt_pk_bf16_f32 v64, v24, v25
    v_cvt_pk_bf16_f32 v65, v26, v27
    v_cvt_pk_bf16_f32 v66, v28, v29
    v_cvt_pk_bf16_f32 v67, v30, v31
    ds_write2st64_b64 v4, v[64:65], v[66:67] offset0:48 offset1:49
    s_waitcnt vmcnt(6)
    v_lshlrev_b32 v24, 16, v68
    v_and_b32 v25, s60, v68
    v_lshlrev_b32 v26, 16, v69
    v_and_b32 v27, s60, v69
    v_lshlrev_b32 v28, 16, v70
    v_and_b32 v29, s60, v70
    v_lshlrev_b32 v30, 16, v71
    v_and_b32 v31, s60, v71
    v_mul_f32 v24, v24, v16
    v_mul_f32 v25, v25, v17
    v_mul_f32 v26, v26, v18
    v_mul_f32 v27, v27, v19
    v_mul_f32 v28, v28, v20
    v_mul_f32 v29, v29, v21
    v_mul_f32 v30, v30, v22
    v_mul_f32 v31, v31, v23
    v_cvt_pk_bf16_f32 v68, v24, v25
    v_cvt_pk_bf16_f32 v69, v26, v27
    v_cvt_pk_bf16_f32 v70, v28, v29
    v_cvt_pk_bf16_f32 v71, v30, v31
    ds_write2st64_b64 v0, v[68:69], v[70:71] offset0:48 offset1:49
    s_waitcnt vmcnt(5)
    v_lshlrev_b32 v24, 16, v72
    v_and_b32 v25, s60, v72
    v_lshlrev_b32 v26, 16, v73
    v_and_b32 v27, s60, v73
    v_lshlrev_b32 v28, 16, v74
    v_and_b32 v29, s60, v74
    v_lshlrev_b32 v30, 16, v75
    v_and_b32 v31, s60, v75
    v_mul_f32 v24, v24, v16
    v_mul_f32 v25, v25, v17
    v_mul_f32 v26, v26, v18
    v_mul_f32 v27, v27, v19
    v_mul_f32 v28, v28, v20
    v_mul_f32 v29, v29, v21
    v_mul_f32 v30, v30, v22
    v_mul_f32 v31, v31, v23
    v_cvt_pk_bf16_f32 v72, v24, v25
    v_cvt_pk_bf16_f32 v73, v26, v27
    v_cvt_pk_bf16_f32 v74, v28, v29
    v_cvt_pk_bf16_f32 v75, v30, v31
    ds_write2st64_b64 v4, v[72:73], v[74:75] offset0:52 offset1:53
    s_waitcnt vmcnt(4)
    v_lshlrev_b32 v24, 16, v76
    v_and_b32 v25, s60, v76
    v_lshlrev_b32 v26, 16, v77
    v_and_b32 v27, s60, v77
    v_lshlrev_b32 v28, 16, v78
    v_and_b32 v29, s60, v78
    v_lshlrev_b32 v30, 16, v79
    v_and_b32 v31, s60, v79
    v_mul_f32 v24, v24, v16
    v_mul_f32 v25, v25, v17
    v_mul_f32 v26, v26, v18
    v_mul_f32 v27, v27, v19
    v_mul_f32 v28, v28, v20
    v_mul_f32 v29, v29, v21
    v_mul_f32 v30, v30, v22
    v_mul_f32 v31, v31, v23
    v_cvt_pk_bf16_f32 v76, v24, v25
    v_cvt_pk_bf16_f32 v77, v26, v27
    v_cvt_pk_bf16_f32 v78, v28, v29
    v_cvt_pk_bf16_f32 v79, v30, v31
    ds_write2st64_b64 v0, v[76:77], v[78:79] offset0:52 offset1:53
    s_waitcnt vmcnt(3)
    v_lshlrev_b32 v24, 16, v80
    v_and_b32 v25, s60, v80
    v_lshlrev_b32 v26, 16, v81
    v_and_b32 v27, s60, v81
    v_lshlrev_b32 v28, 16, v82
    v_and_b32 v29, s60, v82
    v_lshlrev_b32 v30, 16, v83
    v_and_b32 v31, s60, v83
    v_mul_f32 v24, v24, v16
    v_mul_f32 v25, v25, v17
    v_mul_f32 v26, v26, v18
    v_mul_f32 v27, v27, v19
    v_mul_f32 v28, v28, v20
    v_mul_f32 v29, v29, v21
    v_mul_f32 v30, v30, v22
    v_mul_f32 v31, v31, v23
    v_cvt_pk_bf16_f32 v80, v24, v25
    v_cvt_pk_bf16_f32 v81, v26, v27
    v_cvt_pk_bf16_f32 v82, v28, v29
    v_cvt_pk_bf16_f32 v83, v30, v31
    ds_write2st64_b64 v4, v[80:81], v[82:83] offset0:56 offset1:57
    s_waitcnt vmcnt(2)
    v_lshlrev_b32 v24, 16, v84
    v_and_b32 v25, s60, v84
    v_lshlrev_b32 v26, 16, v85
    v_and_b32 v27, s60, v85
    v_lshlrev_b32 v28, 16, v86
    v_and_b32 v29, s60, v86
    v_lshlrev_b32 v30, 16, v87
    v_and_b32 v31, s60, v87
    v_mul_f32 v24, v24, v16
    v_mul_f32 v25, v25, v17
    v_mul_f32 v26, v26, v18
    v_mul_f32 v27, v27, v19
    v_mul_f32 v28, v28, v20
    v_mul_f32 v29, v29, v21
    v_mul_f32 v30, v30, v22
    v_mul_f32 v31, v31, v23
    v_cvt_pk_bf16_f32 v84, v24, v25
    v_cvt_pk_bf16_f32 v85, v26, v27
    v_cvt_pk_bf16_f32 v86, v28, v29
    v_cvt_pk_bf16_f32 v87, v30, v31
    ds_write2st64_b64 v0, v[84:85], v[86:87] offset0:56 offset1:57
    s_waitcnt vmcnt(1)
    v_lshlrev_b32 v24, 16, v88
    v_and_b32 v25, s60, v88
    v_lshlrev_b32 v26, 16, v89
    v_and_b32 v27, s60, v89
    v_lshlrev_b32 v28, 16, v90
    v_and_b32 v29, s60, v90
    v_lshlrev_b32 v30, 16, v91
    v_and_b32 v31, s60, v91
    v_mul_f32 v24, v24, v16
    v_mul_f32 v25, v25, v17
    v_mul_f32 v26, v26, v18
    v_mul_f32 v27, v27, v19
    v_mul_f32 v28, v28, v20
    v_mul_f32 v29, v29, v21
    v_mul_f32 v30, v30, v22
    v_mul_f32 v31, v31, v23
    v_cvt_pk_bf16_f32 v88, v24, v25
    v_cvt_pk_bf16_f32 v89, v26, v27
    v_cvt_pk_bf16_f32 v90, v28, v29
    v_cvt_pk_bf16_f32 v91, v30, v31
    ds_write2st64_b64 v4, v[88:89], v[90:91] offset0:60 offset1:61
    s_waitcnt vmcnt(0)
    v_lshlrev_b32 v24, 16, v92
    v_and_b32 v25, s60, v92
    v_lshlrev_b32 v26, 16, v93
    v_and_b32 v27, s60, v93
    v_lshlrev_b32 v28, 16, v94
    v_and_b32 v29, s60, v94
    v_lshlrev_b32 v30, 16, v95
    v_and_b32 v31, s60, v95
    v_mul_f32 v24, v24, v16
    v_mul_f32 v25, v25, v17
    v_mul_f32 v26, v26, v18
    v_mul_f32 v27, v27, v19
    v_mul_f32 v28, v28, v20
    v_mul_f32 v29, v29, v21
    v_mul_f32 v30, v30, v22
    v_mul_f32 v31, v31, v23
    v_cvt_pk_bf16_f32 v92, v24, v25
    v_cvt_pk_bf16_f32 v93, v26, v27
    v_cvt_pk_bf16_f32 v94, v28, v29
    v_cvt_pk_bf16_f32 v95, v30, v31
    ds_write2st64_b64 v0, v[92:93], v[94:95] offset0:60 offset1:61
    v_mov_b32 v7, 8
    ds_write_b32 v6, v7
    s_add_u32 s20, s4, 11522048
    s_addc_u32 s21, s5, 0
    s_and_b32 s21, s21, 0xffff
    s_mov_b32 s22, 3538944
    s_mov_b32 s23, 0x20000
    s_add_u32 s28, s4, 18616320
    s_addc_u32 s29, s5, 0
    s_and_b32 s29, s29, 0xffff
    s_mov_b32 s30, 3538944
    s_mov_b32 s31, 0x20000
    s_mov_b32 s32, s36
    s_and_b32 s33, s37, 0xffff
    s_mov_b32 s34, 4100
    s_mov_b32 s35, 0x20000
    s_and_b32 s38, s24, 1
    s_sub_u32 s69, 4, s38
    s_add_u32 s39, s24, s69
    s_lshr_b32 s40, s39, 1
    s_lshl_b32 s40, s40, 7
    s_lshl_b32 s39, s25, 2
    s_add_u32 s40, s40, s39
    s_add_u32 s40, s40, s26
    s_lshl_b32 s64, s40, 10
    s_add_u32 s65, s64, 131072
    s_mov_b32 s66, 0
    s_xor_b32 s67, s38, 1
    buffer_load_dwordx4 v[36:39], v2, s[20:23], s64 offen
    buffer_load_dwordx4 v[40:43], v2, s[20:23], s65 offen
    v_and_b32 v45, 15, v1
    v_lshlrev_b32 v45, 1, v45
    s_lshl_b32 s38, s25, 7
    s_lshl_b32 s40, s26, 5
    s_add_u32 s68, s38, s40
    buffer_load_ushort v44, v45, s[32:35], s68 offen
    s_waitcnt lgkmcnt(0)
    s_barrier
    s_lshl_b32 s39, s69, 10
    s_sub_u32 s38, s26, 0
    s_and_b32 s38, s38, 3
    s_mul_i32 s38, s38, 36096
    v_add_u32 v20, s38, v2
    s_add_u32 s38, s38, s39
    v_add_u32 v21, s38, v2
    ds_read_b32 v112, v20 offset:8192
    ds_read_b128 v[48:51], v21 offset:1024
    ds_read_b128 v[52:55], v21 offset:2048
    ds_read_b128 v[56:59], v21 offset:3072
    ds_read_b128 v[60:63], v21 offset:4096
    s_sub_u32 s38, s26, 1
    s_and_b32 s38, s38, 3
    s_mul_i32 s38, s38, 36096
    v_add_u32 v22, s38, v2
    s_add_u32 s38, s38, s39
    v_add_u32 v23, s38, v2
    ds_read_b32 v113, v22 offset:16384
    ds_read_b128 v[64:67], v23 offset:9216
    ds_read_b128 v[68:71], v23 offset:10240
    ds_read_b128 v[72:75], v23 offset:11264
    ds_read_b128 v[76:79], v23 offset:12288
    s_sub_u32 s38, s26, 2
    s_and_b32 s38, s38, 3
    s_mul_i32 s38, s38, 36096
    v_add_u32 v20, s38, v2
    s_add_u32 s38, s38, s39
    v_add_u32 v21, s38, v2
    ds_read_b32 v114, v20 offset:24576
    ds_read_b128 v[80:83], v21 offset:17408
    ds_read_b128 v[84:87], v21 offset:18432
    ds_read_b128 v[88:91], v21 offset:19456
    ds_read_b128 v[92:95], v21 offset:20480
    s_sub_u32 s38, s26, 3
    s_and_b32 s38, s38, 3
    s_mul_i32 s38, s38, 36096
    v_add_u32 v22, s38, v2
    s_add_u32 s38, s38, s39
    v_add_u32 v23, s38, v2
    ds_read_b32 v115, v22 offset:32768
    ds_read_b128 v[96:99], v23 offset:25600
    ds_read_b128 v[100:103], v23 offset:26624
    ds_read_b128 v[104:107], v23 offset:27648
    ds_read_b128 v[108:111], v23 offset:28672
    s_waitcnt lgkmcnt(14)
    v_add_f32 v112, v112, v113
    s_waitcnt lgkmcnt(4)
    v_add_f32 v114, v114, v115
    v_add_f32 v112, v112, v114
    s_waitcnt vmcnt(0)
    v_lshlrev_b32 v44, 16, v44
    v_sub_f32 v112, v44, v112
    v_pk_add_f32 v[48:49], v[48:49], v[64:65]
    s_waitcnt lgkmcnt(3)
    v_pk_add_f32 v[80:81], v[80:81], v[96:97]
    v_pk_add_f32 v[50:51], v[50:51], v[66:67]
    v_pk_add_f32 v[82:83], v[82:83], v[98:99]
    v_lshlrev_b32 v120, 16, v36
    v_and_b32 v121, s60, v36
    v_lshlrev_b32 v122, 16, v37
    v_and_b32 v123, s60, v37
    v_pk_add_f32 v[48:49], v[48:49], v[112:113] op_sel_hi:[1,0]
    v_pk_add_f32 v[50:51], v[50:51], v[112:113] op_sel_hi:[1,0]
    v_pk_add_f32 v[48:49], v[48:49], v[80:81]
    v_pk_add_f32 v[50:51], v[50:51], v[82:83]
    v_pk_mul_f32 v[120:121], v[120:121], v[48:49]
    v_pk_mul_f32 v[122:123], v[122:123], v[50:51]
    v_cvt_pk_bf16_f32 v24, v120, v121
    v_cvt_pk_bf16_f32 v25, v122, v123
    v_pk_add_f32 v[52:53], v[52:53], v[68:69]
    s_waitcnt lgkmcnt(2)
    v_pk_add_f32 v[84:85], v[84:85], v[100:101]
    v_pk_add_f32 v[54:55], v[54:55], v[70:71]
    v_pk_add_f32 v[86:87], v[86:87], v[102:103]
    v_lshlrev_b32 v120, 16, v38
    v_and_b32 v121, s60, v38
    v_lshlrev_b32 v122, 16, v39
    v_and_b32 v123, s60, v39
    v_pk_add_f32 v[52:53], v[52:53], v[112:113] op_sel_hi:[1,0]
    v_pk_add_f32 v[54:55], v[54:55], v[112:113] op_sel_hi:[1,0]
    v_pk_add_f32 v[52:53], v[52:53], v[84:85]
    v_pk_add_f32 v[54:55], v[54:55], v[86:87]
    v_pk_mul_f32 v[120:121], v[120:121], v[52:53]
    v_pk_mul_f32 v[122:123], v[122:123], v[54:55]
    v_cvt_pk_bf16_f32 v26, v120, v121
    v_cvt_pk_bf16_f32 v27, v122, v123
    buffer_store_dwordx4 v[24:27], v2, s[28:31], s64 offen
    v_pk_add_f32 v[56:57], v[56:57], v[72:73]
    s_waitcnt lgkmcnt(1)
    v_pk_add_f32 v[88:89], v[88:89], v[104:105]
    v_pk_add_f32 v[58:59], v[58:59], v[74:75]
    v_pk_add_f32 v[90:91], v[90:91], v[106:107]
    v_lshlrev_b32 v120, 16, v40
    v_and_b32 v121, s60, v40
    v_lshlrev_b32 v122, 16, v41
    v_and_b32 v123, s60, v41
    v_pk_add_f32 v[56:57], v[56:57], v[112:113] op_sel_hi:[1,0]
    v_pk_add_f32 v[58:59], v[58:59], v[112:113] op_sel_hi:[1,0]
    v_pk_add_f32 v[56:57], v[56:57], v[88:89]
    v_pk_add_f32 v[58:59], v[58:59], v[90:91]
    v_pk_mul_f32 v[120:121], v[120:121], v[56:57]
    v_pk_mul_f32 v[122:123], v[122:123], v[58:59]
    v_cvt_pk_bf16_f32 v28, v120, v121
    v_cvt_pk_bf16_f32 v29, v122, v123
    v_pk_add_f32 v[60:61], v[60:61], v[76:77]
    s_waitcnt lgkmcnt(0)
    v_pk_add_f32 v[92:93], v[92:93], v[108:109]
    v_pk_add_f32 v[62:63], v[62:63], v[78:79]
    v_pk_add_f32 v[94:95], v[94:95], v[110:111]
    v_lshlrev_b32 v120, 16, v42
    v_and_b32 v121, s60, v42
    v_lshlrev_b32 v122, 16, v43
    v_and_b32 v123, s60, v43
    v_pk_add_f32 v[60:61], v[60:61], v[112:113] op_sel_hi:[1,0]
    v_pk_add_f32 v[62:63], v[62:63], v[112:113] op_sel_hi:[1,0]
    v_pk_add_f32 v[60:61], v[60:61], v[92:93]
    v_pk_add_f32 v[62:63], v[62:63], v[94:95]
    v_pk_mul_f32 v[120:121], v[120:121], v[60:61]
    v_pk_mul_f32 v[122:123], v[122:123], v[62:63]
    v_cvt_pk_bf16_f32 v30, v120, v121
    v_cvt_pk_bf16_f32 v31, v122, v123
    s_cmp_lg_u32 s67, 0
    s_cbranch_scc1 k3_gemm2_kernel_sth27
    buffer_store_dwordx4 v[28:31], v2, s[28:31], s65 offen
    s_branch k3_gemm2_kernel_ste28
k3_gemm2_kernel_sth27:
    buffer_store_dwordx2 v[28:29], v2, s[28:31], s65 offen
k3_gemm2_kernel_ste28:
    s_endpgm
k3_exit:
    s_nop 7
    s_nop 7
    s_endpgm

.globl k4_gemm3_kernel
.p2align 8
.type k4_gemm3_kernel,@function
k4_gemm3_kernel:
    s_cmp_ge_u32 s2, 256
    s_cbranch_scc1 k4_exit
    s_load_dwordx2 s[4:5], s[0:1], 144
    s_load_dwordx2 s[6:7], s[0:1], 128
    s_and_b32 s3, s2, 7
    s_lshr_b32 s38, s2, 3
    s_and_b32 s24, s3, 1
    s_lshl_b32 s24, s24, 2
    s_and_b32 s40, s38, 3
    s_add_u32 s24, s24, s40
    s_lshr_b32 s25, s3, 1
    s_lshl_b32 s25, s25, 3
    s_lshr_b32 s38, s38, 2
    s_add_u32 s25, s25, s38
    v_lshrrev_b32 v1, 6, v0
    s_nop 0
    v_readfirstlane_b32 s26, v1
    s_waitcnt lgkmcnt(0)
    s_add_u32 s8, s4, 5525504
    s_addc_u32 s9, s5, 0
    s_and_b32 s9, s9, 0xffff
    s_mov_b32 s10, 1105920
    s_mov_b32 s11, 0x20000
    s_add_u32 s12, s4, 18616320
    s_addc_u32 s13, s5, 0
    s_and_b32 s13, s13, 0xffff
    s_mov_b32 s14, 3538944
    s_mov_b32 s15, 0x20000
    s_add_u32 s16, s4, 8900608
    s_addc_u32 s17, s5, 0
    s_and_b32 s17, s17, 0xffff
    s_mov_b32 s18, 2621440
    s_mov_b32 s19, 0x20000
    s_add_u32 s20, s4, 5279744
    s_addc_u32 s21, s5, 0
    s_and_b32 s21, s21, 0xffff
    s_mov_b32 s22, 245760
    s_mov_b32 s23, 0x20000
    s_mov_b32 s28, s6
    s_and_b32 s29, s7, 0xffff
    s_mov_b32 s30, 2621440
    s_mov_b32 s31, 0x20000
    v_and_b32 v14, 63, v0
    v_lshlrev_b32 v1, 4, v14
    v_add_u32 v2, 4096, v1
    s_add_u32 s38, s26, 0
    s_and_b32 s38, s38, 3
    s_lshl_b32 s38, s38, 10
    v_add_u32 v4, s38, v1
    s_add_u32 s38, s26, 1
    s_and_b32 s38, s38, 3
    s_lshl_b32 s38, s38, 10
    v_add_u32 v5, s38, v1
    s_add_u32 s38, s26, 2
    s_and_b32 s38, s38, 3
    s_lshl_b32 s38, s38, 10
    v_add_u32 v6, s38, v1
    s_add_u32 s38, s26, 3
    s_and_b32 s38, s38, 3
    s_lshl_b32 s38, s38, 10
    v_add_u32 v7, s38, v1
    s_mul_i32 s32, s26, 286720
    s_mul_i32 s38, s24, 5120
    s_add_u32 s32, s32, s38
    s_mul_i32 s33, s26, 917504
    s_lshl_b32 s38, s25, 12
    s_add_u32 s33, s33, s38
    s_add_u32 s37, s33, 0
    buffer_load_dwordx4 a[20:23], v4, s[12:15], s37 offen
    buffer_load_dwordx4 a[24:27], v5, s[12:15], s37 offen
    buffer_load_dwordx4 a[28:31], v6, s[12:15], s37 offen
    buffer_load_dwordx4 a[32:35], v7, s[12:15], s37 offen
    s_add_u32 s39, s32, 0
    buffer_load_dwordx4 a[0:3], v1, s[8:11], s39 offen
    buffer_load_dwordx4 a[4:7], v1, s[8:11], s39 offen offset:1024
    buffer_load_dwordx4 a[8:11], v1, s[8:11], s39 offen offset:2048
    buffer_load_dwordx4 a[12:15], v1, s[8:11], s39 offen offset:3072
    buffer_load_dwordx4 a[16:19], v2, s[8:11], s39 offen
    s_add_u32 s37, s33, 131072
    buffer_load_dwordx4 a[56:59], v4, s[12:15], s37 offen
    buffer_load_dwordx4 a[60:63], v5, s[12:15], s37 offen
    buffer_load_dwordx4 a[64:67], v6, s[12:15], s37 offen
    buffer_load_dwordx4 a[68:71], v7, s[12:15], s37 offen
    s_add_u32 s39, s32, 40960
    buffer_load_dwordx4 a[36:39], v1, s[8:11], s39 offen
    buffer_load_dwordx4 a[40:43], v1, s[8:11], s39 offen offset:1024
    buffer_load_dwordx4 a[44:47], v1, s[8:11], s39 offen offset:2048
    buffer_load_dwordx4 a[48:51], v1, s[8:11], s39 offen offset:3072
    buffer_load_dwordx4 a[52:55], v2, s[8:11], s39 offen
    s_add_u32 s37, s33, 262144
    buffer_load_dwordx4 a[92:95], v4, s[12:15], s37 offen
    buffer_load_dwordx4 a[96:99], v5, s[12:15], s37 offen
    buffer_load_dwordx4 a[100:103], v6, s[12:15], s37 offen
    buffer_load_dwordx4 a[104:107], v7, s[12:15], s37 offen
    s_add_u32 s39, s32, 81920
    buffer_load_dwordx4 a[72:75], v1, s[8:11], s39 offen
    buffer_load_dwordx4 a[76:79], v1, s[8:11], s39 offen offset:1024
    buffer_load_dwordx4 a[80:83], v1, s[8:11], s39 offen offset:2048
    buffer_load_dwordx4 a[84:87], v1, s[8:11], s39 offen offset:3072
    buffer_load_dwordx4 a[88:91], v2, s[8:11], s39 offen
    v_min_u32 v3, 79, v0
    s_mul_i32 s38, s24, 80
    s_add_u32 s38, s38, 3200
    v_add_u32 v3, s38, v3
    v_lshlrev_b32 v3, 2, v3
    v_bfe_u32 v8, v0, 3, 3
    v_bfe_u32 v9, v0, 1, 2
    v_bfe_u32 v10, v0, 4, 2
    v_xor_b32 v9, v9, v10
    v_lshlrev_b32 v9, 5, v9
    v_and_b32 v10, 1, v0
    v_lshl_add_u32 v9, v10, 4, v9
    v_lshl_add_u32 v8, v8, 12, v9
    s_mul_i32 s34, s24, 327680
    s_lshl_b32 s38, s26, 15
    s_add_u32 s34, s34, s38
    s_lshl_b32 s38, s25, 7
    s_add_u32 s34, s34, s38
    s_lshl_b32 s35, s26, 10
    s_add_u32 s35, s35, 0
    s_mul_i32 s27, s26, 15360
    v_add_u32 v9, s27, v1
    v_bfe_u32 v10, v0, 4, 2
    v_bfe_u32 v11, v0, 2, 2
    v_lshl_add_u32 v11, v10, 2, v11
    v_bfe_u32 v12, v11, 1, 2
    v_xor_b32 v12, s26, v12
    v_lshlrev_b32 v12, 5, v12
    v_lshl_add_u32 v12, v11, 7, v12
    v_and_b32 v11, 3, v0
    v_lshl_add_u32 v12, v11, 3, v12
    v_lshlrev_b32 v13, 4, v10
    v_and_b32 v11, 15, v0
    v_mul_u32_u24 v11, 176, v11
    v_lshl_add_u32 v11, v10, 3, v11
    s_mul_i32 s38, s26, 2816
    s_add_u32 s38, s38, 74752
    v_add_u32 v11, s38, v11
    s_lshl_b32 s40, s25, 6
    s_lshl_b32 s41, s26, 4
    s_add_u32 s40, s40, s41
    v_add_u32 v15, 0, v14
    v_min_u32 v15, 159, v15
    v_mul_u32_u24 v191, 6554, v15
    v_lshrrev_b32 v191, 16, v191
    v_mul_u32_u24 v188, 10, v191
    v_sub_u32 v15, v15, v188
    v_mul_u32_u24 v188, 176, v191
    v_lshl_add_u32 v188, v15, 4, v188
    v_add_u32 v188, s38, v188
    v_add_u32 v191, s40, v191
    v_mul_u32_u24 v191, 1280, v191
    v_lshl_add_u32 v191, v15, 4, v191
    v_add_u32 v15, 64, v14
    v_min_u32 v15, 159, v15
    v_mul_u32_u24 v192, 6554, v15
    v_lshrrev_b32 v192, 16, v192
    v_mul_u32_u24 v189, 10, v192
    v_sub_u32 v15, v15, v189
    v_mul_u32_u24 v189, 176, v192
    v_lshl_add_u32 v189, v15, 4, v189
    v_add_u32 v189, s38, v189
    v_add_u32 v192, s40, v192
    v_mul_u32_u24 v192, 1280, v192
    v_lshl_add_u32 v192, v15, 4, v192
    v_add_u32 v15, 128, v14
    v_min_u32 v15, 159, v15
    v_mul_u32_u24 v193, 6554, v15
    v_lshrrev_b32 v193, 16, v193
    v_mul_u32_u24 v190, 10, v193
    v_sub_u32 v15, v15, v190
    v_mul_u32_u24 v190, 176, v193
    v_lshl_add_u32 v190, v15, 4, v190
    v_add_u32 v190, s38, v190
    v_add_u32 v193, s40, v193
    v_mul_u32_u24 v193, 1280, v193
    v_lshl_add_u32 v193, v15, 4, v193
    s_mul_i32 s36, s24, 160
    s_waitcnt vmcnt(22)
    v_mfma_f32_16x16x32_bf16 v[16:19], a[0:3], a[20:23], 0
    v_mfma_f32_16x16x32_bf16 v[20:23], a[0:3], a[24:27], 0
    v_mfma_f32_16x16x32_bf16 v[24:27], a[0:3], a[28:31], 0
    s_add_u32 s37, s33, 393216
    buffer_load_dwordx4 a[128:131], v4, s[12:15], s37 offen
    v_mfma_f32_16x16x32_bf16 v[28:31], a[0:3], a[32:35], 0
    s_waitcnt vmcnt(22)
    v_mfma_f32_16x16x32_bf16 v[32:35], a[4:7], a[20:23], 0
    buffer_load_dwordx4 a[132:135], v5, s[12:15], s37 offen
    v_mfma_f32_16x16x32_bf16 v[36:39], a[4:7], a[24:27], 0
    v_mfma_f32_16x16x32_bf16 v[40:43], a[4:7], a[28:31], 0
    buffer_load_dwordx4 a[136:139], v6, s[12:15], s37 offen
    v_mfma_f32_16x16x32_bf16 v[44:47], a[4:7], a[32:35], 0
    s_waitcnt vmcnt(23)
    v_mfma_f32_16x16x32_bf16 v[48:51], a[8:11], a[20:23], 0
    buffer_load_dwordx4 a[140:143], v7, s[12:15], s37 offen
    v_mfma_f32_16x16x32_bf16 v[52:55], a[8:11], a[24:27], 0
    v_mfma_f32_16x16x32_bf16 v[56:59], a[8:11], a[28:31], 0
    v_mfma_f32_16x16x32_bf16 v[60:63], a[8:11], a[32:35], 0
    s_add_u32 s39, s32, 122880
    buffer_load_dwordx4 a[108:111], v1, s[8:11], s39 offen
    s_waitcnt vmcnt(24)
    v_mfma_f32_16x16x32_bf16 v[64:67], a[12:15], a[20:23], 0
    v_mfma_f32_16x16x32_bf16 v[68:71], a[12:15], a[24:27], 0
    buffer_load_dwordx4 a[112:115], v1, s[8:11], s39 offen offset:1024
    v_mfma_f32_16x16x32_bf16 v[72:75], a[12:15], a[28:31], 0
    v_mfma_f32_16x16x32_bf16 v[76:79], a[12:15], a[32:35], 0
    buffer_load_dwordx4 a[116:119], v1, s[8:11], s39 offen offset:2048
    s_waitcnt vmcnt(25)
    v_mfma_f32_16x16x32_bf16 v[80:83], a[16:19], a[20:23], 0
    v_mfma_f32_16x16x32_bf16 v[84:87], a[16:19], a[24:27], 0
    buffer_load_dwordx4 a[120:123], v1, s[8:11], s39 offen offset:3072
    v_mfma_f32_16x16x32_bf16 v[88:91], a[16:19], a[28:31], 0
    v_mfma_f32_16x16x32_bf16 v[92:95], a[16:19], a[32:35], 0
    buffer_load_dwordx4 a[124:127], v2, s[8:11], s39 offen
    s_waitcnt vmcnt(22)
    v_mfma_f32_16x16x32_bf16 v[16:19], a[36:39], a[56:59], v[16:19]
    v_mfma_f32_16x16x32_bf16 v[20:23], a[36:39], a[60:63], v[20:23]
    v_mfma_f32_16x16x32_bf16 v[24:27], a[36:39], a[64:67], v[24:27]
    s_add_u32 s37, s33, 524288
    buffer_load_dwordx4 a[164:167], v4, s[12:15], s37 offen
    v_mfma_f32_16x16x32_bf16 v[28:31], a[36:39], a[68:71], v[28:31]
    s_waitcnt vmcnt(22)
    v_mfma_f32_16x16x32_bf16 v[32:35], a[40:43], a[56:59], v[32:35]
    buffer_load_dwordx4 a[168:171], v5, s[12:15], s37 offen
    v_mfma_f32_16x16x32_bf16 v[36:39], a[40:43], a[60:63], v[36:39]
    v_mfma_f32_16x16x32_bf16 v[40:43], a[40:43], a[64:67], v[40:43]
    buffer_load_dwordx4 a[172:175], v6, s[12:15], s37 offen
    v_mfma_f32_16x16x32_bf16 v[44:47], a[40:43], a[68:71], v[44:47]
    s_waitcnt vmcnt(23)
    v_mfma_f32_16x16x32_bf16 v[48:51], a[44:47], a[56:59], v[48:51]
    buffer_load_dwordx4 a[176:179], v7, s[12:15], s37 offen
    v_mfma_f32_16x16x32_bf16 v[52:55], a[44:47], a[60:63], v[52:55]
    v_mfma_f32_16x16x32_bf16 v[56:59], a[44:47], a[64:67], v[56:59]
    v_mfma_f32_16x16x32_bf16 v[60:63], a[44:47], a[68:71], v[60:63]
    s_add_u32 s39, s32, 163840
    buffer_load_dwordx4 a[144:147], v1, s[8:11], s39 offen
    s_waitcnt vmcnt(24)
    v_mfma_f32_16x16x32_bf16 v[64:67], a[48:51], a[56:59], v[64:67]
    v_mfma_f32_16x16x32_bf16 v[68:71], a[48:51], a[60:63], v[68:71]
    buffer_load_dwordx4 a[148:151], v1, s[8:11], s39 offen offset:1024
    v_mfma_f32_16x16x32_bf16 v[72:75], a[48:51], a[64:67], v[72:75]
    v_mfma_f32_16x16x32_bf16 v[76:79], a[48:51], a[68:71], v[76:79]
    buffer_load_dwordx4 a[152:155], v1, s[8:11], s39 offen offset:2048
    s_waitcnt vmcnt(25)
    v_mfma_f32_16x16x32_bf16 v[80:83], a[52:55], a[56:59], v[80:83]
    v_mfma_f32_16x16x32_bf16 v[84:87], a[52:55], a[60:63], v[84:87]
    buffer_load_dwordx4 a[156:159], v1, s[8:11], s39 offen offset:3072
    v_mfma_f32_16x16x32_bf16 v[88:91], a[52:55], a[64:67], v[88:91]
    v_mfma_f32_16x16x32_bf16 v[92:95], a[52:55], a[68:71], v[92:95]
    buffer_load_dwordx4 a[160:163], v2, s[8:11], s39 offen
    s_waitcnt vmcnt(22)
    v_mfma_f32_16x16x32_bf16 v[16:19], a[72:75], a[92:95], v[16:19]
    v_mfma_f32_16x16x32_bf16 v[20:23], a[72:75], a[96:99], v[20:23]
    v_mfma_f32_16x16x32_bf16 v[24:27], a[72:75], a[100:103], v[24:27]
    s_add_u32 s37, s33, 655360
    buffer_load_dwordx4 a[200:203], v4, s[12:15], s37 offen
    v_mfma_f32_16x16x32_bf16 v[28:31], a[72:75], a[104:107], v[28:31]
    s_waitcnt vmcnt(22)
    v_mfma_f32_16x16x32_bf16 v[32:35], a[76:79], a[92:95], v[32:35]
    buffer_load_dwordx4 a[204:207], v5, s[12:15], s37 offen
    v_mfma_f32_16x16x32_bf16 v[36:39], a[76:79], a[96:99], v[36:39]
    v_mfma_f32_16x16x32_bf16 v[40:43], a[76:79], a[100:103], v[40:43]
    buffer_load_dwordx4 a[208:211], v6, s[12:15], s37 offen
    v_mfma_f32_16x16x32_bf16 v[44:47], a[76:79], a[104:107], v[44:47]
    s_waitcnt vmcnt(23)
    v_mfma_f32_16x16x32_bf16 v[48:51], a[80:83], a[92:95], v[48:51]
    buffer_load_dwordx4 a[212:215], v7, s[12:15], s37 offen
    v_mfma_f32_16x16x32_bf16 v[52:55], a[80:83], a[96:99], v[52:55]
    v_mfma_f32_16x16x32_bf16 v[56:59], a[80:83], a[100:103], v[56:59]
    v_mfma_f32_16x16x32_bf16 v[60:63], a[80:83], a[104:107], v[60:63]
    s_add_u32 s39, s32, 204800
    buffer_load_dwordx4 a[180:183], v1, s[8:11], s39 offen
    s_waitcnt vmcnt(24)
    v_mfma_f32_16x16x32_bf16 v[64:67], a[84:87], a[92:95], v[64:67]
    v_mfma_f32_16x16x32_bf16 v[68:71], a[84:87], a[96:99], v[68:71]
    buffer_load_dwordx4 a[184:187], v1, s[8:11], s39 offen offset:1024
    v_mfma_f32_16x16x32_bf16 v[72:75], a[84:87], a[100:103], v[72:75]
    v_mfma_f32_16x16x32_bf16 v[76:79], a[84:87], a[104:107], v[76:79]
    buffer_load_dwordx4 a[188:191], v1, s[8:11], s39 offen offset:2048
    s_waitcnt vmcnt(25)
    v_mfma_f32_16x16x32_bf16 v[80:83], a[88:91], a[92:95], v[80:83]
    v_mfma_f32_16x16x32_bf16 v[84:87], a[88:91], a[96:99], v[84:87]
    buffer_load_dwordx4 a[192:195], v1, s[8:11], s39 offen offset:3072
    v_mfma_f32_16x16x32_bf16 v[88:91], a[88:91], a[100:103], v[88:91]
    v_mfma_f32_16x16x32_bf16 v[92:95], a[88:91], a[104:107], v[92:95]
    buffer_load_dwordx4 a[196:199], v2, s[8:11], s39 offen
    s_waitcnt vmcnt(22)
    v_mfma_f32_16x16x32_bf16 v[16:19], a[108:111], a[128:131], v[16:19]
    v_mfma_f32_16x16x32_bf16 v[20:23], a[108:111], a[132:135], v[20:23]
    v_mfma_f32_16x16x32_bf16 v[24:27], a[108:111], a[136:139], v[24:27]
    s_add_u32 s37, s33, 786432
    buffer_load_dwordx4 a[236:239], v4, s[12:15], s37 offen
    v_mfma_f32_16x16x32_bf16 v[28:31], a[108:111], a[140:143], v[28:31]
    s_waitcnt vmcnt(22)
    v_mfma_f32_16x16x32_bf16 v[32:35], a[112:115], a[128:131], v[32:35]
    buffer_load_dwordx4 a[240:243], v5, s[12:15], s37 offen
    v_mfma_f32_16x16x32_bf16 v[36:39], a[112:115], a[132:135], v[36:39]
    v_mfma_f32_16x16x32_bf16 v[40:43], a[112:115], a[136:139], v[40:43]
    buffer_load_dwordx4 a[244:247], v6, s[12:15], s37 offen
    v_mfma_f32_16x16x32_bf16 v[44:47], a[112:115], a[140:143], v[44:47]
    s_waitcnt vmcnt(23)
    v_mfma_f32_16x16x32_bf16 v[48:51], a[116:119], a[128:131], v[48:51]
    buffer_load_dwordx4 a[248:251], v7, s[12:15], s37 offen
    v_mfma_f32_16x16x32_bf16 v[52:55], a[116:119], a[132:135], v[52:55]
    v_mfma_f32_16x16x32_bf16 v[56:59], a[116:119], a[136:139], v[56:59]
    v_mfma_f32_16x16x32_bf16 v[60:63], a[116:119], a[140:143], v[60:63]
    s_add_u32 s39, s32, 245760
    buffer_load_dwordx4 a[216:219], v1, s[8:11], s39 offen
    s_waitcnt vmcnt(24)
    v_mfma_f32_16x16x32_bf16 v[64:67], a[120:123], a[128:131], v[64:67]
    v_mfma_f32_16x16x32_bf16 v[68:71], a[120:123], a[132:135], v[68:71]
    buffer_load_dwordx4 a[220:223], v1, s[8:11], s39 offen offset:1024
    v_mfma_f32_16x16x32_bf16 v[72:75], a[120:123], a[136:139], v[72:75]
    v_mfma_f32_16x16x32_bf16 v[76:79], a[120:123], a[140:143], v[76:79]
    buffer_load_dwordx4 a[224:227], v1, s[8:11], s39 offen offset:2048
    s_waitcnt vmcnt(25)
    v_mfma_f32_16x16x32_bf16 v[80:83], a[124:127], a[128:131], v[80:83]
    v_mfma_f32_16x16x32_bf16 v[84:87], a[124:127], a[132:135], v[84:87]
    buffer_load_dwordx4 a[228:231], v1, s[8:11], s39 offen offset:3072
    v_mfma_f32_16x16x32_bf16 v[88:91], a[124:127], a[136:139], v[88:91]
    v_mfma_f32_16x16x32_bf16 v[92:95], a[124:127], a[140:143], v[92:95]
    buffer_load_dwordx4 a[232:235], v2, s[8:11], s39 offen
    s_waitcnt vmcnt(22)
    v_mfma_f32_16x16x32_bf16 v[16:19], a[144:147], a[164:167], v[16:19]
    v_mfma_f32_16x16x32_bf16 v[20:23], a[144:147], a[168:171], v[20:23]
    v_mfma_f32_16x16x32_bf16 v[24:27], a[144:147], a[172:175], v[24:27]
    v_mfma_f32_16x16x32_bf16 v[28:31], a[144:147], a[176:179], v[28:31]
    s_waitcnt vmcnt(21)
    v_mfma_f32_16x16x32_bf16 v[32:35], a[148:151], a[164:167], v[32:35]
    v_cmp_gt_u32 vcc, 80, v0
    s_nop 0
    s_and_saveexec_b64 s[42:43], vcc
    s_mov_b32 s38, 0
    buffer_load_dword v96, v3, s[20:23], s38 offen
    s_mov_b32 s38, 15360
    buffer_load_dword v97, v3, s[20:23], s38 offen
    s_mov_b32 s38, 30720
    buffer_load_dword v98, v3, s[20:23], s38 offen
    s_mov_b32 s38, 46080
    buffer_load_dword v99, v3, s[20:23], s38 offen
    s_mov_b32 s38, 61440
    buffer_load_dword v100, v3, s[20:23], s38 offen
    s_mov_b32 s38, 76800
    buffer_load_dword v101, v3, s[20:23], s38 offen
    s_mov_b32 s38, 92160
    buffer_load_dword v102, v3, s[20:23], s38 offen
    s_mov_b32 s38, 107520
    buffer_load_dword v103, v3, s[20:23], s38 offen
    s_mov_b32 s38, 122880
    buffer_load_dword v104, v3, s[20:23], s38 offen
    s_mov_b32 s38, 138240
    buffer_load_dword v105, v3, s[20:23], s38 offen
    s_mov_b32 s38, 153600
    buffer_load_dword v106, v3, s[20:23], s38 offen
    s_mov_b32 s38, 168960
    buffer_load_dword v107, v3, s[20:23], s38 offen
    s_mov_b32 s38, 184320
    buffer_load_dword v108, v3, s[20:23], s38 offen
    s_mov_b32 s38, 199680
    buffer_load_dword v109, v3, s[20:23], s38 offen
    s_mov_b32 s38, 215040
    buffer_load_dword v110, v3, s[20:23], s38 offen
    s_mov_b32 s38, 230400
    buffer_load_dword v111, v3, s[20:23], s38 offen
    s_mov_b64 exec, s[42:43]
    v_mfma_f32_16x16x32_bf16 v[36:39], a[148:151], a[168:171], v[36:39]
    v_mfma_f32_16x16x32_bf16 v[40:43], a[148:151], a[172:175], v[40:43]
    v_mfma_f32_16x16x32_bf16 v[44:47], a[148:151], a[176:179], v[44:47]
    s_waitcnt vmcnt(36)
    v_mfma_f32_16x16x32_bf16 v[48:51], a[152:155], a[164:167], v[48:51]
    v_mfma_f32_16x16x32_bf16 v[52:55], a[152:155], a[168:171], v[52:55]
    s_add_u32 m0, s35, 0
    s_add_u32 s38, s34, 0
    buffer_load_dwordx4 v8, s[16:19], s38 offen lds
    v_mfma_f32_16x16x32_bf16 v[56:59], a[152:155], a[172:175], v[56:59]
    v_mfma_f32_16x16x32_bf16 v[60:63], a[152:155], a[176:179], v[60:63]
    s_waitcnt vmcnt(36)
    v_mfma_f32_16x16x32_bf16 v[64:67], a[156:159], a[164:167], v[64:67]
    v_mfma_f32_16x16x32_bf16 v[68:71], a[156:159], a[168:171], v[68:71]
    v_mfma_f32_16x16x32_bf16 v[72:75], a[156:159], a[172:175], v[72:75]
    s_add_u32 m0, s35, 4096
    s_add_u32 s38, s34, 131072
    buffer_load_dwordx4 v8, s[16:19], s38 offen lds
    v_mfma_f32_16x16x32_bf16 v[76:79], a[156:159], a[176:179], v[76:79]
    s_waitcnt vmcnt(36)
    v_mfma_f32_16x16x32_bf16 v[80:83], a[160:163], a[164:167], v[80:83]
    v_mfma_f32_16x16x32_bf16 v[84:87], a[160:163], a[168:171], v[84:87]
    v_mfma_f32_16x16x32_bf16 v[88:91], a[160:163], a[172:175], v[88:91]
    v_mfma_f32_16x16x32_bf16 v[92:95], a[160:163], a[176:179], v[92:95]
    s_add_u32 m0, s35, 8192
    s_add_u32 s38, s34, 262144
    buffer_load_dwordx4 v8, s[16:19], s38 offen lds
    s_waitcnt vmcnt(32)
    v_mfma_f32_16x16x32_bf16 v[16:19], a[180:183], a[200:203], v[16:19]
    v_mfma_f32_16x16x32_bf16 v[20:23], a[180:183], a[204:207], v[20:23]
    v_mfma_f32_16x16x32_bf16 v[24:27], a[180:183], a[208:211], v[24:27]
    v_mfma_f32_16x16x32_bf16 v[28:31], a[180:183], a[212:215], v[28:31]
    s_waitcnt vmcnt(31)
    v_mfma_f32_16x16x32_bf16 v[32:35], a[184:187], a[200:203], v[32:35]
    v_mfma_f32_16x16x32_bf16 v[36:39], a[184:187], a[204:207], v[36:39]
    v_mfma_f32_16x16x32_bf16 v[40:43], a[184:187], a[208:211], v[40:43]
    v_mfma_f32_16x16x32_bf16 v[44:47], a[184:187], a[212:215], v[44:47]
    s_waitcnt vmcnt(30)
    v_mfma_f32_16x16x32_bf16 v[48:51], a[188:191], a[200:203], v[48:51]
    v_mfma_f32_16x16x32_bf16 v[52:55], a[188:191], a[204:207], v[52:55]
    v_mfma_f32_16x16x32_bf16 v[56:59], a[188:191], a[208:211], v[56:59]
    v_mfma_f32_16x16x32_bf16 v[60:63], a[188:191], a[212:215], v[60:63]
    s_waitcnt vmcnt(29)
    v_mfma_f32_16x16x32_bf16 v[64:67], a[192:195], a[200:203], v[64:67]
    v_mfma_f32_16x16x32_bf16 v[68:71], a[192:195], a[204:207], v[68:71]
    v_mfma_f32_16x16x32_bf16 v[72:75], a[192:195], a[208:211], v[72:75]
    v_mfma_f32_16x16x32_bf16 v[76:79], a[192:195], a[212:215], v[76:79]
    s_waitcnt vmcnt(28)
    v_mfma_f32_16x16x32_bf16 v[80:83], a[196:199], a[200:203], v[80:83]
    v_mfma_f32_16x16x32_bf16 v[84:87], a[196:199], a[204:207], v[84:87]
    v_mfma_f32_16x16x32_bf16 v[88:91], a[196:199], a[208:211], v[88:91]
    v_mfma_f32_16x16x32_bf16 v[92:95], a[196:199], a[212:215], v[92:95]
    s_waitcnt vmcnt(17)
    v_add_f32 v96, v96, v97
    s_waitcnt vmcnt(16)
    v_add_f32 v96, v96, v98
    s_waitcnt vmcnt(15)
    v_add_f32 v96, v96, v99
    s_waitcnt vmcnt(14)
    v_add_f32 v96, v96, v100
    s_waitcnt vmcnt(13)
    v_add_f32 v96, v96, v101
    s_waitcnt vmcnt(12)
    v_add_f32 v96, v96, v102
    s_waitcnt vmcnt(11)
    v_add_f32 v96, v96, v103
    s_waitcnt vmcnt(10)
    v_add_f32 v96, v96, v104
    s_waitcnt vmcnt(9)
    v_add_f32 v96, v96, v105
    s_waitcnt vmcnt(8)
    v_add_f32 v96, v96, v106
    s_waitcnt vmcnt(7)
    v_add_f32 v96, v96, v107
    s_waitcnt vmcnt(6)
    v_add_f32 v96, v96, v108
    s_waitcnt vmcnt(5)
    v_add_f32 v96, v96, v109
    s_waitcnt vmcnt(4)
    v_add_f32 v96, v96, v110
    s_waitcnt vmcnt(3)
    v_add_f32 v96, v96, v111
    v_cvt_pk_bf16_f32 v96, v96, v96
    v_lshlrev_b32 v96, 16, v96
    v_min_u32 v3, 127, v0
    v_lshlrev_b32 v3, 2, v3
    ds_write_b32 v3, v96 offset:12288
    v_mfma_f32_16x16x32_bf16 v[20:23], a[216:219], a[240:243], v[20:23]
    v_mfma_f32_16x16x32_bf16 v[36:39], a[220:223], a[240:243], v[36:39]
    v_mfma_f32_16x16x32_bf16 v[52:55], a[224:227], a[240:243], v[52:55]
    v_mfma_f32_16x16x32_bf16 v[68:71], a[228:231], a[240:243], v[68:71]
    v_mfma_f32_16x16x32_bf16 v[84:87], a[232:235], a[240:243], v[84:87]
    v_mfma_f32_16x16x32_bf16 v[24:27], a[216:219], a[244:247], v[24:27]
    v_mfma_f32_16x16x32_bf16 v[40:43], a[220:223], a[244:247], v[40:43]
    s_nop 1
    ds_write_b128 v9, v[20:23] offset:13312
    v_mfma_f32_16x16x32_bf16 v[56:59], a[224:227], a[244:247], v[56:59]
    ds_write_b128 v9, v[36:39] offset:14336
    v_mfma_f32_16x16x32_bf16 v[72:75], a[228:231], a[244:247], v[72:75]
    ds_write_b128 v9, v[52:55] offset:15360
    v_mfma_f32_16x16x32_bf16 v[88:91], a[232:235], a[244:247], v[88:91]
    ds_write_b128 v9, v[68:71] offset:16384
    ds_write_b128 v9, v[84:87] offset:17408
    v_mfma_f32_16x16x32_bf16 v[28:31], a[216:219], a[248:251], v[28:31]
    v_mfma_f32_16x16x32_bf16 v[44:47], a[220:223], a[248:251], v[44:47]
    ds_write_b128 v9, v[24:27] offset:18432
    v_mfma_f32_16x16x32_bf16 v[60:63], a[224:227], a[248:251], v[60:63]
    ds_write_b128 v9, v[40:43] offset:19456
    v_mfma_f32_16x16x32_bf16 v[76:79], a[228:231], a[248:251], v[76:79]
    ds_write_b128 v9, v[56:59] offset:20480
    v_mfma_f32_16x16x32_bf16 v[92:95], a[232:235], a[248:251], v[92:95]
    ds_write_b128 v9, v[72:75] offset:21504
    ds_write_b128 v9, v[88:91] offset:22528
    v_mfma_f32_16x16x32_bf16 v[16:19], a[216:219], a[236:239], v[16:19]
    v_mfma_f32_16x16x32_bf16 v[32:35], a[220:223], a[236:239], v[32:35]
    ds_write_b128 v9, v[28:31] offset:23552
    v_mfma_f32_16x16x32_bf16 v[48:51], a[224:227], a[236:239], v[48:51]
    ds_write_b128 v9, v[44:47] offset:24576
    v_mfma_f32_16x16x32_bf16 v[64:67], a[228:231], a[236:239], v[64:67]
    ds_write_b128 v9, v[60:63] offset:25600
    v_mfma_f32_16x16x32_bf16 v[80:83], a[232:235], a[236:239], v[80:83]
    ds_write_b128 v9, v[76:79] offset:26624
    ds_write_b128 v9, v[92:95] offset:27648
    s_waitcnt vmcnt(0) lgkmcnt(0)
    s_sub_u32 s38, s26, 1
    s_and_b32 s38, s38, 3
    s_mul_i32 s38, s38, 15360
    v_add_u32 v8, s38, v1
    s_sub_u32 s38, s26, 2
    s_and_b32 s38, s38, 3
    s_mul_i32 s38, s38, 15360
    v_add_u32 v9, s38, v1
    s_sub_u32 s38, s26, 3
    s_and_b32 s38, s38, 3
    s_mul_i32 s38, s38, 15360
    v_add_u32 v10, s38, v1
    s_barrier
    ds_read_b128 v[96:99], v8 offset:13312
    ds_read_b128 v[116:119], v9 offset:18432
    ds_read_b128 v[136:139], v10 offset:23552
    ds_read_b64_tr_b16 v[156:157], v12 offset:0
    ds_read_b128 v[168:171], v13 offset:12288
    ds_read_b128 v[100:103], v8 offset:14336
    ds_read_b128 v[120:123], v9 offset:19456
    ds_read_b128 v[140:143], v10 offset:24576
    ds_read_b64_tr_b16 v[158:159], v12 offset:2048
    ds_read_b128 v[172:175], v13 offset:12352
    ds_read_b128 v[104:107], v8 offset:15360
    ds_read_b128 v[124:127], v9 offset:20480
    ds_read_b128 v[144:147], v10 offset:25600
    ds_read_b64_tr_b16 v[160:161], v12 offset:4096
    ds_read_b128 v[176:179], v13 offset:12416
    ds_read_b128 v[108:111], v8 offset:16384
    ds_read_b128 v[128:131], v9 offset:21504
    ds_read_b128 v[148:151], v10 offset:26624
    ds_read_b64_tr_b16 v[162:163], v12 offset:6144
    ds_read_b128 v[180:183], v13 offset:12480
    ds_read_b128 v[112:115], v8 offset:17408
    ds_read_b128 v[132:135], v9 offset:22528
    ds_read_b128 v[152:155], v10 offset:27648
    ds_read_b64_tr_b16 v[164:165], v12 offset:8192
    ds_read_b128 v[184:187], v13 offset:12544
    s_mov_b32 s40, 0xffff0000
    s_waitcnt lgkmcnt(15)
    v_pk_add_f32 v[16:17], v[16:17], v[96:97]
    v_pk_add_f32 v[116:117], v[116:117], v[136:137]
    v_pk_add_f32 v[18:19], v[18:19], v[98:99]
    v_pk_add_f32 v[118:119], v[118:119], v[138:139]
    v_lshlrev_b32 v96, 16, v156
    v_and_b32 v97, s40, v156
    v_lshlrev_b32 v98, 16, v157
    v_and_b32 v99, s40, v157
    v_pk_add_f32 v[16:17], v[16:17], v[116:117]
    v_pk_add_f32 v[18:19], v[18:19], v[118:119]
    v_pk_fma_f32 v[96:97], v[16:17], v[168:169], v[96:97]
    v_pk_fma_f32 v[98:99], v[18:19], v[170:171], v[98:99]
    v_cvt_pk_bf16_f32 v4, v96, v97
    v_cvt_pk_bf16_f32 v5, v98, v99
    ds_write_b64 v11, v[4:5] offset:0
    v_pk_add_f32 v[32:33], v[32:33], v[100:101]
    v_pk_add_f32 v[120:121], v[120:121], v[140:141]
    v_pk_add_f32 v[34:35], v[34:35], v[102:103]
    v_pk_add_f32 v[122:123], v[122:123], v[142:143]
    v_lshlrev_b32 v100, 16, v158
    v_and_b32 v101, s40, v158
    v_lshlrev_b32 v102, 16, v159
    v_and_b32 v103, s40, v159
    v_pk_add_f32 v[32:33], v[32:33], v[120:121]
    v_pk_add_f32 v[34:35], v[34:35], v[122:123]
    v_pk_fma_f32 v[100:101], v[32:33], v[172:173], v[100:101]
    v_pk_fma_f32 v[102:103], v[34:35], v[174:175], v[102:103]
    v_cvt_pk_bf16_f32 v6, v100, v101
    v_cvt_pk_bf16_f32 v7, v102, v103
    ds_write_b64 v11, v[6:7] offset:32
    s_waitcnt lgkmcnt(15)
    v_pk_add_f32 v[48:49], v[48:49], v[104:105]
    s_waitcnt lgkmcnt(14)
    v_pk_add_f32 v[124:125], v[124:125], v[144:145]
    v_pk_add_f32 v[50:51], v[50:51], v[106:107]
    v_pk_add_f32 v[126:127], v[126:127], v[146:147]
    s_waitcnt lgkmcnt(13)
    v_lshlrev_b32 v104, 16, v160
    v_and_b32 v105, s40, v160
    v_lshlrev_b32 v106, 16, v161
    v_and_b32 v107, s40, v161
    v_pk_add_f32 v[48:49], v[48:49], v[124:125]
    v_pk_add_f32 v[50:51], v[50:51], v[126:127]
    s_waitcnt lgkmcnt(12)
    v_pk_fma_f32 v[104:105], v[48:49], v[176:177], v[104:105]
    v_pk_fma_f32 v[106:107], v[50:51], v[178:179], v[106:107]
    v_cvt_pk_bf16_f32 v4, v104, v105
    v_cvt_pk_bf16_f32 v5, v106, v107
    ds_write_b64 v11, v[4:5] offset:64
    s_waitcnt lgkmcnt(12)
    v_pk_add_f32 v[64:65], v[64:65], v[108:109]
    s_waitcnt lgkmcnt(10)
    v_pk_add_f32 v[128:129], v[128:129], v[148:149]
    v_pk_add_f32 v[66:67], v[66:67], v[110:111]
    v_pk_add_f32 v[130:131], v[130:131], v[150:151]
    s_waitcnt lgkmcnt(9)
    v_lshlrev_b32 v108, 16, v162
    v_and_b32 v109, s40, v162
    v_lshlrev_b32 v110, 16, v163
    v_and_b32 v111, s40, v163
    v_pk_add_f32 v[64:65], v[64:65], v[128:129]
    v_pk_add_f32 v[66:67], v[66:67], v[130:131]
    s_waitcnt lgkmcnt(8)
    v_pk_fma_f32 v[108:109], v[64:65], v[180:181], v[108:109]
    v_pk_fma_f32 v[110:111], v[66:67], v[182:183], v[110:111]
    v_cvt_pk_bf16_f32 v6, v108, v109
    v_cvt_pk_bf16_f32 v7, v110, v111
    ds_write_b64 v11, v[6:7] offset:96
    s_waitcnt lgkmcnt(8)
    v_pk_add_f32 v[80:81], v[80:81], v[112:113]
    s_waitcnt lgkmcnt(6)
    v_pk_add_f32 v[132:133], v[132:133], v[152:153]
    v_pk_add_f32 v[82:83], v[82:83], v[114:115]
    v_pk_add_f32 v[134:135], v[134:135], v[154:155]
    s_waitcnt lgkmcnt(5)
    v_lshlrev_b32 v112, 16, v164
    v_and_b32 v113, s40, v164
    v_lshlrev_b32 v114, 16, v165
    v_and_b32 v115, s40, v165
    v_pk_add_f32 v[80:81], v[80:81], v[132:133]
    v_pk_add_f32 v[82:83], v[82:83], v[134:135]
    s_waitcnt lgkmcnt(4)
    v_pk_fma_f32 v[112:113], v[80:81], v[184:185], v[112:113]
    v_pk_fma_f32 v[114:115], v[82:83], v[186:187], v[114:115]
    v_cvt_pk_bf16_f32 v4, v112, v113
    v_cvt_pk_bf16_f32 v5, v114, v115
    ds_write_b64 v11, v[4:5] offset:128
    ds_read_b128 v[96:99], v188
    ds_read_b128 v[100:103], v189
    ds_read_b128 v[104:107], v190
    s_waitcnt lgkmcnt(2)
    buffer_store_dwordx4 v[96:99], v191, s[28:31], s36 offen
    s_waitcnt lgkmcnt(1)
    buffer_store_dwordx4 v[100:103], v192, s[28:31], s36 offen
    s_mov_b32 exec_hi, 0
    s_waitcnt lgkmcnt(0)
    buffer_store_dwordx4 v[104:107], v193, s[28:31], s36 offen
    s_endpgm
k4_exit:
    s_nop 7
    s_nop 7
    s_endpgm

all_code_end:
    s_endpgm

.section .rodata,"a"
.p2align 6
.amdhsa_kernel ka_prepconv_kernel
  .amdhsa_next_free_vgpr 128
  .amdhsa_next_free_sgpr 83
  .amdhsa_accum_offset 96
  .amdhsa_group_segment_fixed_size 0
  .amdhsa_kernarg_size 152
  .amdhsa_user_sgpr_count 2
  .amdhsa_user_sgpr_kernarg_segment_ptr 1
  .amdhsa_system_sgpr_workgroup_id_x 1
  .amdhsa_float_denorm_mode_32 0
  .amdhsa_float_denorm_mode_16_64 3
  .amdhsa_ieee_mode 0
.end_amdhsa_kernel

.p2align 6
.amdhsa_kernel k2_gemm1_kernel
  .amdhsa_next_free_vgpr 256
  .amdhsa_next_free_sgpr 48
  .amdhsa_accum_offset 96
  .amdhsa_group_segment_fixed_size 0
  .amdhsa_kernarg_size 152
  .amdhsa_user_sgpr_count 2
  .amdhsa_user_sgpr_kernarg_segment_ptr 1
  .amdhsa_system_sgpr_workgroup_id_x 1
  .amdhsa_float_denorm_mode_32 3
  .amdhsa_float_denorm_mode_16_64 3
  .amdhsa_ieee_mode 1
.end_amdhsa_kernel

.p2align 6
.amdhsa_kernel k3_gemm2_kernel
  .amdhsa_next_free_vgpr 256
  .amdhsa_next_free_sgpr 71
  .amdhsa_accum_offset 128
  .amdhsa_group_segment_fixed_size 0
  .amdhsa_kernarg_size 152
  .amdhsa_user_sgpr_count 2
  .amdhsa_user_sgpr_kernarg_segment_ptr 1
  .amdhsa_system_sgpr_workgroup_id_x 1
  .amdhsa_float_denorm_mode_32 3
  .amdhsa_float_denorm_mode_16_64 3
  .amdhsa_ieee_mode 1
.end_amdhsa_kernel

.p2align 6
.amdhsa_kernel k4_gemm3_kernel
  .amdhsa_next_free_vgpr 448
  .amdhsa_next_free_sgpr 44
  .amdhsa_accum_offset 196
  .amdhsa_group_segment_fixed_size 0
  .amdhsa_kernarg_size 152
  .amdhsa_user_sgpr_count 2
  .amdhsa_user_sgpr_kernarg_segment_ptr 1
  .amdhsa_system_sgpr_workgroup_id_x 1
  .amdhsa_float_denorm_mode_32 3
  .amdhsa_float_denorm_mode_16_64 3
  .amdhsa_ieee_mode 1
.end_amdhsa_kernel
```
